```python
import torch

def _softmax(x, axis=-1):
    return torch.softmax(x, dim=axis)

def _gelu(x):
    return torch.nn.functional.gelu(x, approximate='tanh')

def _silu(x):
    return torch.nn.functional.silu(x)

def _sigmoid(x):
    return torch.sigmoid(x)

def _layernorm(x, axis=-1, eps=1e-05):
    m = x.mean(dim=axis, keepdim=True)
    v = x.var(dim=axis, keepdim=True, unbiased=False)
    return (x - m) / torch.sqrt(v + eps)

def _scatter_add(tgt, idx, src, axis=0):
    return tgt.clone().index_add_(axis, idx, src)

def _segment_sum(src, seg, n):
    out = torch.zeros((n,) + src.shape[1:], dtype=src.dtype)
    return out.index_add_(0, seg, src)

def _pad(x, pw):
    flat = tuple((v for pair in reversed(pw) for v in pair))
    return torch.nn.functional.pad(x, flat)
kernel_name = 'gated_mix__linear_attn_block__mixer_gmlp__prompt'

def setup_inputs():

    _w = lambda a: (lambda t: t.to(torch.bfloat16) if t.is_floating_point() else t)(torch.as_tensor(a))

    def _A_setup():
        B, S, D = (1, 2048, 512)
        return {'x': _w((lambda *s: torch.randn(*s, dtype=torch.bfloat16) * 0.05)(B, S, D)), 'wqkv': _w((lambda *s: torch.randn(*s, dtype=torch.bfloat16) * 1.6)(D, 3 * D)), 'wo': _w((lambda *s: torch.randn(*s, dtype=torch.bfloat16) * 0.2)(D, D))}
    _A_in = _A_setup()

    def _B_setup():
        B, S, D, F = (1, 2048, 512, 1376)
        Fh = F // 2
        return {'x': _w((lambda *s: torch.randn(*s, dtype=torch.bfloat16) * 0.05)(B, S, D)), 'w_in': _w((lambda *s: torch.randn(*s, dtype=torch.bfloat16) * 0.4)(D, 2 * Fh)), 'w_sp': _w(0.01 * (lambda *s: torch.randn(*s, dtype=torch.bfloat16) * 0.4)(S, S)), 'b_sp': _w(1.0 + 0.01 * (lambda *s: torch.randn(*s, dtype=torch.bfloat16) * 0.05)(S)), 'w_out': _w((lambda *s: torch.randn(*s, dtype=torch.bfloat16) * 0.05)(Fh, D))}
    _B_in = _B_setup()
    return {'A_x': _A_in['x'], 'A_wqkv': _A_in['wqkv'], 'A_wo': _A_in['wo'], 'B_x': _B_in['x'], 'B_w_in': _B_in['w_in'], 'B_w_sp': _B_in['w_sp'], 'B_b_sp': _B_in['b_sp'], 'B_w_out': _B_in['w_out'], 'gate_w': _w((lambda *s: torch.randn(*s, dtype=torch.bfloat16) * 0.05)(512) * 16.0)}

def reference(A_x, A_wqkv, A_wo, B_x, B_w_in, B_w_sp, B_b_sp, B_w_out, gate_w):

    def _A_ref(x, wqkv, wo):
        B, S, D = x.shape
        H = 32
        Dh = D // H
        qkv = (lambda x, *d: x.permute(*d))((x @ wqkv).reshape(B, S, 3, H, Dh), 2, 0, 3, 1, 4)
        q, k, v = (qkv[0], qkv[1], qkv[2])
        phi = lambda t: torch.where(t > 0, t + 1, torch.exp(t)) + 1e-06
        pq, pk = (phi(q), phi(k))
        kv = torch.einsum('bhsd,bhse->bhde', pk, v)
        z = torch.einsum('bhsd->bhd', pk)
        num = torch.einsum('bhqd,bhde->bhqe', pq, kv)
        den = torch.einsum('bhqd,bhd->bhq', pq, z)[..., None] + 1e-06
        o = num / den
        return (lambda x, *d: x.permute(*d))(o, 0, 2, 1, 3).reshape(B, S, D) @ wo

    def _B_ref(x, w_in, w_sp, b_sp, w_out):
        B, S, D = x.shape
        F = w_in.shape[-1]
        Fh = F // 2
        z = _gelu(torch.einsum('bsd,df->bsf', x, w_in))
        z1 = z[..., :Fh].clone()
        z2 = _layernorm(z[..., Fh:], axis=-1)
        g = torch.einsum('ts,bsf->btf', w_sp, z2) + b_sp[None, :, None]
        return torch.einsum('bsf,fd->bsd', z1 * g, w_out)
    x = A_x
    g = _sigmoid((x * gate_w).sum(-1, keepdims=True))
    a = _A_ref(x, A_wqkv, A_wo)
    b = _B_ref(x, B_w_in, B_w_sp, B_b_sp, B_w_out)
    return g * a + (1 - g) * b
```

```asm
; @launch grid=(256,1,1) block=(256,1,1) lds=163840
.amdgcn_target "amdgcn-amd-amdhsa--gfx950"
.text
.globl gated_mix__linear_attn_block__mixer_gmlp__prompt_kernel
.p2align 8
.type gated_mix__linear_attn_block__mixer_gmlp__prompt_kernel,@function
gated_mix__linear_attn_block__mixer_gmlp__prompt_kernel:
    s_cmp_ge_u32 s2, 256
    s_cbranch_scc1 L_END
    s_load_dwordx16 s[16:31], s[0:1], 0x0
    s_load_dwordx8 s[32:39], s[0:1], 0x40
    v_lshrrev_b32 v1, 6, v0
    v_and_b32 v0, 63, v0
    s_and_b32 s64, s2, 7
    v_readfirstlane_b32 s56, v1
    s_lshr_b32 s65, s2, 3
    s_lshr_b32 s66, s65, 2
    s_and_b32 s65, s65, 3
    s_and_b32 s67, s64, 1
    s_lshr_b32 s64, s64, 1
    s_lshl3_add_u32 s57, s67, s66
    s_lshl2_add_u32 s58, s64, s65
    s_lshl3_add_u32 s59, s64, s66
    s_lshl2_add_u32 s60, s67, s65
    s_lshl1_add_u32 s15, s65, s66
    s_and_b32 s15, s15, 7
    s_mov_b32 s3, s15
    v_lshrrev_b32 v1, 3, v0
    v_and_b32 v2, 7, v0
    v_lshrrev_b32 v3, 4, v0
    v_xor_b32 v2, v2, v3
    v_lshlrev_b32 v2, 4, v2
    v_mul_u32_u24 v1, 1024, v1
    v_add_u32 v8, v1, v2
    v_xor_b32 v2, 64, v2
    v_add_u32 v1, v1, v2
    v_add_u32 v9, 7168, v1
    v_add_u32 v10, 14336, v8
    v_add_u32 v11, 21504, v1
    s_lshl_b32 s64, s58, 7
    s_add_u32 s65, s64, 1344
    s_sub_u32 s66, s64, 1024
    s_cmp_le_u32 s58, 10
    s_cselect_b32 s75, s65, s66
    s_mov_b32 s74, 3072
    s_cmov_b32 s74, 2752
    s_cselect_b32 s67, 1, 0
    s_cmp_eq_u32 s58, 0
    s_cselect_b32 s76, 32, 0
    v_bfe_u32 v1, v0, 2, 1
    v_bfe_u32 v2, v0, 4, 1
    v_xor_b32 v1, v1, v2
    v_and_b32 v2, 3, v0
    v_lshlrev_b32 v2, 4, v2
    v_lshl_add_u32 v1, v1, 6, v2
    v_lshrrev_b32 v2, 3, v0
    v_mul_lo_u32 v2, v2, s74
    v_add_u32 v2, v2, v1
    v_add_u32 v12, s75, v2
    s_lshl_b32 s64, s74, 3
    s_sub_u32 s64, s64, 1024
    v_add_u32 v13, s64, v12
    v_mov_b32 v3, 0x40000000
    v_cmp_gt_u32 vcc, s76, v1
    s_nop 1
    v_cndmask_b32 v12, v12, v3, vcc
    v_cndmask_b32 v13, v13, v3, vcc
    s_lshl_b32 s80, s74, 6
    s_lshl_b32 s64, s74, 4
    s_mul_i32 s73, s64, s56
    s_lshl_b32 s72, s56, 11
    s_lshl2_add_u32 s79, s57, s56
    s_lshl_b32 s70, s56, 12
    s_add_u32 s70, s70, 65536
    s_lshl_b32 s71, s79, 15
    s_getpc_b64 s[62:63]
L_pc0:
    s_lshr_b32 s64, s2, 3
    s_lshl2_add_u32 s64, s64, s56
    s_lshl_b32 s64, s64, 9
    s_min_u32 s64, s64, L_code_end-L_pc0-512
    v_lshlrev_b32 v4, 3, v0
    v_add_u32 v4, s64, v4
    global_load_dwordx2 v[250:251], v4, s[62:63]
    s_waitcnt lgkmcnt(0)
    s_mov_b32 s40, s16
    s_mov_b32 s41, s17
    s_mov_b32 s42, 0x200000
    s_mov_b32 s43, 0x20000
    s_cmp_eq_u32 s67, 0
    s_cselect_b32 s44, s18, s24
    s_cselect_b32 s45, s19, s25
    s_mov_b32 s46, 0x158000
    s_cmov_b32 s46, 0x180000
    s_mov_b32 s47, 0x20000
    s_add_u32 s12, s15, 0
    s_and_b32 s12, s12, 7
    s_lshl_b32 s12, s12, 7
    s_add_u32 s12, s12, s71
    s_add_u32 m0, s70, 0
    s_nop 0
    buffer_load_dwordx4 v8, s[40:43], s12 offen offset:0 lds
    buffer_load_dwordx4 v9, s[40:43], s12 offen offset:1024 lds
    buffer_load_dwordx4 v10, s[40:43], s12 offen offset:2048 lds
    buffer_load_dwordx4 v11, s[40:43], s12 offen offset:3072 lds
    s_add_u32 s12, s15, 0
    s_and_b32 s12, s12, 7
    s_mul_i32 s12, s12, s80
    s_add_u32 s12, s12, s73
    s_add_u32 m0, s72, 0
    s_nop 0
    buffer_load_dwordx4 v12, s[44:47], s12 offen lds
    buffer_load_dwordx4 v13, s[44:47], s12 offen offset:1024 lds
    s_add_u32 s12, s15, 1
    s_and_b32 s12, s12, 7
    s_lshl_b32 s12, s12, 7
    s_add_u32 s12, s12, s71
    s_add_u32 m0, s70, 16384
    s_nop 0
    buffer_load_dwordx4 v8, s[40:43], s12 offen offset:0 lds
    buffer_load_dwordx4 v9, s[40:43], s12 offen offset:1024 lds
    buffer_load_dwordx4 v10, s[40:43], s12 offen offset:2048 lds
    buffer_load_dwordx4 v11, s[40:43], s12 offen offset:3072 lds
    s_add_u32 s12, s15, 1
    s_and_b32 s12, s12, 7
    s_mul_i32 s12, s12, s80
    s_add_u32 s12, s12, s73
    s_add_u32 m0, s72, 8192
    s_nop 0
    buffer_load_dwordx4 v12, s[44:47], s12 offen lds
    buffer_load_dwordx4 v13, s[44:47], s12 offen offset:1024 lds
    s_mov_b32 s48, s38
    s_mov_b32 s49, s39
    s_mov_b32 s50, 0x10000000
    s_mov_b32 s51, 0x20000
    buffer_load_dword v36, off, s[48:51], 0 sc1
    s_mov_b32 s82, 0x3fb8aa3b
    s_mov_b32 s83, 0x358637bd
    v_mov_b32 v26, 0xc0135761
    v_mov_b32 v38, 0xc0135761
    v_mov_b32 v39, 0xc0135761
    s_mov_b32 s62, 0xbdd2d3e8
    s_mov_b32 s63, 0xbdd2d3e8
    s_mov_b32 s84, 1.0
    s_mov_b32 s85, 1.0
    s_mov_b32 s100, 0x3fb8aa3b
    s_mov_b32 s101, 0x3fb8aa3b
    v_lshlrev_b32 v24, 4, v0
    v_lshlrev_b32 v25, 3, v0
    v_and_b32 v1, 31, v0
    v_lshrrev_b32 v2, 5, v0
    v_bfe_u32 v3, v0, 1, 3
    v_xor_b32 v2, v2, v3
    v_lshlrev_b32 v2, 4, v2
    v_lshl_add_u32 v32, v1, 7, v2
    v_xor_b32 v33, 32, v32
    v_xor_b32 v34, 64, v32
    v_xor_b32 v35, 96, v32
    s_lshl_b32 s64, s56, 12
    s_add_u32 s65, s64, 65536
    v_add_u32 v14, s65, v32
    v_add_u32 v15, s65, v33
    v_add_u32 v16, s65, v34
    v_add_u32 v17, s65, v35
    v_bfe_u32 v1, v0, 2, 2
    v_lshrrev_b32 v2, 5, v0
    v_lshl_add_u32 v2, v2, 3, v1
    v_lshlrev_b32 v2, 7, v2
    v_lshrrev_b32 v1, 1, v1
    v_lshl_add_u32 v2, v1, 6, v2
    v_bfe_u32 v1, v0, 4, 1
    v_lshl_add_u32 v2, v1, 5, v2
    v_and_b32 v1, 3, v0
    v_lshl_add_u32 v22, v1, 3, v2
    v_xor_b32 v23, 64, v22
    s_mov_b32 s4, s26
    s_mov_b32 s5, s27
    s_mov_b32 s6, 0x800000
    s_mov_b32 s7, 0x20000
    v_lshrrev_b32 v1, 3, v0
    v_and_b32 v2, 7, v0
    v_lshrrev_b32 v3, 4, v0
    v_xor_b32 v2, v2, v3
    v_lshlrev_b32 v2, 4, v2
    v_mul_u32_u24 v1, 4096, v1
    v_add_u32 v40, v1, v2
    v_xor_b32 v2, 64, v2
    v_add_u32 v1, v1, v2
    v_add_u32 v41, 31744, v1
    v_add_u32 v42, 63488, v40
    v_add_u32 v43, 95232, v1
    v_lshlrev_b32 v44, 7, v0
    s_lshl_b32 s14, s59, 18
    s_lshl_b32 s64, s56, 10
    s_add_u32 s14, s14, s64
    s_mov_b32 s52, s28
    s_mov_b32 s53, s29
    s_mov_b32 s54, 0x1000
    s_mov_b32 s55, 0x20000
    s_and_b32 s64, s56, 1
    s_lshl_b32 s64, s64, 6
    s_lshl_b32 s65, s59, 7
    s_add_u32 s64, s64, s65
    v_and_b32 v1, 31, v0
    v_lshlrev_b32 v1, 1, v1
    buffer_load_ushort v45, v1, s[52:55], s64 offen
    s_add_u32 s16, s3, 0
    s_and_b32 s16, s16, 7
    s_lshl_b32 s16, s16, 7
    s_add_u32 s16, s16, s14
    s_add_u32 s17, s3, 1
    s_and_b32 s17, s17, 7
    s_lshl_b32 s17, s17, 7
    s_add_u32 s17, s17, s14
    s_add_u32 s22, s3, 2
    s_and_b32 s22, s22, 7
    s_lshl_b32 s22, s22, 7
    s_add_u32 s22, s22, s14
    s_add_u32 s23, s3, 3
    s_and_b32 s23, s23, 7
    s_lshl_b32 s23, s23, 7
    s_add_u32 s23, s23, s14
    s_add_u32 s26, s3, 4
    s_and_b32 s26, s26, 7
    s_lshl_b32 s26, s26, 7
    s_add_u32 s26, s26, s14
    s_add_u32 s27, s3, 5
    s_and_b32 s27, s27, 7
    s_lshl_b32 s27, s27, 7
    s_add_u32 s27, s27, s14
    s_add_u32 s28, s3, 6
    s_and_b32 s28, s28, 7
    s_lshl_b32 s28, s28, 7
    s_add_u32 s28, s28, s14
    s_add_u32 s29, s3, 7
    s_and_b32 s29, s29, 7
    s_lshl_b32 s29, s29, 7
    s_add_u32 s29, s29, s14
    s_lshl_b32 s36, s56, 13
    s_add_u32 s36, s36, 65536
    s_lshl_b32 s37, s56, 14
    s_add_u32 s37, s37, 98304
    v_add_u32 v48, s36, v32
    v_add_u32 v52, s37, v32
    v_add_u32 v56, 8192, v52
    v_add_u32 v49, s36, v33
    v_add_u32 v53, s37, v33
    v_add_u32 v57, 8192, v53
    v_add_u32 v50, s36, v34
    v_add_u32 v54, s37, v34
    v_add_u32 v58, 8192, v54
    v_add_u32 v51, s36, v35
    v_add_u32 v55, s37, v35
    v_add_u32 v59, 8192, v55
    s_lshl_b32 s64, s56, 14
    s_add_u32 s64, s64, 106496
    v_and_b32 v37, 31, v0
    v_lshrrev_b32 v1, 5, v0
    v_and_b32 v2, 15, v0
    v_xor_b32 v1, v1, v2
    v_lshlrev_b32 v1, 3, v1
    v_lshl_add_u32 v37, v37, 7, v1
    v_add_u32 v37, s64, v37
    v_bfe_u32 v3, v0, 2, 2
    v_lshrrev_b32 v4, 5, v0
    v_lshl_add_u32 v3, v4, 3, v3
    v_bfe_u32 v4, v0, 4, 1
    v_and_b32 v5, 3, v0
    v_lshl_add_u32 v4, v4, 2, v5
    v_xor_b32 v4, v4, v3
    v_lshlrev_b32 v4, 3, v4
    v_lshl_add_u32 v3, v3, 7, v4
    v_add_u32 v3, s64, v3
    v_xor_b32 v60, 0, v3
    v_xor_b32 v61, 32, v3
    v_xor_b32 v62, 64, v3
    v_xor_b32 v63, 96, v3
    s_lshl_b32 s64, s58, 7
    s_add_u32 s88, s64, 1024
    s_add_u32 s92, s64, 2048
    s_mov_b32 s90, 0
    s_mov_b32 s94, 0
    s_mov_b32 s89, 0
    s_mov_b32 s93, 0
    s_cmp_lt_u32 s58, 8
    s_cbranch_scc1 L_desc_done
    s_cmp_lt_u32 s58, 11
    s_cbranch_scc0 L_desc_cd
    s_sub_u32 s88, s64, 1024
    s_sub_u32 s92, s64, 1056
    s_mov_b32 s94, 1
    s_cmp_eq_u32 s58, 8
    s_cselect_b32 s93, 32, 0
    s_branch L_desc_done
L_desc_cd:
    s_lshl_b32 s65, s64, 1
    s_sub_u32 s65, s65, 2464
    s_sub_u32 s66, s64, 672
    s_cmp_lt_u32 s58, 14
    s_cselect_b32 s88, s65, s66
    s_add_u32 s92, s88, 128
    s_mov_b32 s90, 1
    s_mov_b32 s94, 1
L_desc_done:
    v_mov_b32 v64, 0
    v_mov_b32 v65, 0
    v_mov_b32 v66, 0
    v_mov_b32 v67, 0
    v_mov_b32 v68, 0
    v_mov_b32 v69, 0
    v_mov_b32 v70, 0
    v_mov_b32 v71, 0
    v_mov_b32 v72, 0
    v_mov_b32 v73, 0
    v_mov_b32 v74, 0
    v_mov_b32 v75, 0
    v_mov_b32 v76, 0
    v_mov_b32 v77, 0
    v_mov_b32 v78, 0
    v_mov_b32 v79, 0
    v_mov_b32 v80, 0
    v_mov_b32 v81, 0
    v_mov_b32 v82, 0
    v_mov_b32 v83, 0
    v_mov_b32 v84, 0
    v_mov_b32 v85, 0
    v_mov_b32 v86, 0
    v_mov_b32 v87, 0
    v_mov_b32 v88, 0
    v_mov_b32 v89, 0
    v_mov_b32 v90, 0
    v_mov_b32 v91, 0
    v_mov_b32 v92, 0
    v_mov_b32 v93, 0
    v_mov_b32 v94, 0
    v_mov_b32 v95, 0
    s_add_u32 s12, s15, 2
    s_and_b32 s12, s12, 7
    s_lshl_b32 s12, s12, 7
    s_add_u32 s12, s12, s71
    s_add_u32 m0, s70, 32768
    s_nop 0
    buffer_load_dwordx4 v8, s[40:43], s12 offen offset:0 lds
    buffer_load_dwordx4 v9, s[40:43], s12 offen offset:1024 lds
    buffer_load_dwordx4 v10, s[40:43], s12 offen offset:2048 lds
    buffer_load_dwordx4 v11, s[40:43], s12 offen offset:3072 lds
    s_add_u32 s12, s15, 2
    s_and_b32 s12, s12, 7
    s_mul_i32 s12, s12, s80
    s_add_u32 s12, s12, s73
    s_add_u32 m0, s72, 16384
    s_nop 0
    buffer_load_dwordx4 v12, s[44:47], s12 offen lds
    buffer_load_dwordx4 v13, s[44:47], s12 offen offset:1024 lds
    s_mov_b32 s8, s38
    s_mov_b32 s9, s39
    s_mov_b32 s10, 0x40
    s_mov_b32 s11, 0x20000
    s_mov_b64 exec, 0
    s_cmp_eq_u32 s56, 1
    s_cbranch_scc1 L_pad_p1_done_0
    s_cmp_eq_u32 s56, 2
    s_cbranch_scc0 L_hop_role
    s_cmp_ge_u32 s60, 6
    s_cbranch_scc1 L_pad_P2L_0
    s_branch L_pad_P3_0
L_hop_role:
    s_cmp_eq_u32 s56, 3
    s_cbranch_scc1 L_hop_role2
    s_cmp_lt_u32 s58, 8
    s_cbranch_scc1 L_pad_roleA_0
    s_cmp_lt_u32 s58, 11
    s_cbranch_scc1 L_pad_roleB_0
    s_cmp_lt_u32 s58, 14
    s_cbranch_scc1 L_pad_roleC_0
    s_branch L_pad_roleD_0
L_hop_role2:
    s_cmp_lt_u32 s58, 8
    s_cbranch_scc1 L_pad_roleA_H
    s_cmp_lt_u32 s58, 11
    s_cbranch_scc1 L_pad_roleB_H
    s_cmp_lt_u32 s58, 14
    s_cbranch_scc1 L_pad_roleC_H
    s_branch L_pad_roleD_H
L_hopret:
    s_mov_b64 exec, -1
    s_branch L_pg0
.p2align 12
L_pg0:
L_pad_pg0_0:
    s_cbranch_execz L_hopret
    s_waitcnt vmcnt(14)
    s_waitcnt lgkmcnt(0)
    s_barrier
    ds_read_b128 a[128:131], v14
    ds_read_b64_tr_b16 v[128:129], v22 offset:0
    ds_read_b64_tr_b16 v[130:131], v22 offset:512
    ds_read_b64_tr_b16 v[132:133], v23 offset:0
    s_waitcnt lgkmcnt(1)
    v_mfma_f32_32x32x16_bf16 v[64:79], v[128:131], a[128:131], v[64:79]
    ds_read_b64_tr_b16 v[134:135], v23 offset:512
    ds_read_b128 a[132:135], v15
    ds_read_b64_tr_b16 v[136:137], v22 offset:2048
    ds_read_b64_tr_b16 v[138:139], v22 offset:2560
    ds_read_b64_tr_b16 v[140:141], v23 offset:2048
    ds_read_b64_tr_b16 v[142:143], v23 offset:2560
    s_waitcnt lgkmcnt(5)
    v_mfma_f32_32x32x16_bf16 v[80:95], v[132:135], a[128:131], v[80:95]
    ds_read_b128 a[136:139], v16
    ds_read_b64_tr_b16 v[144:145], v22 offset:4096
    ds_read_b64_tr_b16 v[146:147], v22 offset:4608
    ds_read_b64_tr_b16 v[148:149], v23 offset:4096
    ds_read_b64_tr_b16 v[150:151], v23 offset:4608
    ds_read_b128 a[140:143], v17
    s_waitcnt lgkmcnt(8)
    v_mfma_f32_32x32x16_bf16 v[64:79], v[136:139], a[132:135], v[64:79]
    ds_read_b64_tr_b16 v[152:153], v22 offset:6144
    ds_read_b64_tr_b16 v[154:155], v22 offset:6656
    ds_read_b64_tr_b16 v[156:157], v23 offset:6144
    ds_read_b64_tr_b16 v[158:159], v23 offset:6656
    s_add_u32 s12, s15, 3
    s_and_b32 s12, s12, 7
    s_waitcnt lgkmcnt(10)
    v_mfma_f32_32x32x16_bf16 v[80:95], v[140:143], a[132:135], v[80:95]
    s_lshl_b32 s12, s12, 7
    s_add_u32 s12, s12, s71
    s_add_u32 m0, s70, 49152
    s_nop 0
    buffer_load_dwordx4 v8, s[40:43], s12 offen offset:0 lds
    buffer_load_dwordx4 v9, s[40:43], s12 offen offset:1024 lds
    buffer_load_dwordx4 v10, s[40:43], s12 offen offset:2048 lds
    s_waitcnt lgkmcnt(7)
    v_mfma_f32_32x32x16_bf16 v[64:79], v[144:147], a[136:139], v[64:79]
    buffer_load_dwordx4 v11, s[40:43], s12 offen offset:3072 lds
    s_add_u32 s12, s15, 3
    s_and_b32 s12, s12, 7
    s_mul_i32 s12, s12, s80
    s_add_u32 s12, s12, s73
    s_add_u32 m0, s72, 24576
    s_waitcnt lgkmcnt(5)
    v_mfma_f32_32x32x16_bf16 v[80:95], v[148:151], a[136:139], v[80:95]
    buffer_load_dwordx4 v12, s[44:47], s12 offen lds
    buffer_load_dwordx4 v13, s[44:47], s12 offen offset:1024 lds
    v_add_u32 v14, 16384, v14
    v_add_u32 v15, 16384, v15
    v_add_u32 v16, 16384, v16
    v_add_u32 v17, 16384, v17
    s_waitcnt lgkmcnt(2)
    v_mfma_f32_32x32x16_bf16 v[64:79], v[152:155], a[140:143], v[64:79]
    s_waitcnt vmcnt(14)
    s_waitcnt lgkmcnt(0)
    s_barrier
    ds_read_b128 a[144:147], v14
    ds_read_b64_tr_b16 v[128:129], v22 offset:8192
    ds_read_b64_tr_b16 v[130:131], v22 offset:8704
    ds_read_b64_tr_b16 v[132:133], v23 offset:8192
    v_mfma_f32_32x32x16_bf16 v[80:95], v[156:159], a[140:143], v[80:95]
    ds_read_b64_tr_b16 v[134:135], v23 offset:8704
    ds_read_b128 a[148:151], v15
    ds_read_b64_tr_b16 v[136:137], v22 offset:10240
    ds_read_b64_tr_b16 v[138:139], v22 offset:10752
    ds_read_b64_tr_b16 v[140:141], v23 offset:10240
    ds_read_b64_tr_b16 v[142:143], v23 offset:10752
    s_waitcnt lgkmcnt(7)
    v_mfma_f32_32x32x16_bf16 v[64:79], v[128:131], a[144:147], v[64:79]
    ds_read_b128 a[152:155], v16
    ds_read_b64_tr_b16 v[144:145], v22 offset:12288
    ds_read_b64_tr_b16 v[146:147], v22 offset:12800
    ds_read_b64_tr_b16 v[148:149], v23 offset:12288
    ds_read_b64_tr_b16 v[150:151], v23 offset:12800
    ds_read_b128 a[156:159], v17
    s_waitcnt lgkmcnt(11)
    v_mfma_f32_32x32x16_bf16 v[80:95], v[132:135], a[144:147], v[80:95]
    ds_read_b64_tr_b16 v[152:153], v22 offset:14336
    ds_read_b64_tr_b16 v[154:155], v22 offset:14848
    ds_read_b64_tr_b16 v[156:157], v23 offset:14336
    ds_read_b64_tr_b16 v[158:159], v23 offset:14848
    s_add_u32 s12, s15, 4
    s_and_b32 s12, s12, 7
    s_waitcnt lgkmcnt(12)
    v_mfma_f32_32x32x16_bf16 v[64:79], v[136:139], a[148:151], v[64:79]
    s_lshl_b32 s12, s12, 7
    s_add_u32 s12, s12, s71
    s_add_u32 m0, s70, 0
    s_nop 0
    buffer_load_dwordx4 v8, s[40:43], s12 offen offset:0 lds
    buffer_load_dwordx4 v9, s[40:43], s12 offen offset:1024 lds
    buffer_load_dwordx4 v10, s[40:43], s12 offen offset:2048 lds
    s_waitcnt lgkmcnt(10)
    v_mfma_f32_32x32x16_bf16 v[80:95], v[140:143], a[148:151], v[80:95]
    buffer_load_dwordx4 v11, s[40:43], s12 offen offset:3072 lds
    s_add_u32 s12, s15, 4
    s_and_b32 s12, s12, 7
    s_mul_i32 s12, s12, s80
    s_add_u32 s12, s12, s73
    s_add_u32 m0, s72, 32768
    s_waitcnt lgkmcnt(7)
    v_mfma_f32_32x32x16_bf16 v[64:79], v[144:147], a[152:155], v[64:79]
    buffer_load_dwordx4 v12, s[44:47], s12 offen lds
    buffer_load_dwordx4 v13, s[44:47], s12 offen offset:1024 lds
    v_add_u32 v14, 16384, v14
    v_add_u32 v15, 16384, v15
    v_add_u32 v16, 16384, v16
    v_add_u32 v17, 16384, v17
    s_waitcnt lgkmcnt(5)
    v_mfma_f32_32x32x16_bf16 v[80:95], v[148:151], a[152:155], v[80:95]
    s_waitcnt vmcnt(12)
    s_waitcnt lgkmcnt(0)
    s_barrier
    ds_read_b128 a[160:163], v14
    ds_read_b64_tr_b16 v[128:129], v22 offset:16384
    ds_read_b64_tr_b16 v[130:131], v22 offset:16896
    ds_read_b64_tr_b16 v[132:133], v23 offset:16384
    v_mfma_f32_32x32x16_bf16 v[64:79], v[152:155], a[156:159], v[64:79]
    ds_read_b64_tr_b16 v[134:135], v23 offset:16896
    ds_read_b128 a[164:167], v15
    ds_read_b64_tr_b16 v[136:137], v22 offset:18432
    ds_read_b64_tr_b16 v[138:139], v22 offset:18944
    ds_read_b64_tr_b16 v[140:141], v23 offset:18432
    ds_read_b64_tr_b16 v[142:143], v23 offset:18944
    v_mfma_f32_32x32x16_bf16 v[80:95], v[156:159], a[156:159], v[80:95]
    ds_read_b128 a[168:171], v16
    ds_read_b64_tr_b16 v[144:145], v22 offset:20480
    ds_read_b64_tr_b16 v[146:147], v22 offset:20992
    ds_read_b64_tr_b16 v[148:149], v23 offset:20480
    ds_read_b64_tr_b16 v[150:151], v23 offset:20992
    ds_read_b128 a[172:175], v17
    s_waitcnt lgkmcnt(13)
    v_mfma_f32_32x32x16_bf16 v[64:79], v[128:131], a[160:163], v[64:79]
    ds_read_b64_tr_b16 v[152:153], v22 offset:22528
    ds_read_b64_tr_b16 v[154:155], v22 offset:23040
    ds_read_b64_tr_b16 v[156:157], v23 offset:22528
    ds_read_b64_tr_b16 v[158:159], v23 offset:23040
    s_waitcnt lgkmcnt(14)
    v_mfma_f32_32x32x16_bf16 v[80:95], v[132:135], a[160:163], v[80:95]
    s_add_u32 s12, s15, 5
    s_and_b32 s12, s12, 7
    s_lshl_b32 s12, s12, 7
    s_add_u32 s12, s12, s71
    s_add_u32 m0, s70, 16384
    s_nop 0
    buffer_load_dwordx4 v8, s[40:43], s12 offen offset:0 lds
    s_waitcnt lgkmcnt(12)
    v_mfma_f32_32x32x16_bf16 v[64:79], v[136:139], a[164:167], v[64:79]
    buffer_load_dwordx4 v9, s[40:43], s12 offen offset:1024 lds
    buffer_load_dwordx4 v10, s[40:43], s12 offen offset:2048 lds
    buffer_load_dwordx4 v11, s[40:43], s12 offen offset:3072 lds
    s_add_u32 s12, s15, 5
    s_and_b32 s12, s12, 7
    s_mul_i32 s12, s12, s80
    s_waitcnt lgkmcnt(10)
    v_mfma_f32_32x32x16_bf16 v[80:95], v[140:143], a[164:167], v[80:95]
    s_add_u32 s12, s12, s73
    s_add_u32 m0, s72, 40960
    s_nop 0
    buffer_load_dwordx4 v12, s[44:47], s12 offen lds
    buffer_load_dwordx4 v13, s[44:47], s12 offen offset:1024 lds
    v_add_u32 v14, 16384, v14
    v_add_u32 v15, 16384, v15
    s_waitcnt lgkmcnt(7)
    v_mfma_f32_32x32x16_bf16 v[64:79], v[144:147], a[168:171], v[64:79]
    v_add_u32 v16, 16384, v16
    v_add_u32 v17, 16384, v17
    s_waitcnt vmcnt(12)
    s_waitcnt lgkmcnt(0)
    s_barrier
    ds_read_b128 a[176:179], v14
    ds_read_b64_tr_b16 v[128:129], v22 offset:24576
    v_mfma_f32_32x32x16_bf16 v[80:95], v[148:151], a[168:171], v[80:95]
    ds_read_b64_tr_b16 v[130:131], v22 offset:25088
    ds_read_b64_tr_b16 v[132:133], v23 offset:24576
    ds_read_b64_tr_b16 v[134:135], v23 offset:25088
    ds_read_b128 a[180:183], v15
    ds_read_b64_tr_b16 v[136:137], v22 offset:26624
    ds_read_b64_tr_b16 v[138:139], v22 offset:27136
    v_mfma_f32_32x32x16_bf16 v[64:79], v[152:155], a[172:175], v[64:79]
    ds_read_b64_tr_b16 v[140:141], v23 offset:26624
    ds_read_b64_tr_b16 v[142:143], v23 offset:27136
    ds_read_b128 a[184:187], v16
    ds_read_b64_tr_b16 v[144:145], v22 offset:28672
    ds_read_b64_tr_b16 v[146:147], v22 offset:29184
    ds_read_b64_tr_b16 v[148:149], v23 offset:28672
    v_mfma_f32_32x32x16_bf16 v[80:95], v[156:159], a[172:175], v[80:95]
    ds_read_b64_tr_b16 v[150:151], v23 offset:29184
    ds_read_b128 a[188:191], v17
    ds_read_b64_tr_b16 v[152:153], v22 offset:30720
    ds_read_b64_tr_b16 v[154:155], v22 offset:31232
    ds_read_b64_tr_b16 v[156:157], v23 offset:30720
    ds_read_b64_tr_b16 v[158:159], v23 offset:31232
    s_waitcnt lgkmcnt(14)
    v_mfma_f32_32x32x16_bf16 v[64:79], v[128:131], a[176:179], v[64:79]
    v_mfma_f32_32x32x16_bf16 v[80:95], v[132:135], a[176:179], v[80:95]
    s_add_u32 s12, s15, 6
    s_and_b32 s12, s12, 7
    s_lshl_b32 s12, s12, 7
    s_add_u32 s12, s12, s71
    s_add_u32 m0, s70, 32768
    s_nop 0
    buffer_load_dwordx4 v8, s[40:43], s12 offen offset:0 lds
    s_waitcnt lgkmcnt(12)
    v_mfma_f32_32x32x16_bf16 v[64:79], v[136:139], a[180:183], v[64:79]
    buffer_load_dwordx4 v9, s[40:43], s12 offen offset:1024 lds
    buffer_load_dwordx4 v10, s[40:43], s12 offen offset:2048 lds
    buffer_load_dwordx4 v11, s[40:43], s12 offen offset:3072 lds
    s_add_u32 s12, s15, 6
    s_and_b32 s12, s12, 7
    s_mul_i32 s12, s12, s80
    s_waitcnt lgkmcnt(10)
    v_mfma_f32_32x32x16_bf16 v[80:95], v[140:143], a[180:183], v[80:95]
    s_add_u32 s12, s12, s73
    s_add_u32 m0, s72, 49152
    s_nop 0
    buffer_load_dwordx4 v12, s[44:47], s12 offen lds
    buffer_load_dwordx4 v13, s[44:47], s12 offen offset:1024 lds
    v_subrev_u32 v14, 49152, v14
    v_subrev_u32 v15, 49152, v15
    s_waitcnt lgkmcnt(7)
    v_mfma_f32_32x32x16_bf16 v[64:79], v[144:147], a[184:187], v[64:79]
    v_subrev_u32 v16, 49152, v16
    v_subrev_u32 v17, 49152, v17
    s_waitcnt vmcnt(12)
    v_add_u32 v27, 0x9e3779b1, v36
    s_nop 0
    v_readfirstlane_b32 s61, v27
    s_waitcnt lgkmcnt(0)
    s_barrier
    v_mfma_f32_32x32x16_bf16 v[80:95], v[148:151], a[184:187], v[80:95]
    ds_read_b128 a[192:195], v14
    ds_read_b64_tr_b16 v[128:129], v22 offset:32768
    ds_read_b64_tr_b16 v[130:131], v22 offset:33280
    ds_read_b64_tr_b16 v[132:133], v23 offset:32768
    ds_read_b64_tr_b16 v[134:135], v23 offset:33280
    ds_read_b128 a[196:199], v15
    v_mfma_f32_32x32x16_bf16 v[64:79], v[152:155], a[188:191], v[64:79]
    ds_read_b64_tr_b16 v[136:137], v22 offset:34816
    ds_read_b64_tr_b16 v[138:139], v22 offset:35328
    ds_read_b64_tr_b16 v[140:141], v23 offset:34816
    ds_read_b64_tr_b16 v[142:143], v23 offset:35328
    ds_read_b128 a[200:203], v16
    ds_read_b64_tr_b16 v[144:145], v22 offset:36864
    v_mfma_f32_32x32x16_bf16 v[80:95], v[156:159], a[188:191], v[80:95]
    ds_read_b64_tr_b16 v[146:147], v22 offset:37376
    ds_read_b64_tr_b16 v[148:149], v23 offset:36864
    ds_read_b64_tr_b16 v[150:151], v23 offset:37376
    ds_read_b128 a[204:207], v17
    ds_read_b64_tr_b16 v[152:153], v22 offset:38912
    ds_read_b64_tr_b16 v[154:155], v22 offset:39424
    s_waitcnt lgkmcnt(14)
    v_mfma_f32_32x32x16_bf16 v[64:79], v[128:131], a[192:195], v[64:79]
    ds_read_b64_tr_b16 v[156:157], v23 offset:38912
    ds_read_b64_tr_b16 v[158:159], v23 offset:39424
    s_waitcnt lgkmcnt(14)
    v_mfma_f32_32x32x16_bf16 v[80:95], v[132:135], a[192:195], v[80:95]
    s_add_u32 s12, s15, 7
    s_and_b32 s12, s12, 7
    s_lshl_b32 s12, s12, 7
    s_add_u32 s12, s12, s71
    s_add_u32 m0, s70, 49152
    s_nop 0
    buffer_load_dwordx4 v8, s[40:43], s12 offen offset:0 lds
    s_waitcnt lgkmcnt(12)
    v_mfma_f32_32x32x16_bf16 v[64:79], v[136:139], a[196:199], v[64:79]
    buffer_load_dwordx4 v9, s[40:43], s12 offen offset:1024 lds
    buffer_load_dwordx4 v10, s[40:43], s12 offen offset:2048 lds
    buffer_load_dwordx4 v11, s[40:43], s12 offen offset:3072 lds
    s_add_u32 s12, s15, 7
    s_and_b32 s12, s12, 7
    s_mul_i32 s12, s12, s80
    s_waitcnt lgkmcnt(10)
    v_mfma_f32_32x32x16_bf16 v[80:95], v[140:143], a[196:199], v[80:95]
    s_add_u32 s12, s12, s73
    s_add_u32 m0, s72, 57344
    s_nop 0
    buffer_load_dwordx4 v12, s[44:47], s12 offen lds
    buffer_load_dwordx4 v13, s[44:47], s12 offen offset:1024 lds
    v_add_u32 v14, 16384, v14
    v_add_u32 v15, 16384, v15
    s_waitcnt lgkmcnt(7)
    v_mfma_f32_32x32x16_bf16 v[64:79], v[144:147], a[200:203], v[64:79]
    v_add_u32 v16, 16384, v16
    v_add_u32 v17, 16384, v17
    s_waitcnt vmcnt(12)
    s_waitcnt lgkmcnt(0)
    s_barrier
    s_cmp_eq_u32 s90, 0
    s_mov_b32 s74, 2752
    v_mfma_f32_32x32x16_bf16 v[80:95], v[148:151], a[200:203], v[80:95]
    s_cmov_b32 s74, 3072
    s_mov_b32 s75, s88
    s_mov_b32 s76, s89
    s_cmp_eq_u32 s90, 0
    s_cselect_b32 s44, s18, s24
    s_cselect_b32 s45, s19, s25
    v_mfma_f32_32x32x16_bf16 v[64:79], v[152:155], a[204:207], v[64:79]
    s_mov_b32 s46, 0x158000
    s_cmov_b32 s46, 0x180000
    s_mov_b32 s47, 0x20000
    v_bfe_u32 v1, v0, 2, 1
    v_bfe_u32 v2, v0, 4, 1
    v_xor_b32 v1, v1, v2
    v_mfma_f32_32x32x16_bf16 v[80:95], v[156:159], a[204:207], v[80:95]
    v_and_b32 v2, 3, v0
    v_lshlrev_b32 v2, 4, v2
    v_lshl_add_u32 v1, v1, 6, v2
    v_lshrrev_b32 v2, 3, v0
    v_mul_lo_u32 v2, v2, s74
    v_add_u32 v2, v2, v1
    v_add_u32 v12, s75, v2
    s_lshl_b32 s64, s74, 3
    s_sub_u32 s64, s64, 1024
    v_add_u32 v13, s64, v12
    v_mov_b32 v3, 0x40000000
    v_cmp_gt_u32 vcc, s76, v1
    s_nop 1
    v_cndmask_b32 v12, v12, v3, vcc
    v_cndmask_b32 v13, v13, v3, vcc
    s_lshl_b32 s80, s74, 6
    s_lshl_b32 s64, s74, 4
    s_mul_i32 s73, s64, s56
    ds_read_b128 a[208:211], v14
    ds_read_b64_tr_b16 v[128:129], v22 offset:40960
    ds_read_b64_tr_b16 v[130:131], v22 offset:41472
    s_waitcnt lgkmcnt(0)
    v_mfma_f32_32x32x16_bf16 v[64:79], v[128:131], a[208:211], v[64:79]
    ds_read_b64_tr_b16 v[132:133], v23 offset:40960
    ds_read_b64_tr_b16 v[134:135], v23 offset:41472
    ds_read_b128 a[212:215], v15
    ds_read_b64_tr_b16 v[136:137], v22 offset:43008
    ds_read_b64_tr_b16 v[138:139], v22 offset:43520
    ds_read_b64_tr_b16 v[140:141], v23 offset:43008
    s_waitcnt lgkmcnt(4)
    v_mfma_f32_32x32x16_bf16 v[80:95], v[132:135], a[208:211], v[80:95]
    ds_read_b64_tr_b16 v[142:143], v23 offset:43520
    ds_read_b128 a[216:219], v16
    ds_read_b64_tr_b16 v[144:145], v22 offset:45056
    ds_read_b64_tr_b16 v[146:147], v22 offset:45568
    ds_read_b64_tr_b16 v[148:149], v23 offset:45056
    ds_read_b64_tr_b16 v[150:151], v23 offset:45568
    s_waitcnt lgkmcnt(7)
    v_mfma_f32_32x32x16_bf16 v[64:79], v[136:139], a[212:215], v[64:79]
    ds_read_b128 a[220:223], v17
    ds_read_b64_tr_b16 v[152:153], v22 offset:47104
    ds_read_b64_tr_b16 v[154:155], v22 offset:47616
    ds_read_b64_tr_b16 v[156:157], v23 offset:47104
    ds_read_b64_tr_b16 v[158:159], v23 offset:47616
    s_add_u32 s12, s15, 4
    s_waitcnt lgkmcnt(10)
    v_mfma_f32_32x32x16_bf16 v[80:95], v[140:143], a[212:215], v[80:95]
    s_and_b32 s12, s12, 7
    s_mul_i32 s12, s12, s80
    s_add_u32 s12, s12, s73
    s_add_u32 m0, s72, 131072
    s_nop 0
    buffer_load_dwordx4 v12, s[44:47], s12 offen lds
    buffer_load_dwordx4 v13, s[44:47], s12 offen offset:1024 lds
    s_waitcnt lgkmcnt(7)
    v_mfma_f32_32x32x16_bf16 v[64:79], v[144:147], a[216:219], v[64:79]
    s_add_u32 s12, s15, 5
    s_and_b32 s12, s12, 7
    s_mul_i32 s12, s12, s80
    s_add_u32 s12, s12, s73
    s_add_u32 m0, s72, 139264
    s_nop 0
    buffer_load_dwordx4 v12, s[44:47], s12 offen lds
    s_waitcnt lgkmcnt(5)
    v_mfma_f32_32x32x16_bf16 v[80:95], v[148:151], a[216:219], v[80:95]
    buffer_load_dwordx4 v13, s[44:47], s12 offen offset:1024 lds
    v_add_u32 v14, 16384, v14
    v_add_u32 v15, 16384, v15
    v_add_u32 v16, 16384, v16
    v_add_u32 v17, 16384, v17
    s_waitcnt vmcnt(10)
    s_waitcnt lgkmcnt(0)
    v_mfma_f32_32x32x16_bf16 v[64:79], v[152:155], a[220:223], v[64:79]
    s_barrier
    ds_read_b128 a[224:227], v14
    ds_read_b64_tr_b16 v[128:129], v22 offset:49152
    ds_read_b64_tr_b16 v[130:131], v22 offset:49664
    ds_read_b64_tr_b16 v[132:133], v23 offset:49152
    ds_read_b64_tr_b16 v[134:135], v23 offset:49664
    v_mfma_f32_32x32x16_bf16 v[80:95], v[156:159], a[220:223], v[80:95]
    ds_read_b128 a[228:231], v15
    ds_read_b64_tr_b16 v[136:137], v22 offset:51200
    ds_read_b64_tr_b16 v[138:139], v22 offset:51712
    ds_read_b64_tr_b16 v[140:141], v23 offset:51200
    ds_read_b64_tr_b16 v[142:143], v23 offset:51712
    ds_read_b128 a[232:235], v16
    s_waitcnt lgkmcnt(8)
    v_mfma_f32_32x32x16_bf16 v[64:79], v[128:131], a[224:227], v[64:79]
    ds_read_b64_tr_b16 v[144:145], v22 offset:53248
    ds_read_b64_tr_b16 v[146:147], v22 offset:53760
    ds_read_b64_tr_b16 v[148:149], v23 offset:53248
    ds_read_b64_tr_b16 v[150:151], v23 offset:53760
    ds_read_b128 a[236:239], v17
    ds_read_b64_tr_b16 v[152:153], v22 offset:55296
    s_waitcnt lgkmcnt(12)
    v_mfma_f32_32x32x16_bf16 v[80:95], v[132:135], a[224:227], v[80:95]
    ds_read_b64_tr_b16 v[154:155], v22 offset:55808
    ds_read_b64_tr_b16 v[156:157], v23 offset:55296
    ds_read_b64_tr_b16 v[158:159], v23 offset:55808
    s_add_u32 s12, s15, 6
    s_and_b32 s12, s12, 7
    s_mul_i32 s12, s12, s80
    s_waitcnt lgkmcnt(12)
    v_mfma_f32_32x32x16_bf16 v[64:79], v[136:139], a[228:231], v[64:79]
    s_add_u32 s12, s12, s73
    s_add_u32 m0, s72, 147456
    s_nop 0
    buffer_load_dwordx4 v12, s[44:47], s12 offen lds
    buffer_load_dwordx4 v13, s[44:47], s12 offen offset:1024 lds
    s_add_u32 s12, s15, 7
    s_and_b32 s12, s12, 7
    s_waitcnt lgkmcnt(10)
    v_mfma_f32_32x32x16_bf16 v[80:95], v[140:143], a[228:231], v[80:95]
    s_mul_i32 s12, s12, s80
    s_add_u32 s12, s12, s73
    s_add_u32 m0, s72, 155648
    s_nop 0
    buffer_load_dwordx4 v12, s[44:47], s12 offen lds
    buffer_load_dwordx4 v13, s[44:47], s12 offen offset:1024 lds
    v_add_u32 v14, 16384, v14
    s_waitcnt lgkmcnt(7)
    v_mfma_f32_32x32x16_bf16 v[64:79], v[144:147], a[232:235], v[64:79]
    v_add_u32 v15, 16384, v15
    v_add_u32 v16, 16384, v16
    v_add_u32 v17, 16384, v17
    s_waitcnt vmcnt(8)
    s_waitcnt lgkmcnt(0)
    s_barrier
    ds_read_b128 a[240:243], v14
    v_mfma_f32_32x32x16_bf16 v[80:95], v[148:151], a[232:235], v[80:95]
    ds_read_b64_tr_b16 v[128:129], v22 offset:57344
    ds_read_b64_tr_b16 v[130:131], v22 offset:57856
    ds_read_b64_tr_b16 v[132:133], v23 offset:57344
    ds_read_b64_tr_b16 v[134:135], v23 offset:57856
    ds_read_b128 a[244:247], v15
    ds_read_b64_tr_b16 v[136:137], v22 offset:59392
    v_mfma_f32_32x32x16_bf16 v[64:79], v[152:155], a[236:239], v[64:79]
    ds_read_b64_tr_b16 v[138:139], v22 offset:59904
    ds_read_b64_tr_b16 v[140:141], v23 offset:59392
    ds_read_b64_tr_b16 v[142:143], v23 offset:59904
    ds_read_b128 a[248:251], v16
    ds_read_b64_tr_b16 v[144:145], v22 offset:61440
    ds_read_b64_tr_b16 v[146:147], v22 offset:61952
    v_mfma_f32_32x32x16_bf16 v[80:95], v[156:159], a[236:239], v[80:95]
    ds_read_b64_tr_b16 v[148:149], v23 offset:61440
    ds_read_b64_tr_b16 v[150:151], v23 offset:61952
    ds_read_b128 a[252:255], v17
    ds_read_b64_tr_b16 v[152:153], v22 offset:63488
    ds_read_b64_tr_b16 v[154:155], v22 offset:64000
    ds_read_b64_tr_b16 v[156:157], v23 offset:63488
    s_waitcnt lgkmcnt(14)
    v_mfma_f32_32x32x16_bf16 v[64:79], v[128:131], a[240:243], v[64:79]
    ds_read_b64_tr_b16 v[158:159], v23 offset:64000
    v_mfma_f32_32x32x16_bf16 v[80:95], v[132:135], a[240:243], v[80:95]
    s_waitcnt lgkmcnt(12)
    v_mfma_f32_32x32x16_bf16 v[64:79], v[136:139], a[244:247], v[64:79]
    s_waitcnt lgkmcnt(10)
    v_mfma_f32_32x32x16_bf16 v[80:95], v[140:143], a[244:247], v[80:95]
    s_waitcnt lgkmcnt(7)
    v_mfma_f32_32x32x16_bf16 v[64:79], v[144:147], a[248:251], v[64:79]
    s_waitcnt lgkmcnt(5)
    v_mfma_f32_32x32x16_bf16 v[80:95], v[148:151], a[248:251], v[80:95]
    s_waitcnt lgkmcnt(2)
    v_mfma_f32_32x32x16_bf16 v[64:79], v[152:155], a[252:255], v[64:79]
    s_waitcnt lgkmcnt(0)
    v_mfma_f32_32x32x16_bf16 v[80:95], v[156:159], a[252:255], v[80:95]
    s_waitcnt lgkmcnt(0)
    s_barrier
    s_cmp_lt_u32 s58, 8
    s_cbranch_scc1 L_roleA
    s_cmp_lt_u32 s58, 11
    s_cbranch_scc1 L_roleB
    s_cmp_lt_u32 s58, 14
    s_cbranch_scc1 L_roleC
    s_branch L_roleD
L_roleA:
L_pad_roleA_0:
    s_cbranch_execz L_pad_roleA_1
    v_lshrrev_b32 v1, 3, v0
    v_lshlrev_b32 v1, 12, v1
    v_and_b32 v2, 7, v0
    v_lshl_add_u32 v44, v2, 7, v1
    v_lshlrev_b32 v46, 10, v0
    v_mov_b32 v47, v46
    v_mov_b32 v1, 0x40000000
    v_cmp_lt_u32 vcc, 21, v0
    s_nop 1
    v_cndmask_b32 v46, v46, v1, vcc
    v_cmp_lt_u32 vcc, 15, v0
    s_nop 1
    v_cndmask_b32 v47, v47, v1, vcc
    s_mov_b32 s8, s30
    s_mov_b32 s9, s31
    s_mov_b32 s10, 0xac000
    s_mov_b32 s11, 0x20000
    s_mov_b32 s40, s20
    s_mov_b32 s41, s21
    s_mov_b32 s42, 0x80000
    s_mov_b32 s43, 0x20000
    v_pk_mul_f32 v[160:161], v[64:65], v[64:65]
    v_pk_mul_f32 v[162:163], v[66:67], v[66:67]
    v_pk_mul_f32 v[164:165], v[68:69], v[68:69]
    v_pk_mul_f32 v[166:167], v[70:71], v[70:71]
    v_pk_fma_f32 v[160:161], v[160:161], s[62:63], v[38:39]
    v_pk_fma_f32 v[162:163], v[162:163], s[62:63], v[38:39]
    v_pk_fma_f32 v[164:165], v[164:165], s[62:63], v[38:39]
    v_pk_fma_f32 v[166:167], v[166:167], s[62:63], v[38:39]
    v_pk_mul_f32 v[160:161], v[160:161], v[64:65]
    v_pk_mul_f32 v[162:163], v[162:163], v[66:67]
    v_pk_mul_f32 v[164:165], v[164:165], v[68:69]
    v_pk_mul_f32 v[166:167], v[166:167], v[70:71]
    v_exp_f32 v160, v160
    v_exp_f32 v161, v161
    s_add_u32 s12, s15, 0
    s_and_b32 s12, s12, 7
    s_mul_i32 s12, s12, s80
    s_add_u32 s12, s12, s73
    s_add_u32 m0, s72, 98304
    s_nop 0
    buffer_load_dwordx4 v12, s[44:47], s12 offen lds
    v_exp_f32 v162, v162
    v_exp_f32 v163, v163
    v_exp_f32 v164, v164
    v_exp_f32 v165, v165
    v_exp_f32 v166, v166
    v_exp_f32 v167, v167
    v_pk_add_f32 v[160:161], v[160:161], s[84:85]
    v_pk_add_f32 v[162:163], v[162:163], s[84:85]
    v_pk_add_f32 v[164:165], v[164:165], s[84:85]
    v_pk_add_f32 v[166:167], v[166:167], s[84:85]
    v_rcp_f32 v160, v160
    v_rcp_f32 v161, v161
    v_rcp_f32 v162, v162
    v_rcp_f32 v163, v163
    buffer_load_dwordx4 v13, s[44:47], s12 offen offset:1024 lds
    v_rcp_f32 v164, v164
    v_rcp_f32 v165, v165
    v_rcp_f32 v166, v166
    v_rcp_f32 v167, v167
    v_pk_mul_f32 v[64:65], v[64:65], v[160:161]
    v_pk_mul_f32 v[66:67], v[66:67], v[162:163]
    v_pk_mul_f32 v[68:69], v[68:69], v[164:165]
    v_pk_mul_f32 v[70:71], v[70:71], v[166:167]
    v_pk_mul_f32 v[160:161], v[72:73], v[72:73]
    v_pk_mul_f32 v[162:163], v[74:75], v[74:75]
    v_pk_mul_f32 v[164:165], v[76:77], v[76:77]
    v_pk_mul_f32 v[166:167], v[78:79], v[78:79]
    v_pk_fma_f32 v[160:161], v[160:161], s[62:63], v[38:39]
    v_pk_fma_f32 v[162:163], v[162:163], s[62:63], v[38:39]
    s_add_u32 s12, s15, 1
    s_and_b32 s12, s12, 7
    s_mul_i32 s12, s12, s80
    s_add_u32 s12, s12, s73
    s_add_u32 m0, s72, 106496
    s_nop 0
    buffer_load_dwordx4 v12, s[44:47], s12 offen lds
    v_pk_fma_f32 v[164:165], v[164:165], s[62:63], v[38:39]
    v_pk_fma_f32 v[166:167], v[166:167], s[62:63], v[38:39]
    v_pk_mul_f32 v[160:161], v[160:161], v[72:73]
    v_pk_mul_f32 v[162:163], v[162:163], v[74:75]
    v_pk_mul_f32 v[164:165], v[164:165], v[76:77]
    v_pk_mul_f32 v[166:167], v[166:167], v[78:79]
    v_exp_f32 v160, v160
    v_exp_f32 v161, v161
    v_exp_f32 v162, v162
    v_exp_f32 v163, v163
    v_exp_f32 v164, v164
    v_exp_f32 v165, v165
    v_exp_f32 v166, v166
    v_exp_f32 v167, v167
    buffer_load_dwordx4 v13, s[44:47], s12 offen offset:1024 lds
    v_pk_add_f32 v[160:161], v[160:161], s[84:85]
    v_pk_add_f32 v[162:163], v[162:163], s[84:85]
    v_pk_add_f32 v[164:165], v[164:165], s[84:85]
    v_pk_add_f32 v[166:167], v[166:167], s[84:85]
    v_rcp_f32 v160, v160
    v_rcp_f32 v161, v161
    v_rcp_f32 v162, v162
    v_rcp_f32 v163, v163
    v_rcp_f32 v164, v164
    v_rcp_f32 v165, v165
    v_rcp_f32 v166, v166
    v_rcp_f32 v167, v167
    v_pk_mul_f32 v[72:73], v[72:73], v[160:161]
    v_pk_mul_f32 v[74:75], v[74:75], v[162:163]
    s_add_u32 s12, s15, 2
    s_and_b32 s12, s12, 7
    s_mul_i32 s12, s12, s80
    s_add_u32 s12, s12, s73
    s_add_u32 m0, s72, 114688
    s_nop 0
    buffer_load_dwordx4 v12, s[44:47], s12 offen lds
    v_pk_mul_f32 v[76:77], v[76:77], v[164:165]
    v_pk_mul_f32 v[78:79], v[78:79], v[166:167]
    v_pk_mul_f32 v[160:161], v[80:81], v[80:81]
    v_pk_mul_f32 v[162:163], v[82:83], v[82:83]
    v_pk_mul_f32 v[164:165], v[84:85], v[84:85]
    v_pk_mul_f32 v[166:167], v[86:87], v[86:87]
    v_pk_fma_f32 v[160:161], v[160:161], s[62:63], v[38:39]
    v_pk_fma_f32 v[162:163], v[162:163], s[62:63], v[38:39]
    v_pk_fma_f32 v[164:165], v[164:165], s[62:63], v[38:39]
    v_pk_fma_f32 v[166:167], v[166:167], s[62:63], v[38:39]
    v_pk_mul_f32 v[160:161], v[160:161], v[80:81]
    v_pk_mul_f32 v[162:163], v[162:163], v[82:83]
    v_pk_mul_f32 v[164:165], v[164:165], v[84:85]
    v_pk_mul_f32 v[166:167], v[166:167], v[86:87]
    buffer_load_dwordx4 v13, s[44:47], s12 offen offset:1024 lds
    v_exp_f32 v160, v160
    v_exp_f32 v161, v161
    v_exp_f32 v162, v162
    v_exp_f32 v163, v163
    v_exp_f32 v164, v164
    v_exp_f32 v165, v165
    v_exp_f32 v166, v166
    v_exp_f32 v167, v167
    v_pk_add_f32 v[160:161], v[160:161], s[84:85]
    v_pk_add_f32 v[162:163], v[162:163], s[84:85]
    v_pk_add_f32 v[164:165], v[164:165], s[84:85]
    v_pk_add_f32 v[166:167], v[166:167], s[84:85]
    v_rcp_f32 v160, v160
    v_rcp_f32 v161, v161
    s_add_u32 s12, s15, 3
    s_and_b32 s12, s12, 7
    s_mul_i32 s12, s12, s80
    s_add_u32 s12, s12, s73
    s_add_u32 m0, s72, 122880
    s_nop 0
    buffer_load_dwordx4 v12, s[44:47], s12 offen lds
    v_rcp_f32 v162, v162
L_pad_roleA_1:
    s_cbranch_execz L_hopret
    v_rcp_f32 v163, v163
    v_rcp_f32 v164, v164
    v_rcp_f32 v165, v165
    v_rcp_f32 v166, v166
    v_rcp_f32 v167, v167
    v_pk_mul_f32 v[80:81], v[80:81], v[160:161]
    v_pk_mul_f32 v[82:83], v[82:83], v[162:163]
    v_pk_mul_f32 v[84:85], v[84:85], v[164:165]
    v_pk_mul_f32 v[86:87], v[86:87], v[166:167]
    v_pk_mul_f32 v[160:161], v[88:89], v[88:89]
    v_pk_mul_f32 v[162:163], v[90:91], v[90:91]
    v_pk_mul_f32 v[164:165], v[92:93], v[92:93]
    v_pk_mul_f32 v[166:167], v[94:95], v[94:95]
    buffer_load_dwordx4 v13, s[44:47], s12 offen offset:1024 lds
    v_pk_fma_f32 v[160:161], v[160:161], s[62:63], v[38:39]
    v_pk_fma_f32 v[162:163], v[162:163], s[62:63], v[38:39]
    v_pk_fma_f32 v[164:165], v[164:165], s[62:63], v[38:39]
    v_pk_fma_f32 v[166:167], v[166:167], s[62:63], v[38:39]
    v_pk_mul_f32 v[160:161], v[160:161], v[88:89]
    v_pk_mul_f32 v[162:163], v[162:163], v[90:91]
    v_pk_mul_f32 v[164:165], v[164:165], v[92:93]
    v_pk_mul_f32 v[166:167], v[166:167], v[94:95]
    v_exp_f32 v160, v160
    v_exp_f32 v161, v161
    v_exp_f32 v162, v162
    v_exp_f32 v163, v163
    v_exp_f32 v164, v164
    v_exp_f32 v165, v165
    s_add_u32 m0, s36, 0
    s_nop 0
    buffer_load_dwordx4 v40, s[4:7], s16 offen offset:0 lds
    v_exp_f32 v166, v166
    v_exp_f32 v167, v167
    v_pk_add_f32 v[160:161], v[160:161], s[84:85]
    v_pk_add_f32 v[162:163], v[162:163], s[84:85]
    v_pk_add_f32 v[164:165], v[164:165], s[84:85]
    v_pk_add_f32 v[166:167], v[166:167], s[84:85]
    v_rcp_f32 v160, v160
    v_rcp_f32 v161, v161
    v_rcp_f32 v162, v162
    v_rcp_f32 v163, v163
    v_rcp_f32 v164, v164
    v_rcp_f32 v165, v165
    v_rcp_f32 v166, v166
    v_rcp_f32 v167, v167
    buffer_load_dwordx4 v41, s[4:7], s16 offen offset:1024 lds
    v_pk_mul_f32 v[88:89], v[88:89], v[160:161]
    v_pk_mul_f32 v[90:91], v[90:91], v[162:163]
    v_pk_mul_f32 v[92:93], v[92:93], v[164:165]
    v_pk_mul_f32 v[94:95], v[94:95], v[166:167]
    v_pk_add_f32 v[162:163], v[64:65], v[66:67]
    v_pk_mul_f32 v[164:165], v[64:65], v[64:65]
    v_pk_add_f32 v[162:163], v[162:163], v[68:69]
    v_pk_add_f32 v[162:163], v[162:163], v[70:71]
    v_pk_add_f32 v[162:163], v[162:163], v[72:73]
    v_pk_add_f32 v[162:163], v[162:163], v[74:75]
    v_pk_add_f32 v[162:163], v[162:163], v[76:77]
    v_pk_add_f32 v[162:163], v[162:163], v[78:79]
    v_pk_add_f32 v[162:163], v[162:163], v[80:81]
    v_pk_add_f32 v[162:163], v[162:163], v[82:83]
    buffer_load_dwordx4 v42, s[4:7], s16 offen offset:2048 lds
    v_pk_add_f32 v[162:163], v[162:163], v[84:85]
    v_pk_add_f32 v[162:163], v[162:163], v[86:87]
    v_pk_add_f32 v[162:163], v[162:163], v[88:89]
    v_pk_add_f32 v[162:163], v[162:163], v[90:91]
    v_pk_add_f32 v[162:163], v[162:163], v[92:93]
    v_pk_add_f32 v[162:163], v[162:163], v[94:95]
    v_pk_fma_f32 v[164:165], v[66:67], v[66:67], v[164:165]
    v_pk_fma_f32 v[164:165], v[68:69], v[68:69], v[164:165]
    v_pk_fma_f32 v[164:165], v[70:71], v[70:71], v[164:165]
    v_pk_fma_f32 v[164:165], v[72:73], v[72:73], v[164:165]
    v_pk_fma_f32 v[164:165], v[74:75], v[74:75], v[164:165]
    v_pk_fma_f32 v[164:165], v[76:77], v[76:77], v[164:165]
    v_pk_fma_f32 v[164:165], v[78:79], v[78:79], v[164:165]
    v_pk_fma_f32 v[164:165], v[80:81], v[80:81], v[164:165]
    buffer_load_dwordx4 v43, s[4:7], s16 offen offset:3072 lds
    v_pk_fma_f32 v[164:165], v[82:83], v[82:83], v[164:165]
    v_pk_fma_f32 v[164:165], v[84:85], v[84:85], v[164:165]
    v_pk_fma_f32 v[164:165], v[86:87], v[86:87], v[164:165]
    v_pk_fma_f32 v[164:165], v[88:89], v[88:89], v[164:165]
    v_pk_fma_f32 v[164:165], v[90:91], v[90:91], v[164:165]
    v_pk_fma_f32 v[164:165], v[92:93], v[92:93], v[164:165]
    v_pk_fma_f32 v[164:165], v[94:95], v[94:95], v[164:165]
    v_mov_b32 v28, v162
    v_mov_b32 v160, v163
    v_mov_b32 v29, v164
    v_mov_b32 v161, v165
    v_add_f32 v28, v28, v160
    v_add_f32 v29, v29, v161
    s_nop 1
    v_permlane32_swap_b32 v28, v29
    v_add_f32 v28, v28, v29
    v_mov_b32 v29, s61
    s_mul_i32 s64, s79, 5632
    s_lshl_b32 s65, s58, 9
    s_add_u32 s64, s64, s65
    s_add_u32 s64, s64, 524288
    buffer_store_dwordx2 v[28:29], v25, s[48:51], s64 offen sc1
    s_waitcnt vmcnt(5)
    s_barrier
    v_add_u32 v22, 98304, v22
    v_add_u32 v23, 98304, v23
    s_add_u32 s12, s16, 131072
    s_add_u32 m0, s36, 4096
    s_nop 0
    buffer_load_dwordx4 v40, s[4:7], s12 offen offset:0 lds
    buffer_load_dwordx4 v41, s[4:7], s12 offen offset:1024 lds
    buffer_load_dwordx4 v42, s[4:7], s12 offen offset:2048 lds
    buffer_load_dwordx4 v43, s[4:7], s12 offen offset:3072 lds
    ds_read_b64_tr_b16 v[128:129], v22 offset:0
    ds_read_b64_tr_b16 v[130:131], v22 offset:512
    ds_read_b64_tr_b16 v[132:133], v23 offset:0
    ds_read_b64_tr_b16 v[134:135], v23 offset:512
    ds_read_b64_tr_b16 v[136:137], v22 offset:2048
    s_waitcnt lgkmcnt(3)
    v_mfma_f32_32x32x16_bf16 v[96:111], a[128:131], v[128:131], 0
    ds_read_b64_tr_b16 v[138:139], v22 offset:2560
    ds_read_b64_tr_b16 v[140:141], v23 offset:2048
    ds_read_b64_tr_b16 v[142:143], v23 offset:2560
    ds_read_b64_tr_b16 v[144:145], v22 offset:4096
    ds_read_b64_tr_b16 v[146:147], v22 offset:4608
    s_waitcnt lgkmcnt(6)
    v_mfma_f32_32x32x16_bf16 v[112:127], a[128:131], v[132:135], 0
    ds_read_b64_tr_b16 v[148:149], v23 offset:4096
    ds_read_b64_tr_b16 v[150:151], v23 offset:4608
    s_cmp_eq_u32 s94, 0
    s_mov_b32 s74, 2752
    s_cmov_b32 s74, 3072
    s_waitcnt lgkmcnt(6)
    v_mfma_f32_32x32x16_bf16 v[96:111], a[132:135], v[136:139], v[96:111]
    s_mov_b32 s75, s92
    s_mov_b32 s76, s93
    s_cmp_eq_u32 s94, 0
    s_cselect_b32 s44, s18, s24
    s_cselect_b32 s45, s19, s25
    s_waitcnt lgkmcnt(4)
    v_mfma_f32_32x32x16_bf16 v[112:127], a[132:135], v[140:143], v[112:127]
    s_mov_b32 s46, 0x158000
    s_cmov_b32 s46, 0x180000
    s_mov_b32 s47, 0x20000
    v_bfe_u32 v1, v0, 2, 1
    v_bfe_u32 v2, v0, 4, 1
    s_waitcnt lgkmcnt(2)
    v_mfma_f32_32x32x16_bf16 v[96:111], a[136:139], v[144:147], v[96:111]
    v_xor_b32 v1, v1, v2
    v_and_b32 v2, 3, v0
    v_lshlrev_b32 v2, 4, v2
    v_lshl_add_u32 v1, v1, 6, v2
    v_lshrrev_b32 v2, 3, v0
    s_waitcnt lgkmcnt(0)
    v_mfma_f32_32x32x16_bf16 v[112:127], a[136:139], v[148:151], v[112:127]
    v_mul_lo_u32 v2, v2, s74
    v_add_u32 v2, v2, v1
    v_add_u32 v12, s75, v2
    s_lshl_b32 s64, s74, 3
    s_sub_u32 s64, s64, 1024
    v_add_u32 v13, s64, v12
    v_mov_b32 v3, 0x40000000
    v_cmp_gt_u32 vcc, s76, v1
    s_nop 1
    v_cndmask_b32 v12, v12, v3, vcc
    v_cndmask_b32 v13, v13, v3, vcc
    s_lshl_b32 s80, s74, 6
    s_lshl_b32 s64, s74, 4
    s_mul_i32 s73, s64, s56
    s_add_u32 s12, s15, 0
    s_and_b32 s12, s12, 7
    s_mul_i32 s12, s12, s80
    s_add_u32 s12, s12, s73
    s_add_u32 m0, s72, 0
    s_nop 0
    buffer_load_dwordx4 v12, s[44:47], s12 offen lds
    ds_read_b64_tr_b16 v[152:153], v22 offset:6144
    ds_read_b64_tr_b16 v[154:155], v22 offset:6656
    s_waitcnt lgkmcnt(0)
    v_mfma_f32_32x32x16_bf16 v[96:111], a[140:143], v[152:155], v[96:111]
    ds_read_b64_tr_b16 v[156:157], v23 offset:6144
    ds_read_b64_tr_b16 v[158:159], v23 offset:6656
    buffer_load_dwordx4 v13, s[44:47], s12 offen offset:1024 lds
    ds_read_b64_tr_b16 v[128:129], v22 offset:8192
    ds_read_b64_tr_b16 v[130:131], v22 offset:8704
    s_waitcnt lgkmcnt(2)
    v_mfma_f32_32x32x16_bf16 v[112:127], a[140:143], v[156:159], v[112:127]
    ds_read_b64_tr_b16 v[132:133], v23 offset:8192
    ds_read_b64_tr_b16 v[134:135], v23 offset:8704
    s_add_u32 s12, s15, 1
    s_and_b32 s12, s12, 7
    s_mul_i32 s12, s12, s80
    s_waitcnt lgkmcnt(2)
    v_mfma_f32_32x32x16_bf16 v[96:111], a[144:147], v[128:131], v[96:111]
    s_add_u32 s12, s12, s73
    s_add_u32 m0, s72, 8192
    s_nop 0
    buffer_load_dwordx4 v12, s[44:47], s12 offen lds
    ds_read_b64_tr_b16 v[136:137], v22 offset:10240
    ds_read_b64_tr_b16 v[138:139], v22 offset:10752
    s_waitcnt lgkmcnt(2)
    v_mfma_f32_32x32x16_bf16 v[112:127], a[144:147], v[132:135], v[112:127]
    ds_read_b64_tr_b16 v[140:141], v23 offset:10240
    ds_read_b64_tr_b16 v[142:143], v23 offset:10752
    buffer_load_dwordx4 v13, s[44:47], s12 offen offset:1024 lds
    ds_read_b64_tr_b16 v[144:145], v22 offset:12288
    ds_read_b64_tr_b16 v[146:147], v22 offset:12800
    s_waitcnt lgkmcnt(4)
    v_mfma_f32_32x32x16_bf16 v[96:111], a[148:151], v[136:139], v[96:111]
    ds_read_b64_tr_b16 v[148:149], v23 offset:12288
    ds_read_b64_tr_b16 v[150:151], v23 offset:12800
    s_add_u32 s12, s15, 2
    s_and_b32 s12, s12, 7
    s_mul_i32 s12, s12, s80
    s_waitcnt lgkmcnt(4)
    v_mfma_f32_32x32x16_bf16 v[112:127], a[148:151], v[140:143], v[112:127]
    s_add_u32 s12, s12, s73
    s_add_u32 m0, s72, 16384
    s_nop 0
    buffer_load_dwordx4 v12, s[44:47], s12 offen lds
    ds_read_b64_tr_b16 v[152:153], v22 offset:14336
    ds_read_b64_tr_b16 v[154:155], v22 offset:14848
    s_waitcnt lgkmcnt(4)
    v_mfma_f32_32x32x16_bf16 v[96:111], a[152:155], v[144:147], v[96:111]
    ds_read_b64_tr_b16 v[156:157], v23 offset:14336
    ds_read_b64_tr_b16 v[158:159], v23 offset:14848
    buffer_load_dwordx4 v13, s[44:47], s12 offen offset:1024 lds
    ds_read_b64_tr_b16 v[128:129], v22 offset:16384
    ds_read_b64_tr_b16 v[130:131], v22 offset:16896
    s_waitcnt lgkmcnt(6)
    v_mfma_f32_32x32x16_bf16 v[112:127], a[152:155], v[148:151], v[112:127]
    ds_read_b64_tr_b16 v[132:133], v23 offset:16384
    ds_read_b64_tr_b16 v[134:135], v23 offset:16896
    s_add_u32 s12, s15, 3
    s_and_b32 s12, s12, 7
    s_mul_i32 s12, s12, s80
    s_waitcnt lgkmcnt(6)
    v_mfma_f32_32x32x16_bf16 v[96:111], a[156:159], v[152:155], v[96:111]
    s_add_u32 s12, s12, s73
    s_add_u32 m0, s72, 24576
    s_nop 0
    buffer_load_dwordx4 v12, s[44:47], s12 offen lds
    ds_read_b64_tr_b16 v[136:137], v22 offset:18432
    ds_read_b64_tr_b16 v[138:139], v22 offset:18944
    s_waitcnt lgkmcnt(6)
    v_mfma_f32_32x32x16_bf16 v[112:127], a[156:159], v[156:159], v[112:127]
    ds_read_b64_tr_b16 v[140:141], v23 offset:18432
    ds_read_b64_tr_b16 v[142:143], v23 offset:18944
    buffer_load_dwordx4 v13, s[44:47], s12 offen offset:1024 lds
    ds_read_b64_tr_b16 v[144:145], v22 offset:20480
    ds_read_b64_tr_b16 v[146:147], v22 offset:20992
    s_waitcnt lgkmcnt(8)
    v_mfma_f32_32x32x16_bf16 v[96:111], a[160:163], v[128:131], v[96:111]
    ds_read_b64_tr_b16 v[148:149], v23 offset:20480
    ds_read_b64_tr_b16 v[150:151], v23 offset:20992
    s_add_u32 s12, s15, 4
    s_and_b32 s12, s12, 7
    s_mul_i32 s12, s12, s80
    s_waitcnt lgkmcnt(8)
    v_mfma_f32_32x32x16_bf16 v[112:127], a[160:163], v[132:135], v[112:127]
    s_add_u32 s12, s12, s73
    s_add_u32 m0, s72, 32768
    s_nop 0
    buffer_load_dwordx4 v12, s[44:47], s12 offen lds
    ds_read_b64_tr_b16 v[152:153], v22 offset:22528
    ds_read_b64_tr_b16 v[154:155], v22 offset:23040
    s_waitcnt lgkmcnt(8)
    v_mfma_f32_32x32x16_bf16 v[96:111], a[164:167], v[136:139], v[96:111]
    ds_read_b64_tr_b16 v[156:157], v23 offset:22528
    ds_read_b64_tr_b16 v[158:159], v23 offset:23040
    buffer_load_dwordx4 v13, s[44:47], s12 offen offset:1024 lds
    ds_read_b64_tr_b16 v[128:129], v22 offset:24576
    ds_read_b64_tr_b16 v[130:131], v22 offset:25088
    s_waitcnt lgkmcnt(10)
    v_mfma_f32_32x32x16_bf16 v[112:127], a[164:167], v[140:143], v[112:127]
    ds_read_b64_tr_b16 v[132:133], v23 offset:24576
    ds_read_b64_tr_b16 v[134:135], v23 offset:25088
    s_add_u32 s12, s15, 5
    s_and_b32 s12, s12, 7
    s_mul_i32 s12, s12, s80
    s_waitcnt lgkmcnt(10)
    v_mfma_f32_32x32x16_bf16 v[96:111], a[168:171], v[144:147], v[96:111]
    s_add_u32 s12, s12, s73
    s_add_u32 m0, s72, 40960
    s_nop 0
    buffer_load_dwordx4 v12, s[44:47], s12 offen lds
    ds_read_b64_tr_b16 v[136:137], v22 offset:26624
    ds_read_b64_tr_b16 v[138:139], v22 offset:27136
    s_waitcnt lgkmcnt(10)
    v_mfma_f32_32x32x16_bf16 v[112:127], a[168:171], v[148:151], v[112:127]
    ds_read_b64_tr_b16 v[140:141], v23 offset:26624
    ds_read_b64_tr_b16 v[142:143], v23 offset:27136
    buffer_load_dwordx4 v13, s[44:47], s12 offen offset:1024 lds
    ds_read_b64_tr_b16 v[144:145], v22 offset:28672
    ds_read_b64_tr_b16 v[146:147], v22 offset:29184
    s_waitcnt lgkmcnt(12)
    v_mfma_f32_32x32x16_bf16 v[96:111], a[172:175], v[152:155], v[96:111]
    ds_read_b64_tr_b16 v[148:149], v23 offset:28672
    ds_read_b64_tr_b16 v[150:151], v23 offset:29184
    s_waitcnt lgkmcnt(12)
    v_mfma_f32_32x32x16_bf16 v[112:127], a[172:175], v[156:159], v[112:127]
    s_add_u32 s12, s15, 6
    s_and_b32 s12, s12, 7
    s_mul_i32 s12, s12, s80
    s_add_u32 s12, s12, s73
    s_add_u32 m0, s72, 49152
    s_waitcnt lgkmcnt(10)
    v_mfma_f32_32x32x16_bf16 v[96:111], a[176:179], v[128:131], v[96:111]
    buffer_load_dwordx4 v12, s[44:47], s12 offen lds
    ds_read_b64_tr_b16 v[152:153], v22 offset:30720
    ds_read_b64_tr_b16 v[154:155], v22 offset:31232
    ds_read_b64_tr_b16 v[156:157], v23 offset:30720
    ds_read_b64_tr_b16 v[158:159], v23 offset:31232
    s_waitcnt lgkmcnt(12)
    v_mfma_f32_32x32x16_bf16 v[112:127], a[176:179], v[132:135], v[112:127]
    buffer_load_dwordx4 v13, s[44:47], s12 offen offset:1024 lds
    ds_read_b64_tr_b16 v[128:129], v22 offset:32768
    ds_read_b64_tr_b16 v[130:131], v22 offset:33280
    ds_read_b64_tr_b16 v[132:133], v23 offset:32768
    ds_read_b64_tr_b16 v[134:135], v23 offset:33280
    s_waitcnt lgkmcnt(14)
    v_mfma_f32_32x32x16_bf16 v[96:111], a[180:183], v[136:139], v[96:111]
    s_waitcnt lgkmcnt(12)
    v_mfma_f32_32x32x16_bf16 v[112:127], a[180:183], v[140:143], v[112:127]
    s_add_u32 s12, s15, 7
    s_and_b32 s12, s12, 7
    s_mul_i32 s12, s12, s80
    s_add_u32 s12, s12, s73
    s_add_u32 m0, s72, 57344
    s_waitcnt lgkmcnt(10)
    v_mfma_f32_32x32x16_bf16 v[96:111], a[184:187], v[144:147], v[96:111]
    buffer_load_dwordx4 v12, s[44:47], s12 offen lds
    ds_read_b64_tr_b16 v[136:137], v22 offset:34816
    ds_read_b64_tr_b16 v[138:139], v22 offset:35328
    ds_read_b64_tr_b16 v[140:141], v23 offset:34816
    ds_read_b64_tr_b16 v[142:143], v23 offset:35328
    s_waitcnt lgkmcnt(12)
    v_mfma_f32_32x32x16_bf16 v[112:127], a[184:187], v[148:151], v[112:127]
    buffer_load_dwordx4 v13, s[44:47], s12 offen offset:1024 lds
    ds_read_b64_tr_b16 v[144:145], v22 offset:36864
    ds_read_b64_tr_b16 v[146:147], v22 offset:37376
    ds_read_b64_tr_b16 v[148:149], v23 offset:36864
    ds_read_b64_tr_b16 v[150:151], v23 offset:37376
    s_waitcnt lgkmcnt(14)
    v_mfma_f32_32x32x16_bf16 v[96:111], a[188:191], v[152:155], v[96:111]
    s_waitcnt lgkmcnt(12)
    v_mfma_f32_32x32x16_bf16 v[112:127], a[188:191], v[156:159], v[112:127]
    ds_read_b64_tr_b16 v[152:153], v22 offset:38912
    ds_read_b64_tr_b16 v[154:155], v22 offset:39424
    ds_read_b64_tr_b16 v[156:157], v23 offset:38912
    ds_read_b64_tr_b16 v[158:159], v23 offset:39424
    s_waitcnt lgkmcnt(14)
    v_mfma_f32_32x32x16_bf16 v[96:111], a[192:195], v[128:131], v[96:111]
    s_waitcnt lgkmcnt(12)
    v_mfma_f32_32x32x16_bf16 v[112:127], a[192:195], v[132:135], v[112:127]
    ds_read_b64_tr_b16 v[128:129], v22 offset:40960
    ds_read_b64_tr_b16 v[130:131], v22 offset:41472
    ds_read_b64_tr_b16 v[132:133], v23 offset:40960
    ds_read_b64_tr_b16 v[134:135], v23 offset:41472
    s_waitcnt lgkmcnt(14)
    v_mfma_f32_32x32x16_bf16 v[96:111], a[196:199], v[136:139], v[96:111]
    s_waitcnt lgkmcnt(12)
    v_mfma_f32_32x32x16_bf16 v[112:127], a[196:199], v[140:143], v[112:127]
    ds_read_b64_tr_b16 v[136:137], v22 offset:43008
    ds_read_b64_tr_b16 v[138:139], v22 offset:43520
    ds_read_b64_tr_b16 v[140:141], v23 offset:43008
    ds_read_b64_tr_b16 v[142:143], v23 offset:43520
    s_waitcnt lgkmcnt(14)
    v_mfma_f32_32x32x16_bf16 v[96:111], a[200:203], v[144:147], v[96:111]
    s_waitcnt lgkmcnt(12)
    v_mfma_f32_32x32x16_bf16 v[112:127], a[200:203], v[148:151], v[112:127]
    ds_read_b64_tr_b16 v[144:145], v22 offset:45056
    ds_read_b64_tr_b16 v[146:147], v22 offset:45568
    ds_read_b64_tr_b16 v[148:149], v23 offset:45056
    ds_read_b64_tr_b16 v[150:151], v23 offset:45568
    s_waitcnt lgkmcnt(14)
    v_mfma_f32_32x32x16_bf16 v[96:111], a[204:207], v[152:155], v[96:111]
    s_waitcnt lgkmcnt(12)
    v_mfma_f32_32x32x16_bf16 v[112:127], a[204:207], v[156:159], v[112:127]
    ds_read_b64_tr_b16 v[152:153], v22 offset:47104
    ds_read_b64_tr_b16 v[154:155], v22 offset:47616
    ds_read_b64_tr_b16 v[156:157], v23 offset:47104
    ds_read_b64_tr_b16 v[158:159], v23 offset:47616
    s_waitcnt lgkmcnt(14)
    v_mfma_f32_32x32x16_bf16 v[96:111], a[208:211], v[128:131], v[96:111]
    s_waitcnt lgkmcnt(12)
    v_mfma_f32_32x32x16_bf16 v[112:127], a[208:211], v[132:135], v[112:127]
    ds_read_b64_tr_b16 v[128:129], v22 offset:49152
    ds_read_b64_tr_b16 v[130:131], v22 offset:49664
    ds_read_b64_tr_b16 v[132:133], v23 offset:49152
    ds_read_b64_tr_b16 v[134:135], v23 offset:49664
    s_waitcnt lgkmcnt(14)
    v_mfma_f32_32x32x16_bf16 v[96:111], a[212:215], v[136:139], v[96:111]
    s_waitcnt lgkmcnt(12)
    v_mfma_f32_32x32x16_bf16 v[112:127], a[212:215], v[140:143], v[112:127]
    ds_read_b64_tr_b16 v[136:137], v22 offset:51200
    ds_read_b64_tr_b16 v[138:139], v22 offset:51712
    ds_read_b64_tr_b16 v[140:141], v23 offset:51200
    ds_read_b64_tr_b16 v[142:143], v23 offset:51712
    s_waitcnt lgkmcnt(14)
    v_mfma_f32_32x32x16_bf16 v[96:111], a[216:219], v[144:147], v[96:111]
    s_waitcnt lgkmcnt(12)
    v_mfma_f32_32x32x16_bf16 v[112:127], a[216:219], v[148:151], v[112:127]
    ds_read_b64_tr_b16 v[144:145], v22 offset:53248
    ds_read_b64_tr_b16 v[146:147], v22 offset:53760
    ds_read_b64_tr_b16 v[148:149], v23 offset:53248
    ds_read_b64_tr_b16 v[150:151], v23 offset:53760
    s_waitcnt lgkmcnt(14)
    v_mfma_f32_32x32x16_bf16 v[96:111], a[220:223], v[152:155], v[96:111]
    s_waitcnt lgkmcnt(12)
    v_mfma_f32_32x32x16_bf16 v[112:127], a[220:223], v[156:159], v[112:127]
    ds_read_b64_tr_b16 v[152:153], v22 offset:55296
    ds_read_b64_tr_b16 v[154:155], v22 offset:55808
    ds_read_b64_tr_b16 v[156:157], v23 offset:55296
    ds_read_b64_tr_b16 v[158:159], v23 offset:55808
    s_waitcnt lgkmcnt(14)
    v_mfma_f32_32x32x16_bf16 v[96:111], a[224:227], v[128:131], v[96:111]
    s_waitcnt lgkmcnt(12)
    v_mfma_f32_32x32x16_bf16 v[112:127], a[224:227], v[132:135], v[112:127]
    ds_read_b64_tr_b16 v[128:129], v22 offset:57344
    ds_read_b64_tr_b16 v[130:131], v22 offset:57856
    ds_read_b64_tr_b16 v[132:133], v23 offset:57344
    ds_read_b64_tr_b16 v[134:135], v23 offset:57856
    s_waitcnt lgkmcnt(14)
    v_mfma_f32_32x32x16_bf16 v[96:111], a[228:231], v[136:139], v[96:111]
    s_waitcnt lgkmcnt(12)
    v_mfma_f32_32x32x16_bf16 v[112:127], a[228:231], v[140:143], v[112:127]
    ds_read_b64_tr_b16 v[136:137], v22 offset:59392
    ds_read_b64_tr_b16 v[138:139], v22 offset:59904
    ds_read_b64_tr_b16 v[140:141], v23 offset:59392
    ds_read_b64_tr_b16 v[142:143], v23 offset:59904
    s_waitcnt lgkmcnt(14)
    v_mfma_f32_32x32x16_bf16 v[96:111], a[232:235], v[144:147], v[96:111]
    s_waitcnt lgkmcnt(12)
    v_mfma_f32_32x32x16_bf16 v[112:127], a[232:235], v[148:151], v[112:127]
    ds_read_b64_tr_b16 v[144:145], v22 offset:61440
    ds_read_b64_tr_b16 v[146:147], v22 offset:61952
    ds_read_b64_tr_b16 v[148:149], v23 offset:61440
    ds_read_b64_tr_b16 v[150:151], v23 offset:61952
    s_waitcnt lgkmcnt(14)
    v_mfma_f32_32x32x16_bf16 v[96:111], a[236:239], v[152:155], v[96:111]
    s_waitcnt lgkmcnt(12)
    v_mfma_f32_32x32x16_bf16 v[112:127], a[236:239], v[156:159], v[112:127]
    ds_read_b64_tr_b16 v[152:153], v22 offset:63488
    ds_read_b64_tr_b16 v[154:155], v22 offset:64000
    ds_read_b64_tr_b16 v[156:157], v23 offset:63488
    ds_read_b64_tr_b16 v[158:159], v23 offset:64000
    s_waitcnt lgkmcnt(14)
    v_mfma_f32_32x32x16_bf16 v[96:111], a[240:243], v[128:131], v[96:111]
    s_waitcnt lgkmcnt(12)
    v_mfma_f32_32x32x16_bf16 v[112:127], a[240:243], v[132:135], v[112:127]
    s_waitcnt lgkmcnt(10)
    v_mfma_f32_32x32x16_bf16 v[96:111], a[244:247], v[136:139], v[96:111]
    s_waitcnt lgkmcnt(8)
    v_mfma_f32_32x32x16_bf16 v[112:127], a[244:247], v[140:143], v[112:127]
    s_waitcnt lgkmcnt(6)
    v_mfma_f32_32x32x16_bf16 v[96:111], a[248:251], v[144:147], v[96:111]
    s_waitcnt lgkmcnt(4)
    v_mfma_f32_32x32x16_bf16 v[112:127], a[248:251], v[148:151], v[112:127]
    s_waitcnt lgkmcnt(2)
    v_mfma_f32_32x32x16_bf16 v[96:111], a[252:255], v[152:155], v[96:111]
    s_waitcnt lgkmcnt(0)
    v_mfma_f32_32x32x16_bf16 v[112:127], a[252:255], v[156:159], v[112:127]
    s_barrier
    s_mul_i32 s69, s79, 5632
    s_add_u32 s69, s69, 524288
    s_add_u32 s68, s69, 4096
    buffer_load_dwordx2 v[224:225], v25, s[48:51], s69 offen offset:0 sc1
    buffer_load_dwordx2 v[226:227], v25, s[48:51], s69 offen offset:512 sc1
    buffer_load_dwordx2 v[228:229], v25, s[48:51], s69 offen offset:1024 sc1
    buffer_load_dwordx2 v[230:231], v25, s[48:51], s69 offen offset:1536 sc1
    buffer_load_dwordx2 v[232:233], v25, s[48:51], s69 offen offset:2048 sc1
    buffer_load_dwordx2 v[234:235], v25, s[48:51], s69 offen offset:2560 sc1
    buffer_load_dwordx2 v[236:237], v25, s[48:51], s69 offen offset:3072 sc1
    buffer_load_dwordx2 v[238:239], v25, s[48:51], s69 offen offset:3584 sc1
    buffer_load_dwordx2 v[240:241], v25, s[48:51], s68 offen offset:0 sc1
    buffer_load_dwordx2 v[242:243], v25, s[48:51], s68 offen offset:512 sc1
    buffer_load_dwordx2 v[244:245], v25, s[48:51], s68 offen offset:1024 sc1
    v_pk_mul_f32 v[160:161], v[96:97], s[100:101]
    v_pk_mul_f32 v[162:163], v[98:99], s[100:101]
    v_pk_mul_f32 v[164:165], v[100:101], s[100:101]
    v_pk_mul_f32 v[166:167], v[102:103], s[100:101]
    v_exp_f32_e64 v160, v160 clamp
    v_exp_f32_e64 v161, v161 clamp
    v_exp_f32_e64 v162, v162 clamp
    v_exp_f32_e64 v163, v163 clamp
    v_exp_f32_e64 v164, v164 clamp
    v_exp_f32_e64 v165, v165 clamp
    v_exp_f32_e64 v166, v166 clamp
    v_exp_f32_e64 v167, v167 clamp
    v_max_f32 v96, s83, v96
    v_max_f32 v97, s83, v97
    v_max_f32 v98, s83, v98
    v_max_f32 v99, s83, v99
    v_max_f32 v100, s83, v100
    v_max_f32 v101, s83, v101
    v_max_f32 v102, s83, v102
    v_max_f32 v103, s83, v103
    v_pk_add_f32 v[96:97], v[96:97], v[160:161]
    v_pk_add_f32 v[98:99], v[98:99], v[162:163]
    v_pk_add_f32 v[100:101], v[100:101], v[164:165]
    v_pk_add_f32 v[102:103], v[102:103], v[166:167]
    v_cvt_pk_bf16_f32 v192, v96, v97
    v_cvt_pk_bf16_f32 v193, v98, v99
    v_cvt_pk_bf16_f32 v194, v100, v101
    v_cvt_pk_bf16_f32 v195, v102, v103
    v_pk_mul_f32 v[160:161], v[104:105], s[100:101]
    v_pk_mul_f32 v[162:163], v[106:107], s[100:101]
    v_pk_mul_f32 v[164:165], v[108:109], s[100:101]
    v_pk_mul_f32 v[166:167], v[110:111], s[100:101]
    v_exp_f32_e64 v160, v160 clamp
    v_exp_f32_e64 v161, v161 clamp
    v_exp_f32_e64 v162, v162 clamp
    v_exp_f32_e64 v163, v163 clamp
    v_exp_f32_e64 v164, v164 clamp
    v_exp_f32_e64 v165, v165 clamp
    v_exp_f32_e64 v166, v166 clamp
    v_exp_f32_e64 v167, v167 clamp
    v_max_f32 v104, s83, v104
    v_max_f32 v105, s83, v105
    v_max_f32 v106, s83, v106
    v_max_f32 v107, s83, v107
    v_max_f32 v108, s83, v108
    v_max_f32 v109, s83, v109
    v_max_f32 v110, s83, v110
    v_max_f32 v111, s83, v111
    v_pk_add_f32 v[104:105], v[104:105], v[160:161]
    v_pk_add_f32 v[106:107], v[106:107], v[162:163]
    v_pk_add_f32 v[108:109], v[108:109], v[164:165]
    v_pk_add_f32 v[110:111], v[110:111], v[166:167]
    v_cvt_pk_bf16_f32 v196, v104, v105
    v_cvt_pk_bf16_f32 v197, v106, v107
    v_cvt_pk_bf16_f32 v198, v108, v109
    v_cvt_pk_bf16_f32 v199, v110, v111
    v_pk_mul_f32 v[160:161], v[112:113], s[100:101]
    v_pk_mul_f32 v[162:163], v[114:115], s[100:101]
    v_pk_mul_f32 v[164:165], v[116:117], s[100:101]
    v_pk_mul_f32 v[166:167], v[118:119], s[100:101]
    v_exp_f32_e64 v160, v160 clamp
    v_exp_f32_e64 v161, v161 clamp
    v_exp_f32_e64 v162, v162 clamp
    v_exp_f32_e64 v163, v163 clamp
    v_exp_f32_e64 v164, v164 clamp
    v_exp_f32_e64 v165, v165 clamp
    v_exp_f32_e64 v166, v166 clamp
    v_exp_f32_e64 v167, v167 clamp
    v_max_f32 v112, s83, v112
    v_max_f32 v113, s83, v113
    v_max_f32 v114, s83, v114
    v_max_f32 v115, s83, v115
    v_max_f32 v116, s83, v116
    v_max_f32 v117, s83, v117
    v_max_f32 v118, s83, v118
    v_max_f32 v119, s83, v119
    v_pk_add_f32 v[112:113], v[112:113], v[160:161]
    v_pk_add_f32 v[114:115], v[114:115], v[162:163]
    v_pk_add_f32 v[116:117], v[116:117], v[164:165]
    v_pk_add_f32 v[118:119], v[118:119], v[166:167]
    v_cvt_pk_bf16_f32 v200, v112, v113
    v_cvt_pk_bf16_f32 v201, v114, v115
    v_cvt_pk_bf16_f32 v202, v116, v117
    v_cvt_pk_bf16_f32 v203, v118, v119
    v_pk_mul_f32 v[160:161], v[120:121], s[100:101]
    v_pk_mul_f32 v[162:163], v[122:123], s[100:101]
    v_pk_mul_f32 v[164:165], v[124:125], s[100:101]
    v_pk_mul_f32 v[166:167], v[126:127], s[100:101]
    v_exp_f32_e64 v160, v160 clamp
    v_exp_f32_e64 v161, v161 clamp
    v_exp_f32_e64 v162, v162 clamp
    v_exp_f32_e64 v163, v163 clamp
    v_exp_f32_e64 v164, v164 clamp
    v_exp_f32_e64 v165, v165 clamp
    v_exp_f32_e64 v166, v166 clamp
    v_exp_f32_e64 v167, v167 clamp
    v_max_f32 v120, s83, v120
    v_max_f32 v121, s83, v121
    v_max_f32 v122, s83, v122
    v_max_f32 v123, s83, v123
    v_max_f32 v124, s83, v124
    v_max_f32 v125, s83, v125
    v_max_f32 v126, s83, v126
    v_max_f32 v127, s83, v127
    v_pk_add_f32 v[120:121], v[120:121], v[160:161]
    v_pk_add_f32 v[122:123], v[122:123], v[162:163]
    v_pk_add_f32 v[124:125], v[124:125], v[164:165]
    v_pk_add_f32 v[126:127], v[126:127], v[166:167]
    v_cvt_pk_bf16_f32 v204, v120, v121
    v_cvt_pk_bf16_f32 v205, v122, v123
    v_cvt_pk_bf16_f32 v206, v124, v125
    v_cvt_pk_bf16_f32 v207, v126, v127
    s_waitcnt vmcnt(8)
    v_min3_u32 v160, v225, v227, v229
    v_max3_u32 v161, v225, v227, v229
    s_waitcnt vmcnt(6)
    v_min3_u32 v160, v160, v231, v233
    v_max3_u32 v161, v161, v231, v233
    s_waitcnt vmcnt(4)
    v_min3_u32 v160, v160, v235, v237
    v_max3_u32 v161, v161, v235, v237
    s_waitcnt vmcnt(2)
    v_min3_u32 v160, v160, v239, v241
    v_max3_u32 v161, v161, v239, v241
    s_waitcnt vmcnt(0)
    v_min3_u32 v160, v160, v243, v245
    v_max3_u32 v161, v161, v243, v245
    v_xor_b32 v160, s61, v160
    v_xor_b32 v161, s61, v161
    v_or_b32 v160, v160, v161
    v_cmp_ne_u32 vcc, 0, v160
    s_nop 0
    s_cbranch_vccnz ZS_2
ZC_1:
    v_add_f32 v160, v224, v226
    v_add_f32 v161, v228, v230
    v_add_f32 v160, v160, v232
    v_add_f32 v161, v161, v234
    v_add_f32 v160, v160, v236
    v_add_f32 v161, v161, v238
    v_add_f32 v160, v160, v240
    v_add_f32 v161, v161, v242
    v_add_f32 v160, v160, v244
    v_add_f32 v160, v160, v161
    v_mov_b32 v161, v160
    s_nop 1
    v_permlane32_swap_b32 v160, v161
    v_mul_f32 v160, 0x3abe82fa, v160
    v_mul_f32 v161, 0x3abe82fa, v161
L_pad_roleA_H:
L_pad_roleA_2:
    s_cbranch_execz L_pad_pg0_0
    v_fma_f32 v161, -v160, v160, v161
    v_max_f32 v161, 0, v161
    v_add_f32 v161, 0x3727c5ac, v161
    v_rsq_f32 v161, v161
    s_nop 0
    v_mul_f32 v160, v160, v161
    v_sub_f32 v160, 0, v160
    v_fma_f32 v64, v64, v161, v160
    v_fma_f32 v65, v65, v161, v160
    v_fma_f32 v66, v66, v161, v160
    v_fma_f32 v67, v67, v161, v160
    v_cvt_pk_bf16_f32 v208, v64, v65
    v_cvt_pk_bf16_f32 v209, v66, v67
    ds_write_b64 v37, v[208:209]
    v_fma_f32 v68, v68, v161, v160
    v_fma_f32 v69, v69, v161, v160
    v_fma_f32 v70, v70, v161, v160
    v_fma_f32 v71, v71, v161, v160
    v_cvt_pk_bf16_f32 v210, v68, v69
    v_cvt_pk_bf16_f32 v211, v70, v71
    v_xor_b32 v163, 16, v37
    ds_write_b64 v163, v[210:211]
    v_fma_f32 v72, v72, v161, v160
    v_fma_f32 v73, v73, v161, v160
    v_fma_f32 v74, v74, v161, v160
    v_fma_f32 v75, v75, v161, v160
    v_cvt_pk_bf16_f32 v212, v72, v73
    v_cvt_pk_bf16_f32 v213, v74, v75
    v_xor_b32 v163, 32, v37
    ds_write_b64 v163, v[212:213]
    v_fma_f32 v76, v76, v161, v160
    v_fma_f32 v77, v77, v161, v160
    v_fma_f32 v78, v78, v161, v160
    v_fma_f32 v79, v79, v161, v160
    v_cvt_pk_bf16_f32 v214, v76, v77
    v_cvt_pk_bf16_f32 v215, v78, v79
    v_xor_b32 v163, 48, v37
    ds_write_b64 v163, v[214:215]
    v_fma_f32 v80, v80, v161, v160
    v_fma_f32 v81, v81, v161, v160
    v_fma_f32 v82, v82, v161, v160
    v_fma_f32 v83, v83, v161, v160
    v_cvt_pk_bf16_f32 v216, v80, v81
    v_cvt_pk_bf16_f32 v217, v82, v83
    v_xor_b32 v163, 64, v37
    ds_write_b64 v163, v[216:217]
    v_fma_f32 v84, v84, v161, v160
    v_fma_f32 v85, v85, v161, v160
    v_fma_f32 v86, v86, v161, v160
    v_fma_f32 v87, v87, v161, v160
    v_cvt_pk_bf16_f32 v218, v84, v85
    v_cvt_pk_bf16_f32 v219, v86, v87
    v_xor_b32 v163, 80, v37
    ds_write_b64 v163, v[218:219]
    v_fma_f32 v88, v88, v161, v160
    v_fma_f32 v89, v89, v161, v160
    v_fma_f32 v90, v90, v161, v160
    v_fma_f32 v91, v91, v161, v160
    v_cvt_pk_bf16_f32 v220, v88, v89
    v_cvt_pk_bf16_f32 v221, v90, v91
    v_xor_b32 v163, 96, v37
    ds_write_b64 v163, v[220:221]
    v_fma_f32 v92, v92, v161, v160
    v_fma_f32 v93, v93, v161, v160
    v_fma_f32 v94, v94, v161, v160
    v_fma_f32 v95, v95, v161, v160
    v_cvt_pk_bf16_f32 v222, v92, v93
    v_cvt_pk_bf16_f32 v223, v94, v95
    v_xor_b32 v163, 112, v37
    ds_write_b64 v163, v[222:223]
    s_waitcnt lgkmcnt(0)
    ds_read_b64_tr_b16 v[176:177], v60 offset:0
    ds_read_b64_tr_b16 v[178:179], v61 offset:512
    ds_read_b64_tr_b16 v[180:181], v60 offset:2048
    ds_read_b64_tr_b16 v[182:183], v61 offset:2560
    ds_read_b64_tr_b16 v[184:185], v62 offset:0
    ds_read_b64_tr_b16 v[186:187], v63 offset:512
    ds_read_b64_tr_b16 v[188:189], v62 offset:2048
    ds_read_b64_tr_b16 v[190:191], v63 offset:2560
    s_lshl_b32 s64, s58, 18
    s_lshl_b32 s65, s79, 11
    s_add_u32 s64, s64, s65
    s_add_u32 s64, s64, 2097152
    s_add_u32 s65, s64, 131072
    s_waitcnt lgkmcnt(6)
    buffer_store_dwordx4 v[176:179], v24, s[48:51], s64 offen offset:0 sc1
    s_waitcnt lgkmcnt(4)
    buffer_store_dwordx4 v[180:183], v24, s[48:51], s64 offen offset:1024 sc1
    s_waitcnt lgkmcnt(2)
    buffer_store_dwordx4 v[184:187], v24, s[48:51], s65 offen offset:0 sc1
    s_waitcnt lgkmcnt(0)
    buffer_store_dwordx4 v[188:191], v24, s[48:51], s65 offen offset:1024 sc1
    s_barrier
    v_subrev_u32 v22, 98304, v22
    v_subrev_u32 v23, 98304, v23
    ds_read_b64_tr_b16 v[128:129], v22 offset:0
    ds_read_b64_tr_b16 v[130:131], v22 offset:512
    ds_read_b64_tr_b16 v[132:133], v23 offset:0
    ds_read_b64_tr_b16 v[134:135], v23 offset:512
    ds_read_b64_tr_b16 v[136:137], v22 offset:2048
    s_waitcnt lgkmcnt(3)
    v_mfma_f32_32x32x16_bf16 v[96:111], a[128:131], v[128:131], 0
    ds_read_b64_tr_b16 v[138:139], v22 offset:2560
    ds_read_b64_tr_b16 v[140:141], v23 offset:2048
    ds_read_b64_tr_b16 v[142:143], v23 offset:2560
    ds_read_b64_tr_b16 v[144:145], v22 offset:4096
    ds_read_b64_tr_b16 v[146:147], v22 offset:4608
    s_waitcnt lgkmcnt(6)
    v_mfma_f32_32x32x16_bf16 v[112:127], a[128:131], v[132:135], 0
    ds_read_b64_tr_b16 v[148:149], v23 offset:4096
    ds_read_b64_tr_b16 v[150:151], v23 offset:4608
    s_add_u32 m0, s37, 0
    s_nop 0
    buffer_load_dwordx4 v40, s[4:7], s17 offen offset:0 lds
    ds_read_b64_tr_b16 v[152:153], v22 offset:6144
    s_waitcnt lgkmcnt(7)
    v_mfma_f32_32x32x16_bf16 v[96:111], a[132:135], v[136:139], v[96:111]
    ds_read_b64_tr_b16 v[154:155], v22 offset:6656
    ds_read_b64_tr_b16 v[156:157], v23 offset:6144
    ds_read_b64_tr_b16 v[158:159], v23 offset:6656
    buffer_load_dwordx4 v41, s[4:7], s17 offen offset:1024 lds
    ds_read_b64_tr_b16 v[128:129], v22 offset:8192
    s_waitcnt lgkmcnt(9)
    v_mfma_f32_32x32x16_bf16 v[112:127], a[132:135], v[140:143], v[112:127]
    ds_read_b64_tr_b16 v[130:131], v22 offset:8704
    ds_read_b64_tr_b16 v[132:133], v23 offset:8192
    ds_read_b64_tr_b16 v[134:135], v23 offset:8704
    s_mul_i32 s70, s60, 3
    s_min_u32 s70, s70, 20
    s_waitcnt lgkmcnt(10)
    v_mfma_f32_32x32x16_bf16 v[96:111], a[136:139], v[144:147], v[96:111]
    s_cmp_lt_u32 s60, 6
    s_cselect_b32 s71, 3, 2
    s_add_u32 s66, s70, s71
    s_sub_u32 s67, s66, 1
    s_mov_b32 s64, 0
    s_waitcnt lgkmcnt(8)
    v_mfma_f32_32x32x16_bf16 v[112:127], a[136:139], v[148:151], v[112:127]
    s_add_u32 s88, s70, s64
    s_cmp_ge_u32 s88, s66
    s_cselect_b32 s65, s71, 0
    s_sub_u32 s88, s88, s65
    s_add_u32 s89, s70, s64
    s_waitcnt lgkmcnt(6)
    v_mfma_f32_32x32x16_bf16 v[96:111], a[140:143], v[152:155], v[96:111]
    s_add_u32 s89, s89, 1
    s_cmp_ge_u32 s89, s66
    s_cselect_b32 s65, s71, 0
    s_sub_u32 s89, s89, s65
    s_add_u32 s90, s70, s64
    s_waitcnt lgkmcnt(4)
    v_mfma_f32_32x32x16_bf16 v[112:127], a[140:143], v[156:159], v[112:127]
    s_add_u32 s90, s90, 2
    s_cmp_ge_u32 s90, s66
    s_cselect_b32 s65, s71, 0
    s_sub_u32 s90, s90, s65
    s_lshr_b32 s64, s70, 1
    s_waitcnt lgkmcnt(2)
    v_mfma_f32_32x32x16_bf16 v[96:111], a[144:147], v[128:131], v[96:111]
    s_lshr_b32 s65, s67, 1
    s_sub_u32 s65, s65, s64
    v_bfe_u32 v1, v0, 3, 2
    v_bfe_u32 v2, v0, 2, 1
    v_mul_u32_u24 v2, s65, v2
    s_waitcnt lgkmcnt(0)
    v_mfma_f32_32x32x16_bf16 v[112:127], a[144:147], v[132:135], v[112:127]
    v_lshl_add_u32 v1, v1, 4, v2
    s_lshl_b32 s66, s56, 6
    s_add_u32 s66, s66, s64
    v_add_u32 v1, s66, v1
    v_and_b32 v2, 3, v0
    v_lshl_add_u32 v1, v1, 2, v2
    v_and_b32 v2, 3, v1
    v_lshrrev_b32 v1, 2, v1
    v_lshlrev_b32 v1, 4, v1
    v_add_lshl_u32 v8, v1, v2, 2
    buffer_load_dwordx4 v42, s[4:7], s17 offen offset:2048 lds
    ds_read_b64_tr_b16 v[136:137], v22 offset:10240
    ds_read_b64_tr_b16 v[138:139], v22 offset:10752
    s_waitcnt lgkmcnt(0)
    v_mfma_f32_32x32x16_bf16 v[96:111], a[148:151], v[136:139], v[96:111]
    ds_read_b64_tr_b16 v[140:141], v23 offset:10240
    ds_read_b64_tr_b16 v[142:143], v23 offset:10752
    buffer_load_dwordx4 v43, s[4:7], s17 offen offset:3072 lds
    ds_read_b64_tr_b16 v[144:145], v22 offset:12288
    ds_read_b64_tr_b16 v[146:147], v22 offset:12800
    s_waitcnt lgkmcnt(2)
    v_mfma_f32_32x32x16_bf16 v[112:127], a[148:151], v[140:143], v[112:127]
    ds_read_b64_tr_b16 v[148:149], v23 offset:12288
    ds_read_b64_tr_b16 v[150:151], v23 offset:12800
    s_add_u32 s12, s17, 131072
    s_add_u32 m0, s37, 4096
    s_nop 0
    buffer_load_dwordx4 v40, s[4:7], s12 offen offset:0 lds
    s_waitcnt lgkmcnt(2)
    v_mfma_f32_32x32x16_bf16 v[96:111], a[152:155], v[144:147], v[96:111]
    ds_read_b64_tr_b16 v[152:153], v22 offset:14336
    ds_read_b64_tr_b16 v[154:155], v22 offset:14848
    ds_read_b64_tr_b16 v[156:157], v23 offset:14336
    ds_read_b64_tr_b16 v[158:159], v23 offset:14848
    buffer_load_dwordx4 v41, s[4:7], s12 offen offset:1024 lds
    s_waitcnt lgkmcnt(4)
    v_mfma_f32_32x32x16_bf16 v[112:127], a[152:155], v[148:151], v[112:127]
    ds_read_b64_tr_b16 v[128:129], v22 offset:16384
    ds_read_b64_tr_b16 v[130:131], v22 offset:16896
    ds_read_b64_tr_b16 v[132:133], v23 offset:16384
    ds_read_b64_tr_b16 v[134:135], v23 offset:16896
    buffer_load_dwordx4 v42, s[4:7], s12 offen offset:2048 lds
    s_waitcnt lgkmcnt(6)
    v_mfma_f32_32x32x16_bf16 v[96:111], a[156:159], v[152:155], v[96:111]
    ds_read_b64_tr_b16 v[136:137], v22 offset:18432
    ds_read_b64_tr_b16 v[138:139], v22 offset:18944
    ds_read_b64_tr_b16 v[140:141], v23 offset:18432
    ds_read_b64_tr_b16 v[142:143], v23 offset:18944
    buffer_load_dwordx4 v43, s[4:7], s12 offen offset:3072 lds
    s_waitcnt lgkmcnt(8)
    v_mfma_f32_32x32x16_bf16 v[112:127], a[156:159], v[156:159], v[112:127]
    ds_read_b64_tr_b16 v[144:145], v22 offset:20480
    ds_read_b64_tr_b16 v[146:147], v22 offset:20992
    ds_read_b64_tr_b16 v[148:149], v23 offset:20480
    ds_read_b64_tr_b16 v[150:151], v23 offset:20992
    s_add_u32 m0, s37, 8192
    s_waitcnt lgkmcnt(10)
    v_mfma_f32_32x32x16_bf16 v[96:111], a[160:163], v[128:131], v[96:111]
    buffer_load_dwordx4 v40, s[4:7], s22 offen offset:0 lds
    ds_read_b64_tr_b16 v[152:153], v22 offset:22528
    ds_read_b64_tr_b16 v[154:155], v22 offset:23040
    ds_read_b64_tr_b16 v[156:157], v23 offset:22528
    ds_read_b64_tr_b16 v[158:159], v23 offset:23040
    s_waitcnt lgkmcnt(12)
    v_mfma_f32_32x32x16_bf16 v[112:127], a[160:163], v[132:135], v[112:127]
    buffer_load_dwordx4 v41, s[4:7], s22 offen offset:1024 lds
    ds_read_b64_tr_b16 v[128:129], v22 offset:24576
    ds_read_b64_tr_b16 v[130:131], v22 offset:25088
    ds_read_b64_tr_b16 v[132:133], v23 offset:24576
    ds_read_b64_tr_b16 v[134:135], v23 offset:25088
    s_waitcnt lgkmcnt(14)
    v_mfma_f32_32x32x16_bf16 v[96:111], a[164:167], v[136:139], v[96:111]
    s_waitcnt lgkmcnt(12)
    v_mfma_f32_32x32x16_bf16 v[112:127], a[164:167], v[140:143], v[112:127]
    buffer_load_dwordx4 v42, s[4:7], s22 offen offset:2048 lds
    ds_read_b64_tr_b16 v[136:137], v22 offset:26624
    ds_read_b64_tr_b16 v[138:139], v22 offset:27136
    ds_read_b64_tr_b16 v[140:141], v23 offset:26624
    ds_read_b64_tr_b16 v[142:143], v23 offset:27136
    s_waitcnt lgkmcnt(14)
    v_mfma_f32_32x32x16_bf16 v[96:111], a[168:171], v[144:147], v[96:111]
    s_waitcnt lgkmcnt(12)
    v_mfma_f32_32x32x16_bf16 v[112:127], a[168:171], v[148:151], v[112:127]
    buffer_load_dwordx4 v43, s[4:7], s22 offen offset:3072 lds
    ds_read_b64_tr_b16 v[144:145], v22 offset:28672
    ds_read_b64_tr_b16 v[146:147], v22 offset:29184
    ds_read_b64_tr_b16 v[148:149], v23 offset:28672
    ds_read_b64_tr_b16 v[150:151], v23 offset:29184
    s_waitcnt lgkmcnt(14)
    v_mfma_f32_32x32x16_bf16 v[96:111], a[172:175], v[152:155], v[96:111]
    s_waitcnt lgkmcnt(12)
    v_mfma_f32_32x32x16_bf16 v[112:127], a[172:175], v[156:159], v[112:127]
    s_waitcnt vmcnt(12)
    s_lshl4_add_u32 s64, s57, s58
    s_lshl4_add_u32 s64, s64, s56
    s_lshl_b32 s64, s64, 2
    s_add_u32 s64, s64, 65536
    v_mov_b32 v30, s61
    s_waitcnt lgkmcnt(10)
    v_mfma_f32_32x32x16_bf16 v[96:111], a[176:179], v[128:131], v[96:111]
    buffer_store_dword v30, off, s[48:51], s64 sc1
    s_add_u32 s12, s22, 131072
    s_add_u32 m0, s37, 12288
    s_nop 0
    buffer_load_dwordx4 v40, s[4:7], s12 offen offset:0 lds
    ds_read_b64_tr_b16 v[152:153], v22 offset:30720
    s_waitcnt lgkmcnt(9)
    v_mfma_f32_32x32x16_bf16 v[112:127], a[176:179], v[132:135], v[112:127]
    ds_read_b64_tr_b16 v[154:155], v22 offset:31232
    ds_read_b64_tr_b16 v[156:157], v23 offset:30720
    ds_read_b64_tr_b16 v[158:159], v23 offset:31232
    buffer_load_dwordx4 v41, s[4:7], s12 offen offset:1024 lds
    ds_read_b64_tr_b16 v[128:129], v22 offset:32768
    s_waitcnt lgkmcnt(11)
    v_mfma_f32_32x32x16_bf16 v[96:111], a[180:183], v[136:139], v[96:111]
    ds_read_b64_tr_b16 v[130:131], v22 offset:33280
    ds_read_b64_tr_b16 v[132:133], v23 offset:32768
    ds_read_b64_tr_b16 v[134:135], v23 offset:33280
    s_waitcnt lgkmcnt(12)
    v_mfma_f32_32x32x16_bf16 v[112:127], a[180:183], v[140:143], v[112:127]
    buffer_load_dwordx4 v42, s[4:7], s12 offen offset:2048 lds
    ds_read_b64_tr_b16 v[136:137], v22 offset:34816
    ds_read_b64_tr_b16 v[138:139], v22 offset:35328
    ds_read_b64_tr_b16 v[140:141], v23 offset:34816
    ds_read_b64_tr_b16 v[142:143], v23 offset:35328
    s_waitcnt lgkmcnt(14)
    v_mfma_f32_32x32x16_bf16 v[96:111], a[184:187], v[144:147], v[96:111]
    s_waitcnt lgkmcnt(12)
    v_mfma_f32_32x32x16_bf16 v[112:127], a[184:187], v[148:151], v[112:127]
    buffer_load_dwordx4 v43, s[4:7], s12 offen offset:3072 lds
    ds_read_b64_tr_b16 v[144:145], v22 offset:36864
    ds_read_b64_tr_b16 v[146:147], v22 offset:37376
    ds_read_b64_tr_b16 v[148:149], v23 offset:36864
    ds_read_b64_tr_b16 v[150:151], v23 offset:37376
    s_waitcnt lgkmcnt(14)
    v_mfma_f32_32x32x16_bf16 v[96:111], a[188:191], v[152:155], v[96:111]
    s_waitcnt lgkmcnt(12)
    v_mfma_f32_32x32x16_bf16 v[112:127], a[188:191], v[156:159], v[112:127]
    ds_read_b64_tr_b16 v[152:153], v22 offset:38912
    ds_read_b64_tr_b16 v[154:155], v22 offset:39424
    ds_read_b64_tr_b16 v[156:157], v23 offset:38912
    ds_read_b64_tr_b16 v[158:159], v23 offset:39424
    s_waitcnt lgkmcnt(14)
    v_mfma_f32_32x32x16_bf16 v[96:111], a[192:195], v[128:131], v[96:111]
    s_waitcnt lgkmcnt(12)
    v_mfma_f32_32x32x16_bf16 v[112:127], a[192:195], v[132:135], v[112:127]
    ds_read_b64_tr_b16 v[128:129], v22 offset:40960
    ds_read_b64_tr_b16 v[130:131], v22 offset:41472
    ds_read_b64_tr_b16 v[132:133], v23 offset:40960
    ds_read_b64_tr_b16 v[134:135], v23 offset:41472
    s_waitcnt lgkmcnt(14)
    v_mfma_f32_32x32x16_bf16 v[96:111], a[196:199], v[136:139], v[96:111]
    s_waitcnt lgkmcnt(12)
    v_mfma_f32_32x32x16_bf16 v[112:127], a[196:199], v[140:143], v[112:127]
    ds_read_b64_tr_b16 v[136:137], v22 offset:43008
    ds_read_b64_tr_b16 v[138:139], v22 offset:43520
    ds_read_b64_tr_b16 v[140:141], v23 offset:43008
    ds_read_b64_tr_b16 v[142:143], v23 offset:43520
    s_waitcnt lgkmcnt(14)
    v_mfma_f32_32x32x16_bf16 v[96:111], a[200:203], v[144:147], v[96:111]
    s_waitcnt lgkmcnt(12)
    v_mfma_f32_32x32x16_bf16 v[112:127], a[200:203], v[148:151], v[112:127]
    ds_read_b64_tr_b16 v[144:145], v22 offset:45056
    ds_read_b64_tr_b16 v[146:147], v22 offset:45568
    ds_read_b64_tr_b16 v[148:149], v23 offset:45056
    ds_read_b64_tr_b16 v[150:151], v23 offset:45568
    s_waitcnt lgkmcnt(14)
    v_mfma_f32_32x32x16_bf16 v[96:111], a[204:207], v[152:155], v[96:111]
    s_waitcnt lgkmcnt(12)
    v_mfma_f32_32x32x16_bf16 v[112:127], a[204:207], v[156:159], v[112:127]
    ds_read_b128 a[0:3], v48 offset:0
    ds_read_b128 a[4:7], v48 offset:4096
    ds_read_b128 a[8:11], v49 offset:0
    ds_read_b128 a[12:15], v49 offset:4096
    ds_read_b128 a[16:19], v50 offset:0
    s_waitcnt lgkmcnt(14)
    v_mfma_f32_32x32x16_bf16 v[96:111], a[208:211], v[128:131], v[96:111]
    ds_read_b128 a[20:23], v50 offset:4096
    ds_read_b128 a[24:27], v51 offset:0
    ds_read_b128 a[28:31], v51 offset:4096
    ds_read_b64_tr_b16 v[152:153], v22 offset:47104
    ds_read_b64_tr_b16 v[154:155], v22 offset:47616
    s_waitcnt lgkmcnt(14)
    v_mfma_f32_32x32x16_bf16 v[112:127], a[208:211], v[132:135], v[112:127]
    ds_read_b64_tr_b16 v[156:157], v23 offset:47104
    ds_read_b64_tr_b16 v[158:159], v23 offset:47616
    s_waitcnt lgkmcnt(4)
    s_add_u32 m0, s36, 0
    s_nop 0
    buffer_load_dwordx4 v40, s[4:7], s23 offen offset:0 lds
    v_mfma_f32_32x32x16_bf16 v[96:111], a[212:215], v[136:139], v[96:111]
    ds_read_b64_tr_b16 v[128:129], v22 offset:49152
    ds_read_b64_tr_b16 v[130:131], v22 offset:49664
    ds_read_b64_tr_b16 v[132:133], v23 offset:49152
    ds_read_b64_tr_b16 v[134:135], v23 offset:49664
    v_mfma_f32_32x32x16_bf16 v[112:127], a[212:215], v[140:143], v[112:127]
    buffer_load_dwordx4 v41, s[4:7], s23 offen offset:1024 lds
    ds_read_b64_tr_b16 v[136:137], v22 offset:51200
    ds_read_b64_tr_b16 v[138:139], v22 offset:51712
    ds_read_b64_tr_b16 v[140:141], v23 offset:51200
    ds_read_b64_tr_b16 v[142:143], v23 offset:51712
    v_mfma_f32_32x32x16_bf16 v[96:111], a[216:219], v[144:147], v[96:111]
    v_mfma_f32_32x32x16_bf16 v[112:127], a[216:219], v[148:151], v[112:127]
    buffer_load_dwordx4 v42, s[4:7], s23 offen offset:2048 lds
    ds_read_b64_tr_b16 v[144:145], v22 offset:53248
    ds_read_b64_tr_b16 v[146:147], v22 offset:53760
    ds_read_b64_tr_b16 v[148:149], v23 offset:53248
    ds_read_b64_tr_b16 v[150:151], v23 offset:53760
    s_waitcnt lgkmcnt(14)
    v_mfma_f32_32x32x16_bf16 v[96:111], a[220:223], v[152:155], v[96:111]
    s_waitcnt lgkmcnt(12)
    v_mfma_f32_32x32x16_bf16 v[112:127], a[220:223], v[156:159], v[112:127]
    s_waitcnt vmcnt(12)
    ds_read_b128 a[32:35], v52 offset:0
    ds_read_b128 a[36:39], v52 offset:4096
    ds_read_b128 a[40:43], v53 offset:0
    ds_read_b128 a[44:47], v53 offset:4096
    ds_read_b128 a[48:51], v54 offset:0
    s_waitcnt lgkmcnt(14)
    v_mfma_f32_32x32x16_bf16 v[96:111], a[224:227], v[128:131], v[96:111]
    ds_read_b128 a[52:55], v54 offset:4096
    ds_read_b128 a[56:59], v55 offset:0
    ds_read_b128 a[60:63], v55 offset:4096
    buffer_load_dwordx4 v43, s[4:7], s23 offen offset:3072 lds
    ds_read_b64_tr_b16 v[152:153], v22 offset:55296
    s_waitcnt lgkmcnt(14)
    v_mfma_f32_32x32x16_bf16 v[112:127], a[224:227], v[132:135], v[112:127]
    ds_read_b64_tr_b16 v[154:155], v22 offset:55808
    ds_read_b64_tr_b16 v[156:157], v23 offset:55296
    ds_read_b64_tr_b16 v[158:159], v23 offset:55808
    s_waitcnt lgkmcnt(4)
    s_add_u32 s12, s23, 131072
    v_mfma_f32_32x32x16_bf16 v[96:111], a[228:231], v[136:139], v[96:111]
    s_add_u32 m0, s36, 4096
    s_nop 0
    buffer_load_dwordx4 v40, s[4:7], s12 offen offset:0 lds
    ds_read_b64_tr_b16 v[128:129], v22 offset:57344
    ds_read_b64_tr_b16 v[130:131], v22 offset:57856
    ds_read_b64_tr_b16 v[132:133], v23 offset:57344
    v_mfma_f32_32x32x16_bf16 v[112:127], a[228:231], v[140:143], v[112:127]
    ds_read_b64_tr_b16 v[134:135], v23 offset:57856
    buffer_load_dwordx4 v41, s[4:7], s12 offen offset:1024 lds
    ds_read_b64_tr_b16 v[136:137], v22 offset:59392
    ds_read_b64_tr_b16 v[138:139], v22 offset:59904
    ds_read_b64_tr_b16 v[140:141], v23 offset:59392
    v_mfma_f32_32x32x16_bf16 v[96:111], a[232:235], v[144:147], v[96:111]
    ds_read_b64_tr_b16 v[142:143], v23 offset:59904
    v_mfma_f32_32x32x16_bf16 v[112:127], a[232:235], v[148:151], v[112:127]
    buffer_load_dwordx4 v42, s[4:7], s12 offen offset:2048 lds
    ds_read_b64_tr_b16 v[144:145], v22 offset:61440
    ds_read_b64_tr_b16 v[146:147], v22 offset:61952
    ds_read_b64_tr_b16 v[148:149], v23 offset:61440
    ds_read_b64_tr_b16 v[150:151], v23 offset:61952
    s_waitcnt lgkmcnt(14)
    v_mfma_f32_32x32x16_bf16 v[96:111], a[236:239], v[152:155], v[96:111]
    s_waitcnt lgkmcnt(12)
    v_mfma_f32_32x32x16_bf16 v[112:127], a[236:239], v[156:159], v[112:127]
    s_waitcnt vmcnt(7)
    ds_read_b128 a[64:67], v56 offset:0
    ds_read_b128 a[68:71], v56 offset:4096
    ds_read_b128 a[72:75], v57 offset:0
    ds_read_b128 a[76:79], v57 offset:4096
    ds_read_b128 a[80:83], v58 offset:0
    s_waitcnt lgkmcnt(14)
    v_mfma_f32_32x32x16_bf16 v[96:111], a[240:243], v[128:131], v[96:111]
    ds_read_b128 a[84:87], v58 offset:4096
    ds_read_b128 a[88:91], v59 offset:0
    ds_read_b128 a[92:95], v59 offset:4096
    buffer_load_dwordx4 v43, s[4:7], s12 offen offset:3072 lds
    ds_read_b64_tr_b16 v[152:153], v22 offset:63488
    s_waitcnt lgkmcnt(14)
    v_mfma_f32_32x32x16_bf16 v[112:127], a[240:243], v[132:135], v[112:127]
    ds_read_b64_tr_b16 v[154:155], v22 offset:64000
    ds_read_b64_tr_b16 v[156:157], v23 offset:63488
    ds_read_b64_tr_b16 v[158:159], v23 offset:64000
    s_waitcnt lgkmcnt(4)
    s_add_u32 m0, s37, 0
    v_mfma_f32_32x32x16_bf16 v[96:111], a[244:247], v[136:139], v[96:111]
    buffer_load_dwordx4 v40, s[4:7], s26 offen offset:0 lds
    v_mfma_f32_32x32x16_bf16 v[112:127], a[244:247], v[140:143], v[112:127]
    buffer_load_dwordx4 v41, s[4:7], s26 offen offset:1024 lds
    v_mfma_f32_32x32x16_bf16 v[96:111], a[248:251], v[144:147], v[96:111]
    v_mfma_f32_32x32x16_bf16 v[112:127], a[248:251], v[148:151], v[112:127]
    buffer_load_dwordx4 v42, s[4:7], s26 offen offset:2048 lds
    s_waitcnt lgkmcnt(2)
    v_mfma_f32_32x32x16_bf16 v[96:111], a[252:255], v[152:155], v[96:111]
    s_waitcnt lgkmcnt(0)
    v_mfma_f32_32x32x16_bf16 v[112:127], a[252:255], v[156:159], v[112:127]
    s_nop 9
    v_cvt_pk_bf16_f32 v208, v96, v97
    v_cvt_pk_bf16_f32 v209, v98, v99
    v_cvt_pk_bf16_f32 v210, v100, v101
    v_cvt_pk_bf16_f32 v211, v102, v103
    v_cvt_pk_bf16_f32 v212, v104, v105
    v_cvt_pk_bf16_f32 v213, v106, v107
    v_cvt_pk_bf16_f32 v214, v108, v109
    v_cvt_pk_bf16_f32 v215, v110, v111
    buffer_load_dwordx4 v43, s[4:7], s26 offen offset:3072 lds
    v_cvt_pk_bf16_f32 v216, v112, v113
    v_cvt_pk_bf16_f32 v217, v114, v115
    v_cvt_pk_bf16_f32 v218, v116, v117
    v_cvt_pk_bf16_f32 v219, v118, v119
    v_cvt_pk_bf16_f32 v220, v120, v121
    v_cvt_pk_bf16_f32 v221, v122, v123
    v_cvt_pk_bf16_f32 v222, v124, v125
    v_cvt_pk_bf16_f32 v223, v126, v127
    s_add_u32 s12, s26, 131072
    s_add_u32 m0, s37, 4096
    s_nop 0
    buffer_load_dwordx4 v40, s[4:7], s12 offen offset:0 lds
    v_mov_b32 v160, 0x3f803f80
    v_mov_b32 v161, 0x3f803f80
    v_mov_b32 v162, 0x3f803f80
    v_mov_b32 v163, 0x3f803f80
    v_mfma_f32_32x32x16_bf16 v[64:79], v[192:195], v[208:211], 0
    s_nop 0
    v_mfma_f32_32x32x16_bf16 v[224:239], v[192:195], v[160:163], 0
    v_mfma_f32_32x32x16_bf16 v[80:95], v[200:203], v[216:219], 0
    v_mfma_f32_32x32x16_bf16 v[240:255], v[200:203], v[160:163], 0
    buffer_load_dwordx4 v41, s[4:7], s12 offen offset:1024 lds
    v_mfma_f32_32x32x16_bf16 v[64:79], v[196:199], v[212:215], v[64:79]
    v_mfma_f32_32x32x16_bf16 v[224:239], v[196:199], v[160:163], v[224:239]
    v_mfma_f32_32x32x16_bf16 v[80:95], v[204:207], v[220:223], v[80:95]
    v_mfma_f32_32x32x16_bf16 v[240:255], v[204:207], v[160:163], v[240:255]
    s_mov_b32 s97, 65536
    buffer_load_dword v14, v8, s[48:51], s97 offen sc1
    v_and_b32 v1, 31, v0
    v_cmp_gt_u32 vcc, 16, v1
    s_nop 5
    v_cndmask_b32 v64, v224, v64, vcc
    v_cndmask_b32 v65, v225, v65, vcc
    v_cndmask_b32 v66, v226, v66, vcc
    v_cndmask_b32 v67, v227, v67, vcc
    v_cndmask_b32 v68, v228, v68, vcc
    v_cndmask_b32 v69, v229, v69, vcc
    v_cndmask_b32 v70, v230, v70, vcc
    v_cndmask_b32 v71, v231, v71, vcc
    v_cndmask_b32 v72, v72, v232, vcc
    v_cndmask_b32 v73, v73, v233, vcc
    v_cndmask_b32 v74, v74, v234, vcc
    v_cndmask_b32 v75, v75, v235, vcc
    v_cndmask_b32 v76, v76, v236, vcc
    v_cndmask_b32 v77, v77, v237, vcc
    v_cndmask_b32 v78, v78, v238, vcc
    v_cndmask_b32 v79, v79, v239, vcc
    v_cndmask_b32 v80, v240, v80, vcc
    v_cndmask_b32 v81, v241, v81, vcc
    v_cndmask_b32 v82, v242, v82, vcc
    v_cndmask_b32 v83, v243, v83, vcc
    v_cndmask_b32 v84, v244, v84, vcc
    v_cndmask_b32 v85, v245, v85, vcc
    v_cndmask_b32 v86, v246, v86, vcc
    v_cndmask_b32 v87, v247, v87, vcc
    v_cndmask_b32 v88, v88, v248, vcc
    v_cndmask_b32 v89, v89, v249, vcc
    v_cndmask_b32 v90, v90, v250, vcc
    v_cndmask_b32 v91, v91, v251, vcc
    v_cndmask_b32 v92, v92, v252, vcc
    v_cndmask_b32 v93, v93, v253, vcc
    v_cndmask_b32 v94, v94, v254, vcc
    v_cndmask_b32 v95, v95, v255, vcc
    s_barrier
    s_lshl_b32 s64, s56, 11
    s_add_u32 s64, s64, 0
    v_add_u32 v1, s64, v24
    ds_write_b128 v1, v[64:67] offset:0
    ds_write_b128 v1, v[68:71] offset:1024
    ds_write_b128 v1, v[72:75] offset:8192
    ds_write_b128 v1, v[76:79] offset:9216
    ds_write_b128 v1, v[80:83] offset:16384
    ds_write_b128 v1, v[84:87] offset:17408
    ds_write_b128 v1, v[88:91] offset:24576
    ds_write_b128 v1, v[92:95] offset:25600
    s_lshl_b32 s64, s56, 13
    s_add_u32 s64, s64, 0
    v_add_u32 v1, s64, v24
    s_waitcnt lgkmcnt(0)
    s_barrier
    ds_read_b128 v[224:227], v1 offset:0
    ds_read_b128 v[228:231], v1 offset:1024
    ds_read_b128 v[232:235], v1 offset:2048
    ds_read_b128 v[236:239], v1 offset:3072
    ds_read_b128 v[240:243], v1 offset:4096
    ds_read_b128 v[244:247], v1 offset:5120
    ds_read_b128 v[248:251], v1 offset:6144
    ds_read_b128 v[252:255], v1 offset:7168
    s_waitcnt lgkmcnt(5)
    v_add_f32 v224, v224, v232
    s_waitcnt lgkmcnt(1)
    v_add_f32 v240, v240, v248
    v_add_f32 v225, v225, v233
    v_add_f32 v241, v241, v249
    v_add_f32 v226, v226, v234
    v_add_f32 v242, v242, v250
    v_add_f32 v227, v227, v235
    v_add_f32 v243, v243, v251
    v_add_f32 v228, v228, v236
    s_waitcnt lgkmcnt(0)
    v_add_f32 v244, v244, v252
    v_add_f32 v229, v229, v237
    v_add_f32 v245, v245, v253
    v_add_f32 v230, v230, v238
    v_add_f32 v246, v246, v254
    v_add_f32 v231, v231, v239
    v_add_f32 v247, v247, v255
    v_add_f32 v224, v224, v240
    v_add_f32 v225, v225, v241
    v_add_f32 v226, v226, v242
    v_add_f32 v227, v227, v243
    v_add_f32 v228, v228, v244
    v_add_f32 v229, v229, v245
    v_add_f32 v230, v230, v246
    v_add_f32 v231, v231, v247
    s_lshl2_add_u32 s64, s58, s56
    s_lshl_b32 s64, s64, 15
    s_lshl_b32 s65, s57, 10
    s_add_u32 s64, s64, s65
    s_add_u32 s64, s64, 1048576
    buffer_store_dwordx4 v[224:227], v24, s[48:51], s64 offen sc1
    s_add_u32 s64, s64, 16384
    buffer_store_dwordx4 v[228:231], v24, s[48:51], s64 offen sc1
    buffer_load_dwordx4 v42, s[4:7], s12 offen offset:2048 lds
    buffer_load_dwordx4 v43, s[4:7], s12 offen offset:3072 lds
    s_add_u32 m0, s37, 8192
    s_nop 0
    buffer_load_dwordx4 v40, s[4:7], s27 offen offset:0 lds
    buffer_load_dwordx4 v41, s[4:7], s27 offen offset:1024 lds
    buffer_load_dwordx4 v42, s[4:7], s27 offen offset:2048 lds
    buffer_load_dwordx4 v43, s[4:7], s27 offen offset:3072 lds
    s_add_u32 s12, s27, 131072
    s_add_u32 m0, s37, 12288
    s_nop 0
    buffer_load_dwordx4 v40, s[4:7], s12 offen offset:0 lds
    buffer_load_dwordx4 v41, s[4:7], s12 offen offset:1024 lds
    buffer_load_dwordx4 v42, s[4:7], s12 offen offset:2048 lds
    buffer_load_dwordx4 v43, s[4:7], s12 offen offset:3072 lds
    s_waitcnt vmcnt(10)
    s_lshl4_add_u32 s64, s57, s58
    s_lshl4_add_u32 s64, s64, s56
    s_lshl_b32 s64, s64, 2
    s_add_u32 s64, s64, 131072
    v_mov_b32 v30, s61
    buffer_store_dword v30, off, s[48:51], s64 sc1
    s_branch L_p1_done
L_roleB:
L_pad_roleB_0:
    s_cbranch_execz L_pad_roleB_1
    v_lshrrev_b32 v1, 3, v0
    v_lshlrev_b32 v1, 12, v1
    v_and_b32 v2, 7, v0
    v_lshl_add_u32 v44, v2, 7, v1
    v_lshlrev_b32 v46, 10, v0
    v_mov_b32 v47, v46
    v_mov_b32 v1, 0x40000000
    v_cmp_lt_u32 vcc, 21, v0
    s_nop 1
    v_cndmask_b32 v46, v46, v1, vcc
    v_cmp_lt_u32 vcc, 15, v0
    s_nop 1
    v_cndmask_b32 v47, v47, v1, vcc
    s_mov_b32 s8, s30
    s_mov_b32 s9, s31
    s_mov_b32 s10, 0xac000
    s_mov_b32 s11, 0x20000
    s_mov_b32 s40, s20
    s_mov_b32 s41, s21
    s_mov_b32 s42, 0x80000
    s_mov_b32 s43, 0x20000
    v_pk_mul_f32 v[160:161], v[64:65], v[64:65]
    v_pk_mul_f32 v[162:163], v[66:67], v[66:67]
    v_pk_mul_f32 v[164:165], v[68:69], v[68:69]
    v_pk_mul_f32 v[166:167], v[70:71], v[70:71]
    v_pk_fma_f32 v[160:161], v[160:161], s[62:63], v[38:39]
    v_pk_fma_f32 v[162:163], v[162:163], s[62:63], v[38:39]
    v_pk_fma_f32 v[164:165], v[164:165], s[62:63], v[38:39]
    v_pk_fma_f32 v[166:167], v[166:167], s[62:63], v[38:39]
    v_pk_mul_f32 v[160:161], v[160:161], v[64:65]
    v_pk_mul_f32 v[162:163], v[162:163], v[66:67]
    v_pk_mul_f32 v[164:165], v[164:165], v[68:69]
    v_pk_mul_f32 v[166:167], v[166:167], v[70:71]
    v_exp_f32 v160, v160
    v_exp_f32 v161, v161
    s_add_u32 s12, s15, 0
    s_and_b32 s12, s12, 7
    s_mul_i32 s12, s12, s80
    s_add_u32 s12, s12, s73
    s_add_u32 m0, s72, 98304
    s_nop 0
    buffer_load_dwordx4 v12, s[44:47], s12 offen lds
    v_exp_f32 v162, v162
    v_exp_f32 v163, v163
    v_exp_f32 v164, v164
    v_exp_f32 v165, v165
    v_exp_f32 v166, v166
    v_exp_f32 v167, v167
    v_pk_add_f32 v[160:161], v[160:161], s[84:85]
    v_pk_add_f32 v[162:163], v[162:163], s[84:85]
    v_pk_add_f32 v[164:165], v[164:165], s[84:85]
    v_pk_add_f32 v[166:167], v[166:167], s[84:85]
    v_rcp_f32 v160, v160
    v_rcp_f32 v161, v161
    v_rcp_f32 v162, v162
    v_rcp_f32 v163, v163
    buffer_load_dwordx4 v13, s[44:47], s12 offen offset:1024 lds
    v_rcp_f32 v164, v164
    v_rcp_f32 v165, v165
    v_rcp_f32 v166, v166
    v_rcp_f32 v167, v167
    v_pk_mul_f32 v[64:65], v[64:65], v[160:161]
    v_pk_mul_f32 v[66:67], v[66:67], v[162:163]
    v_pk_mul_f32 v[68:69], v[68:69], v[164:165]
    v_pk_mul_f32 v[70:71], v[70:71], v[166:167]
    v_pk_mul_f32 v[160:161], v[72:73], v[72:73]
    v_pk_mul_f32 v[162:163], v[74:75], v[74:75]
    v_pk_mul_f32 v[164:165], v[76:77], v[76:77]
    v_pk_mul_f32 v[166:167], v[78:79], v[78:79]
    v_pk_fma_f32 v[160:161], v[160:161], s[62:63], v[38:39]
    v_pk_fma_f32 v[162:163], v[162:163], s[62:63], v[38:39]
    s_add_u32 s12, s15, 1
    s_and_b32 s12, s12, 7
    s_mul_i32 s12, s12, s80
    s_add_u32 s12, s12, s73
    s_add_u32 m0, s72, 106496
    s_nop 0
    buffer_load_dwordx4 v12, s[44:47], s12 offen lds
    v_pk_fma_f32 v[164:165], v[164:165], s[62:63], v[38:39]
    v_pk_fma_f32 v[166:167], v[166:167], s[62:63], v[38:39]
    v_pk_mul_f32 v[160:161], v[160:161], v[72:73]
    v_pk_mul_f32 v[162:163], v[162:163], v[74:75]
    v_pk_mul_f32 v[164:165], v[164:165], v[76:77]
    v_pk_mul_f32 v[166:167], v[166:167], v[78:79]
    v_exp_f32 v160, v160
    v_exp_f32 v161, v161
    v_exp_f32 v162, v162
    v_exp_f32 v163, v163
    v_exp_f32 v164, v164
    v_exp_f32 v165, v165
    v_exp_f32 v166, v166
    v_exp_f32 v167, v167
    buffer_load_dwordx4 v13, s[44:47], s12 offen offset:1024 lds
    v_pk_add_f32 v[160:161], v[160:161], s[84:85]
    v_pk_add_f32 v[162:163], v[162:163], s[84:85]
    v_pk_add_f32 v[164:165], v[164:165], s[84:85]
    v_pk_add_f32 v[166:167], v[166:167], s[84:85]
    v_rcp_f32 v160, v160
    v_rcp_f32 v161, v161
    v_rcp_f32 v162, v162
    v_rcp_f32 v163, v163
    v_rcp_f32 v164, v164
    v_rcp_f32 v165, v165
    v_rcp_f32 v166, v166
    v_rcp_f32 v167, v167
    v_pk_mul_f32 v[72:73], v[72:73], v[160:161]
    v_pk_mul_f32 v[74:75], v[74:75], v[162:163]
    s_add_u32 s12, s15, 2
    s_and_b32 s12, s12, 7
    s_mul_i32 s12, s12, s80
    s_add_u32 s12, s12, s73
    s_add_u32 m0, s72, 114688
    s_nop 0
    buffer_load_dwordx4 v12, s[44:47], s12 offen lds
    v_pk_mul_f32 v[76:77], v[76:77], v[164:165]
    v_pk_mul_f32 v[78:79], v[78:79], v[166:167]
    v_pk_mul_f32 v[160:161], v[80:81], v[80:81]
    v_pk_mul_f32 v[162:163], v[82:83], v[82:83]
    v_pk_mul_f32 v[164:165], v[84:85], v[84:85]
    v_pk_mul_f32 v[166:167], v[86:87], v[86:87]
    v_pk_fma_f32 v[160:161], v[160:161], s[62:63], v[38:39]
    v_pk_fma_f32 v[162:163], v[162:163], s[62:63], v[38:39]
    v_pk_fma_f32 v[164:165], v[164:165], s[62:63], v[38:39]
    v_pk_fma_f32 v[166:167], v[166:167], s[62:63], v[38:39]
    v_pk_mul_f32 v[160:161], v[160:161], v[80:81]
    v_pk_mul_f32 v[162:163], v[162:163], v[82:83]
    v_pk_mul_f32 v[164:165], v[164:165], v[84:85]
    v_pk_mul_f32 v[166:167], v[166:167], v[86:87]
    buffer_load_dwordx4 v13, s[44:47], s12 offen offset:1024 lds
    v_exp_f32 v160, v160
    v_exp_f32 v161, v161
    v_exp_f32 v162, v162
    v_exp_f32 v163, v163
    v_exp_f32 v164, v164
    v_exp_f32 v165, v165
    v_exp_f32 v166, v166
    v_exp_f32 v167, v167
    v_pk_add_f32 v[160:161], v[160:161], s[84:85]
    v_pk_add_f32 v[162:163], v[162:163], s[84:85]
    v_pk_add_f32 v[164:165], v[164:165], s[84:85]
    v_pk_add_f32 v[166:167], v[166:167], s[84:85]
    v_rcp_f32 v160, v160
    v_rcp_f32 v161, v161
    s_add_u32 s12, s15, 3
    s_and_b32 s12, s12, 7
    s_mul_i32 s12, s12, s80
    s_add_u32 s12, s12, s73
    s_add_u32 m0, s72, 122880
    s_nop 0
    buffer_load_dwordx4 v12, s[44:47], s12 offen lds
    v_rcp_f32 v162, v162
    v_rcp_f32 v163, v163
    v_rcp_f32 v164, v164
    v_rcp_f32 v165, v165
    v_rcp_f32 v166, v166
    v_rcp_f32 v167, v167
    v_pk_mul_f32 v[80:81], v[80:81], v[160:161]
    v_pk_mul_f32 v[82:83], v[82:83], v[162:163]
    v_pk_mul_f32 v[84:85], v[84:85], v[164:165]
    v_pk_mul_f32 v[86:87], v[86:87], v[166:167]
    v_pk_mul_f32 v[160:161], v[88:89], v[88:89]
    v_pk_mul_f32 v[162:163], v[90:91], v[90:91]
    v_pk_mul_f32 v[164:165], v[92:93], v[92:93]
    v_pk_mul_f32 v[166:167], v[94:95], v[94:95]
    buffer_load_dwordx4 v13, s[44:47], s12 offen offset:1024 lds
    v_pk_fma_f32 v[160:161], v[160:161], s[62:63], v[38:39]
    v_pk_fma_f32 v[162:163], v[162:163], s[62:63], v[38:39]
    v_pk_fma_f32 v[164:165], v[164:165], s[62:63], v[38:39]
    v_pk_fma_f32 v[166:167], v[166:167], s[62:63], v[38:39]
    v_pk_mul_f32 v[160:161], v[160:161], v[88:89]
    v_pk_mul_f32 v[162:163], v[162:163], v[90:91]
    v_pk_mul_f32 v[164:165], v[164:165], v[92:93]
    v_pk_mul_f32 v[166:167], v[166:167], v[94:95]
    v_exp_f32 v160, v160
    v_exp_f32 v161, v161
    v_exp_f32 v162, v162
    v_exp_f32 v163, v163
    v_exp_f32 v164, v164
    v_exp_f32 v165, v165
    s_add_u32 m0, s36, 0
    s_nop 0
    buffer_load_dwordx4 v40, s[4:7], s16 offen offset:0 lds
    v_exp_f32 v166, v166
    v_exp_f32 v167, v167
    v_pk_add_f32 v[160:161], v[160:161], s[84:85]
    v_pk_add_f32 v[162:163], v[162:163], s[84:85]
    v_pk_add_f32 v[164:165], v[164:165], s[84:85]
    v_pk_add_f32 v[166:167], v[166:167], s[84:85]
    v_rcp_f32 v160, v160
    v_rcp_f32 v161, v161
    v_rcp_f32 v162, v162
    v_rcp_f32 v163, v163
    v_rcp_f32 v164, v164
    v_rcp_f32 v165, v165
    v_rcp_f32 v166, v166
    v_rcp_f32 v167, v167
    buffer_load_dwordx4 v41, s[4:7], s16 offen offset:1024 lds
    v_pk_mul_f32 v[88:89], v[88:89], v[160:161]
    v_pk_mul_f32 v[90:91], v[90:91], v[162:163]
    v_pk_mul_f32 v[92:93], v[92:93], v[164:165]
    v_pk_mul_f32 v[94:95], v[94:95], v[166:167]
    v_pk_add_f32 v[162:163], v[64:65], v[66:67]
    v_pk_mul_f32 v[164:165], v[64:65], v[64:65]
    v_pk_add_f32 v[162:163], v[162:163], v[68:69]
    v_pk_add_f32 v[162:163], v[162:163], v[70:71]
    v_pk_add_f32 v[162:163], v[162:163], v[72:73]
    v_pk_add_f32 v[162:163], v[162:163], v[74:75]
    v_pk_add_f32 v[162:163], v[162:163], v[76:77]
    v_pk_add_f32 v[162:163], v[162:163], v[78:79]
    v_pk_add_f32 v[162:163], v[162:163], v[80:81]
    v_pk_add_f32 v[162:163], v[162:163], v[82:83]
    buffer_load_dwordx4 v42, s[4:7], s16 offen offset:2048 lds
    v_pk_add_f32 v[162:163], v[162:163], v[84:85]
    v_pk_add_f32 v[162:163], v[162:163], v[86:87]
    v_pk_add_f32 v[162:163], v[162:163], v[88:89]
    v_pk_add_f32 v[162:163], v[162:163], v[90:91]
    v_pk_add_f32 v[162:163], v[162:163], v[92:93]
    v_pk_add_f32 v[162:163], v[162:163], v[94:95]
    v_pk_fma_f32 v[164:165], v[66:67], v[66:67], v[164:165]
    v_pk_fma_f32 v[164:165], v[68:69], v[68:69], v[164:165]
    v_pk_fma_f32 v[164:165], v[70:71], v[70:71], v[164:165]
    v_pk_fma_f32 v[164:165], v[72:73], v[72:73], v[164:165]
    v_pk_fma_f32 v[164:165], v[74:75], v[74:75], v[164:165]
    v_pk_fma_f32 v[164:165], v[76:77], v[76:77], v[164:165]
    v_pk_fma_f32 v[164:165], v[78:79], v[78:79], v[164:165]
    v_pk_fma_f32 v[164:165], v[80:81], v[80:81], v[164:165]
    buffer_load_dwordx4 v43, s[4:7], s16 offen offset:3072 lds
    v_pk_fma_f32 v[164:165], v[82:83], v[82:83], v[164:165]
    v_pk_fma_f32 v[164:165], v[84:85], v[84:85], v[164:165]
    v_pk_fma_f32 v[164:165], v[86:87], v[86:87], v[164:165]
    v_pk_fma_f32 v[164:165], v[88:89], v[88:89], v[164:165]
    v_pk_fma_f32 v[164:165], v[90:91], v[90:91], v[164:165]
    v_pk_fma_f32 v[164:165], v[92:93], v[92:93], v[164:165]
    v_pk_fma_f32 v[164:165], v[94:95], v[94:95], v[164:165]
    v_mov_b32 v28, v162
    v_mov_b32 v160, v163
    v_mov_b32 v29, v164
    v_mov_b32 v161, v165
    v_add_f32 v28, v28, v160
    v_add_f32 v29, v29, v161
    s_nop 1
    v_permlane32_swap_b32 v28, v29
    v_add_f32 v28, v28, v29
    v_mov_b32 v29, s61
    s_mul_i32 s64, s79, 5632
    s_lshl_b32 s65, s58, 9
    s_add_u32 s64, s64, s65
    s_add_u32 s64, s64, 524288
    buffer_store_dwordx2 v[28:29], v25, s[48:51], s64 offen sc1
    s_waitcnt vmcnt(5)
    s_barrier
    v_add_u32 v22, 98304, v22
    v_add_u32 v23, 98304, v23
    s_add_u32 s12, s16, 131072
    s_add_u32 m0, s36, 4096
    s_nop 0
    buffer_load_dwordx4 v40, s[4:7], s12 offen offset:0 lds
    buffer_load_dwordx4 v41, s[4:7], s12 offen offset:1024 lds
    buffer_load_dwordx4 v42, s[4:7], s12 offen offset:2048 lds
    buffer_load_dwordx4 v43, s[4:7], s12 offen offset:3072 lds
    ds_read_b64_tr_b16 v[128:129], v22 offset:0
    ds_read_b64_tr_b16 v[130:131], v22 offset:512
    ds_read_b64_tr_b16 v[132:133], v23 offset:0
    ds_read_b64_tr_b16 v[134:135], v23 offset:512
    ds_read_b64_tr_b16 v[136:137], v22 offset:2048
    s_waitcnt lgkmcnt(3)
    v_mfma_f32_32x32x16_bf16 v[96:111], v[128:131], a[128:131], 0
    ds_read_b64_tr_b16 v[138:139], v22 offset:2560
    ds_read_b64_tr_b16 v[140:141], v23 offset:2048
    ds_read_b64_tr_b16 v[142:143], v23 offset:2560
    ds_read_b64_tr_b16 v[144:145], v22 offset:4096
    ds_read_b64_tr_b16 v[146:147], v22 offset:4608
    s_waitcnt lgkmcnt(6)
    v_mfma_f32_32x32x16_bf16 v[112:127], v[132:135], a[128:131], 0
    ds_read_b64_tr_b16 v[148:149], v23 offset:4096
    ds_read_b64_tr_b16 v[150:151], v23 offset:4608
    s_cmp_eq_u32 s94, 0
    s_mov_b32 s74, 2752
    s_cmov_b32 s74, 3072
    s_waitcnt lgkmcnt(6)
    v_mfma_f32_32x32x16_bf16 v[96:111], v[136:139], a[132:135], v[96:111]
    s_mov_b32 s75, s92
    s_mov_b32 s76, s93
    s_cmp_eq_u32 s94, 0
    s_cselect_b32 s44, s18, s24
    s_cselect_b32 s45, s19, s25
    s_waitcnt lgkmcnt(4)
    v_mfma_f32_32x32x16_bf16 v[112:127], v[140:143], a[132:135], v[112:127]
    s_mov_b32 s46, 0x158000
    s_cmov_b32 s46, 0x180000
    s_mov_b32 s47, 0x20000
    v_bfe_u32 v1, v0, 2, 1
    v_bfe_u32 v2, v0, 4, 1
    s_waitcnt lgkmcnt(2)
    v_mfma_f32_32x32x16_bf16 v[96:111], v[144:147], a[136:139], v[96:111]
    v_xor_b32 v1, v1, v2
    v_and_b32 v2, 3, v0
    v_lshlrev_b32 v2, 4, v2
    v_lshl_add_u32 v1, v1, 6, v2
    v_lshrrev_b32 v2, 3, v0
    s_waitcnt lgkmcnt(0)
    v_mfma_f32_32x32x16_bf16 v[112:127], v[148:151], a[136:139], v[112:127]
    v_mul_lo_u32 v2, v2, s74
    v_add_u32 v2, v2, v1
    v_add_u32 v12, s75, v2
    s_lshl_b32 s64, s74, 3
    s_sub_u32 s64, s64, 1024
    v_add_u32 v13, s64, v12
    v_mov_b32 v3, 0x40000000
    v_cmp_gt_u32 vcc, s76, v1
    s_nop 1
    v_cndmask_b32 v12, v12, v3, vcc
    v_cndmask_b32 v13, v13, v3, vcc
    s_lshl_b32 s80, s74, 6
    s_lshl_b32 s64, s74, 4
    s_mul_i32 s73, s64, s56
    s_add_u32 s12, s15, 0
    s_and_b32 s12, s12, 7
    s_mul_i32 s12, s12, s80
    s_add_u32 s12, s12, s73
    s_add_u32 m0, s72, 0
    s_nop 0
    buffer_load_dwordx4 v12, s[44:47], s12 offen lds
    ds_read_b64_tr_b16 v[152:153], v22 offset:6144
    ds_read_b64_tr_b16 v[154:155], v22 offset:6656
    s_waitcnt lgkmcnt(0)
    v_mfma_f32_32x32x16_bf16 v[96:111], v[152:155], a[140:143], v[96:111]
    ds_read_b64_tr_b16 v[156:157], v23 offset:6144
    ds_read_b64_tr_b16 v[158:159], v23 offset:6656
    buffer_load_dwordx4 v13, s[44:47], s12 offen offset:1024 lds
    ds_read_b64_tr_b16 v[128:129], v22 offset:8192
    ds_read_b64_tr_b16 v[130:131], v22 offset:8704
    s_waitcnt lgkmcnt(2)
    v_mfma_f32_32x32x16_bf16 v[112:127], v[156:159], a[140:143], v[112:127]
    ds_read_b64_tr_b16 v[132:133], v23 offset:8192
    ds_read_b64_tr_b16 v[134:135], v23 offset:8704
    s_add_u32 s12, s15, 1
    s_and_b32 s12, s12, 7
    s_mul_i32 s12, s12, s80
    s_waitcnt lgkmcnt(2)
    v_mfma_f32_32x32x16_bf16 v[96:111], v[128:131], a[144:147], v[96:111]
    s_add_u32 s12, s12, s73
    s_add_u32 m0, s72, 8192
    s_nop 0
    buffer_load_dwordx4 v12, s[44:47], s12 offen lds
    ds_read_b64_tr_b16 v[136:137], v22 offset:10240
    ds_read_b64_tr_b16 v[138:139], v22 offset:10752
    s_waitcnt lgkmcnt(2)
    v_mfma_f32_32x32x16_bf16 v[112:127], v[132:135], a[144:147], v[112:127]
    ds_read_b64_tr_b16 v[140:141], v23 offset:10240
    ds_read_b64_tr_b16 v[142:143], v23 offset:10752
    buffer_load_dwordx4 v13, s[44:47], s12 offen offset:1024 lds
    ds_read_b64_tr_b16 v[144:145], v22 offset:12288
    ds_read_b64_tr_b16 v[146:147], v22 offset:12800
    s_waitcnt lgkmcnt(4)
    v_mfma_f32_32x32x16_bf16 v[96:111], v[136:139], a[148:151], v[96:111]
    ds_read_b64_tr_b16 v[148:149], v23 offset:12288
    ds_read_b64_tr_b16 v[150:151], v23 offset:12800
    s_add_u32 s12, s15, 2
    s_and_b32 s12, s12, 7
    s_mul_i32 s12, s12, s80
    s_waitcnt lgkmcnt(4)
    v_mfma_f32_32x32x16_bf16 v[112:127], v[140:143], a[148:151], v[112:127]
    s_add_u32 s12, s12, s73
    s_add_u32 m0, s72, 16384
    s_nop 0
    buffer_load_dwordx4 v12, s[44:47], s12 offen lds
    ds_read_b64_tr_b16 v[152:153], v22 offset:14336
    ds_read_b64_tr_b16 v[154:155], v22 offset:14848
    s_waitcnt lgkmcnt(4)
    v_mfma_f32_32x32x16_bf16 v[96:111], v[144:147], a[152:155], v[96:111]
    ds_read_b64_tr_b16 v[156:157], v23 offset:14336
    ds_read_b64_tr_b16 v[158:159], v23 offset:14848
    buffer_load_dwordx4 v13, s[44:47], s12 offen offset:1024 lds
    ds_read_b64_tr_b16 v[128:129], v22 offset:16384
    ds_read_b64_tr_b16 v[130:131], v22 offset:16896
    s_waitcnt lgkmcnt(6)
    v_mfma_f32_32x32x16_bf16 v[112:127], v[148:151], a[152:155], v[112:127]
    ds_read_b64_tr_b16 v[132:133], v23 offset:16384
    ds_read_b64_tr_b16 v[134:135], v23 offset:16896
    s_add_u32 s12, s15, 3
    s_and_b32 s12, s12, 7
    s_mul_i32 s12, s12, s80
    s_waitcnt lgkmcnt(6)
    v_mfma_f32_32x32x16_bf16 v[96:111], v[152:155], a[156:159], v[96:111]
    s_add_u32 s12, s12, s73
    s_add_u32 m0, s72, 24576
    s_nop 0
    buffer_load_dwordx4 v12, s[44:47], s12 offen lds
    ds_read_b64_tr_b16 v[136:137], v22 offset:18432
    ds_read_b64_tr_b16 v[138:139], v22 offset:18944
    s_waitcnt lgkmcnt(6)
    v_mfma_f32_32x32x16_bf16 v[112:127], v[156:159], a[156:159], v[112:127]
    ds_read_b64_tr_b16 v[140:141], v23 offset:18432
    ds_read_b64_tr_b16 v[142:143], v23 offset:18944
    buffer_load_dwordx4 v13, s[44:47], s12 offen offset:1024 lds
    ds_read_b64_tr_b16 v[144:145], v22 offset:20480
    ds_read_b64_tr_b16 v[146:147], v22 offset:20992
    s_waitcnt lgkmcnt(8)
    v_mfma_f32_32x32x16_bf16 v[96:111], v[128:131], a[160:163], v[96:111]
    ds_read_b64_tr_b16 v[148:149], v23 offset:20480
    ds_read_b64_tr_b16 v[150:151], v23 offset:20992
    s_add_u32 s12, s15, 4
    s_and_b32 s12, s12, 7
    s_mul_i32 s12, s12, s80
    s_waitcnt lgkmcnt(8)
    v_mfma_f32_32x32x16_bf16 v[112:127], v[132:135], a[160:163], v[112:127]
    s_add_u32 s12, s12, s73
    s_add_u32 m0, s72, 32768
    s_nop 0
    buffer_load_dwordx4 v12, s[44:47], s12 offen lds
    ds_read_b64_tr_b16 v[152:153], v22 offset:22528
    ds_read_b64_tr_b16 v[154:155], v22 offset:23040
    s_waitcnt lgkmcnt(8)
    v_mfma_f32_32x32x16_bf16 v[96:111], v[136:139], a[164:167], v[96:111]
    ds_read_b64_tr_b16 v[156:157], v23 offset:22528
    ds_read_b64_tr_b16 v[158:159], v23 offset:23040
    buffer_load_dwordx4 v13, s[44:47], s12 offen offset:1024 lds
    ds_read_b64_tr_b16 v[128:129], v22 offset:24576
    ds_read_b64_tr_b16 v[130:131], v22 offset:25088
    s_waitcnt lgkmcnt(10)
    v_mfma_f32_32x32x16_bf16 v[112:127], v[140:143], a[164:167], v[112:127]
    ds_read_b64_tr_b16 v[132:133], v23 offset:24576
    ds_read_b64_tr_b16 v[134:135], v23 offset:25088
    s_add_u32 s12, s15, 5
    s_and_b32 s12, s12, 7
    s_mul_i32 s12, s12, s80
    s_waitcnt lgkmcnt(10)
    v_mfma_f32_32x32x16_bf16 v[96:111], v[144:147], a[168:171], v[96:111]
    s_add_u32 s12, s12, s73
    s_add_u32 m0, s72, 40960
    s_nop 0
    buffer_load_dwordx4 v12, s[44:47], s12 offen lds
    ds_read_b64_tr_b16 v[136:137], v22 offset:26624
    ds_read_b64_tr_b16 v[138:139], v22 offset:27136
    s_waitcnt lgkmcnt(10)
    v_mfma_f32_32x32x16_bf16 v[112:127], v[148:151], a[168:171], v[112:127]
    ds_read_b64_tr_b16 v[140:141], v23 offset:26624
    ds_read_b64_tr_b16 v[142:143], v23 offset:27136
    buffer_load_dwordx4 v13, s[44:47], s12 offen offset:1024 lds
    ds_read_b64_tr_b16 v[144:145], v22 offset:28672
    ds_read_b64_tr_b16 v[146:147], v22 offset:29184
    s_waitcnt lgkmcnt(12)
    v_mfma_f32_32x32x16_bf16 v[96:111], v[152:155], a[172:175], v[96:111]
    ds_read_b64_tr_b16 v[148:149], v23 offset:28672
    ds_read_b64_tr_b16 v[150:151], v23 offset:29184
    s_waitcnt lgkmcnt(12)
    v_mfma_f32_32x32x16_bf16 v[112:127], v[156:159], a[172:175], v[112:127]
    s_add_u32 s12, s15, 6
    s_and_b32 s12, s12, 7
    s_mul_i32 s12, s12, s80
    s_add_u32 s12, s12, s73
    s_add_u32 m0, s72, 49152
    s_waitcnt lgkmcnt(10)
    v_mfma_f32_32x32x16_bf16 v[96:111], v[128:131], a[176:179], v[96:111]
    buffer_load_dwordx4 v12, s[44:47], s12 offen lds
    ds_read_b64_tr_b16 v[152:153], v22 offset:30720
    ds_read_b64_tr_b16 v[154:155], v22 offset:31232
    ds_read_b64_tr_b16 v[156:157], v23 offset:30720
    ds_read_b64_tr_b16 v[158:159], v23 offset:31232
    s_waitcnt lgkmcnt(12)
    v_mfma_f32_32x32x16_bf16 v[112:127], v[132:135], a[176:179], v[112:127]
    buffer_load_dwordx4 v13, s[44:47], s12 offen offset:1024 lds
    ds_read_b64_tr_b16 v[128:129], v22 offset:32768
    ds_read_b64_tr_b16 v[130:131], v22 offset:33280
    ds_read_b64_tr_b16 v[132:133], v23 offset:32768
    ds_read_b64_tr_b16 v[134:135], v23 offset:33280
    s_waitcnt lgkmcnt(14)
    v_mfma_f32_32x32x16_bf16 v[96:111], v[136:139], a[180:183], v[96:111]
    s_waitcnt lgkmcnt(12)
    v_mfma_f32_32x32x16_bf16 v[112:127], v[140:143], a[180:183], v[112:127]
    s_add_u32 s12, s15, 7
    s_and_b32 s12, s12, 7
    s_mul_i32 s12, s12, s80
    s_add_u32 s12, s12, s73
    s_add_u32 m0, s72, 57344
    s_waitcnt lgkmcnt(10)
    v_mfma_f32_32x32x16_bf16 v[96:111], v[144:147], a[184:187], v[96:111]
    buffer_load_dwordx4 v12, s[44:47], s12 offen lds
    ds_read_b64_tr_b16 v[136:137], v22 offset:34816
    ds_read_b64_tr_b16 v[138:139], v22 offset:35328
    ds_read_b64_tr_b16 v[140:141], v23 offset:34816
    ds_read_b64_tr_b16 v[142:143], v23 offset:35328
    s_waitcnt lgkmcnt(12)
    v_mfma_f32_32x32x16_bf16 v[112:127], v[148:151], a[184:187], v[112:127]
    buffer_load_dwordx4 v13, s[44:47], s12 offen offset:1024 lds
    ds_read_b64_tr_b16 v[144:145], v22 offset:36864
    ds_read_b64_tr_b16 v[146:147], v22 offset:37376
    ds_read_b64_tr_b16 v[148:149], v23 offset:36864
    ds_read_b64_tr_b16 v[150:151], v23 offset:37376
    s_waitcnt lgkmcnt(14)
    v_mfma_f32_32x32x16_bf16 v[96:111], v[152:155], a[188:191], v[96:111]
    s_waitcnt lgkmcnt(12)
    v_mfma_f32_32x32x16_bf16 v[112:127], v[156:159], a[188:191], v[112:127]
    ds_read_b64_tr_b16 v[152:153], v22 offset:38912
    ds_read_b64_tr_b16 v[154:155], v22 offset:39424
    ds_read_b64_tr_b16 v[156:157], v23 offset:38912
    ds_read_b64_tr_b16 v[158:159], v23 offset:39424
    s_waitcnt lgkmcnt(14)
    v_mfma_f32_32x32x16_bf16 v[96:111], v[128:131], a[192:195], v[96:111]
    s_waitcnt lgkmcnt(12)
    v_mfma_f32_32x32x16_bf16 v[112:127], v[132:135], a[192:195], v[112:127]
    ds_read_b64_tr_b16 v[128:129], v22 offset:40960
    ds_read_b64_tr_b16 v[130:131], v22 offset:41472
    ds_read_b64_tr_b16 v[132:133], v23 offset:40960
    ds_read_b64_tr_b16 v[134:135], v23 offset:41472
    s_waitcnt lgkmcnt(14)
    v_mfma_f32_32x32x16_bf16 v[96:111], v[136:139], a[196:199], v[96:111]
    s_waitcnt lgkmcnt(12)
    v_mfma_f32_32x32x16_bf16 v[112:127], v[140:143], a[196:199], v[112:127]
    ds_read_b64_tr_b16 v[136:137], v22 offset:43008
    ds_read_b64_tr_b16 v[138:139], v22 offset:43520
    ds_read_b64_tr_b16 v[140:141], v23 offset:43008
    ds_read_b64_tr_b16 v[142:143], v23 offset:43520
    s_waitcnt lgkmcnt(14)
    v_mfma_f32_32x32x16_bf16 v[96:111], v[144:147], a[200:203], v[96:111]
    s_waitcnt lgkmcnt(12)
    v_mfma_f32_32x32x16_bf16 v[112:127], v[148:151], a[200:203], v[112:127]
    ds_read_b64_tr_b16 v[144:145], v22 offset:45056
    ds_read_b64_tr_b16 v[146:147], v22 offset:45568
    ds_read_b64_tr_b16 v[148:149], v23 offset:45056
    ds_read_b64_tr_b16 v[150:151], v23 offset:45568
    s_waitcnt lgkmcnt(14)
    v_mfma_f32_32x32x16_bf16 v[96:111], v[152:155], a[204:207], v[96:111]
    s_waitcnt lgkmcnt(12)
    v_mfma_f32_32x32x16_bf16 v[112:127], v[156:159], a[204:207], v[112:127]
    ds_read_b64_tr_b16 v[152:153], v22 offset:47104
    ds_read_b64_tr_b16 v[154:155], v22 offset:47616
    ds_read_b64_tr_b16 v[156:157], v23 offset:47104
    ds_read_b64_tr_b16 v[158:159], v23 offset:47616
    s_waitcnt lgkmcnt(14)
    v_mfma_f32_32x32x16_bf16 v[96:111], v[128:131], a[208:211], v[96:111]
    s_waitcnt lgkmcnt(12)
    v_mfma_f32_32x32x16_bf16 v[112:127], v[132:135], a[208:211], v[112:127]
    ds_read_b64_tr_b16 v[128:129], v22 offset:49152
    ds_read_b64_tr_b16 v[130:131], v22 offset:49664
    ds_read_b64_tr_b16 v[132:133], v23 offset:49152
    ds_read_b64_tr_b16 v[134:135], v23 offset:49664
    s_waitcnt lgkmcnt(14)
    v_mfma_f32_32x32x16_bf16 v[96:111], v[136:139], a[212:215], v[96:111]
    s_waitcnt lgkmcnt(12)
    v_mfma_f32_32x32x16_bf16 v[112:127], v[140:143], a[212:215], v[112:127]
    ds_read_b64_tr_b16 v[136:137], v22 offset:51200
    ds_read_b64_tr_b16 v[138:139], v22 offset:51712
    ds_read_b64_tr_b16 v[140:141], v23 offset:51200
    ds_read_b64_tr_b16 v[142:143], v23 offset:51712
    s_waitcnt lgkmcnt(14)
    v_mfma_f32_32x32x16_bf16 v[96:111], v[144:147], a[216:219], v[96:111]
    s_waitcnt lgkmcnt(12)
    v_mfma_f32_32x32x16_bf16 v[112:127], v[148:151], a[216:219], v[112:127]
    ds_read_b64_tr_b16 v[144:145], v22 offset:53248
    ds_read_b64_tr_b16 v[146:147], v22 offset:53760
    ds_read_b64_tr_b16 v[148:149], v23 offset:53248
    ds_read_b64_tr_b16 v[150:151], v23 offset:53760
    s_waitcnt lgkmcnt(14)
    v_mfma_f32_32x32x16_bf16 v[96:111], v[152:155], a[220:223], v[96:111]
    s_waitcnt lgkmcnt(12)
    v_mfma_f32_32x32x16_bf16 v[112:127], v[156:159], a[220:223], v[112:127]
    ds_read_b64_tr_b16 v[152:153], v22 offset:55296
    ds_read_b64_tr_b16 v[154:155], v22 offset:55808
    ds_read_b64_tr_b16 v[156:157], v23 offset:55296
    ds_read_b64_tr_b16 v[158:159], v23 offset:55808
    s_waitcnt lgkmcnt(14)
    v_mfma_f32_32x32x16_bf16 v[96:111], v[128:131], a[224:227], v[96:111]
    s_waitcnt lgkmcnt(12)
    v_mfma_f32_32x32x16_bf16 v[112:127], v[132:135], a[224:227], v[112:127]
    ds_read_b64_tr_b16 v[128:129], v22 offset:57344
    ds_read_b64_tr_b16 v[130:131], v22 offset:57856
    ds_read_b64_tr_b16 v[132:133], v23 offset:57344
    ds_read_b64_tr_b16 v[134:135], v23 offset:57856
    s_waitcnt lgkmcnt(14)
    v_mfma_f32_32x32x16_bf16 v[96:111], v[136:139], a[228:231], v[96:111]
    s_waitcnt lgkmcnt(12)
    v_mfma_f32_32x32x16_bf16 v[112:127], v[140:143], a[228:231], v[112:127]
    ds_read_b64_tr_b16 v[136:137], v22 offset:59392
    ds_read_b64_tr_b16 v[138:139], v22 offset:59904
    ds_read_b64_tr_b16 v[140:141], v23 offset:59392
    ds_read_b64_tr_b16 v[142:143], v23 offset:59904
    s_waitcnt lgkmcnt(14)
    v_mfma_f32_32x32x16_bf16 v[96:111], v[144:147], a[232:235], v[96:111]
    s_waitcnt lgkmcnt(12)
    v_mfma_f32_32x32x16_bf16 v[112:127], v[148:151], a[232:235], v[112:127]
    ds_read_b64_tr_b16 v[144:145], v22 offset:61440
    ds_read_b64_tr_b16 v[146:147], v22 offset:61952
    ds_read_b64_tr_b16 v[148:149], v23 offset:61440
    ds_read_b64_tr_b16 v[150:151], v23 offset:61952
    s_waitcnt lgkmcnt(14)
    v_mfma_f32_32x32x16_bf16 v[96:111], v[152:155], a[236:239], v[96:111]
    s_waitcnt lgkmcnt(12)
    v_mfma_f32_32x32x16_bf16 v[112:127], v[156:159], a[236:239], v[112:127]
    ds_read_b64_tr_b16 v[152:153], v22 offset:63488
    ds_read_b64_tr_b16 v[154:155], v22 offset:64000
    ds_read_b64_tr_b16 v[156:157], v23 offset:63488
    ds_read_b64_tr_b16 v[158:159], v23 offset:64000
    s_waitcnt lgkmcnt(14)
    v_mfma_f32_32x32x16_bf16 v[96:111], v[128:131], a[240:243], v[96:111]
    s_waitcnt lgkmcnt(12)
    v_mfma_f32_32x32x16_bf16 v[112:127], v[132:135], a[240:243], v[112:127]
    s_waitcnt lgkmcnt(10)
    v_mfma_f32_32x32x16_bf16 v[96:111], v[136:139], a[244:247], v[96:111]
    s_waitcnt lgkmcnt(8)
    v_mfma_f32_32x32x16_bf16 v[112:127], v[140:143], a[244:247], v[112:127]
    s_waitcnt lgkmcnt(6)
    v_mfma_f32_32x32x16_bf16 v[96:111], v[144:147], a[248:251], v[96:111]
    s_waitcnt lgkmcnt(4)
    v_mfma_f32_32x32x16_bf16 v[112:127], v[148:151], a[248:251], v[112:127]
    s_waitcnt lgkmcnt(2)
    v_mfma_f32_32x32x16_bf16 v[96:111], v[152:155], a[252:255], v[96:111]
    s_waitcnt lgkmcnt(0)
    v_mfma_f32_32x32x16_bf16 v[112:127], v[156:159], a[252:255], v[112:127]
    s_barrier
    s_mul_i32 s69, s79, 5632
    s_add_u32 s69, s69, 524288
    s_add_u32 s68, s69, 4096
    buffer_load_dwordx2 v[224:225], v25, s[48:51], s69 offen offset:0 sc1
    buffer_load_dwordx2 v[226:227], v25, s[48:51], s69 offen offset:512 sc1
    buffer_load_dwordx2 v[228:229], v25, s[48:51], s69 offen offset:1024 sc1
    buffer_load_dwordx2 v[230:231], v25, s[48:51], s69 offen offset:1536 sc1
    buffer_load_dwordx2 v[232:233], v25, s[48:51], s69 offen offset:2048 sc1
    buffer_load_dwordx2 v[234:235], v25, s[48:51], s69 offen offset:2560 sc1
    buffer_load_dwordx2 v[236:237], v25, s[48:51], s69 offen offset:3072 sc1
    buffer_load_dwordx2 v[238:239], v25, s[48:51], s69 offen offset:3584 sc1
    buffer_load_dwordx2 v[240:241], v25, s[48:51], s68 offen offset:0 sc1
    buffer_load_dwordx2 v[242:243], v25, s[48:51], s68 offen offset:512 sc1
    buffer_load_dwordx2 v[244:245], v25, s[48:51], s68 offen offset:1024 sc1
    s_sub_u32 s68, s58, 8
    s_lshl_b32 s68, s68, 12
    s_add_u32 s68, s68, 8388608
    s_mul_i32 s77, s79, 32768
    s_add_u32 s77, s77, s68
    s_add_u32 s78, s77, 2048
    v_pk_mul_f32 v[160:161], v[96:97], s[100:101]
    v_pk_mul_f32 v[162:163], v[98:99], s[100:101]
    v_pk_mul_f32 v[164:165], v[100:101], s[100:101]
    v_pk_mul_f32 v[166:167], v[102:103], s[100:101]
    v_exp_f32_e64 v160, v160 clamp
    v_exp_f32_e64 v161, v161 clamp
    v_exp_f32_e64 v162, v162 clamp
    v_exp_f32_e64 v163, v163 clamp
L_pad_roleB_1:
    s_cbranch_execz L_hopret
    v_exp_f32_e64 v164, v164 clamp
    v_exp_f32_e64 v165, v165 clamp
    v_exp_f32_e64 v166, v166 clamp
    v_exp_f32_e64 v167, v167 clamp
    v_max_f32 v96, s83, v96
    v_max_f32 v97, s83, v97
    v_max_f32 v98, s83, v98
    v_max_f32 v99, s83, v99
    v_max_f32 v100, s83, v100
    v_max_f32 v101, s83, v101
    v_max_f32 v102, s83, v102
    v_max_f32 v103, s83, v103
    v_pk_add_f32 v[96:97], v[96:97], v[160:161]
    v_pk_add_f32 v[98:99], v[98:99], v[162:163]
    v_pk_add_f32 v[100:101], v[100:101], v[164:165]
    v_pk_add_f32 v[102:103], v[102:103], v[166:167]
    v_cvt_pk_bf16_f32 v208, v96, v97
    v_cvt_pk_bf16_f32 v209, v98, v99
    v_cvt_pk_bf16_f32 v210, v100, v101
    v_cvt_pk_bf16_f32 v211, v102, v103
    buffer_store_dwordx4 v[208:211], v24, s[48:51], s77 offen offset:0 sc1
    v_pk_mul_f32 v[160:161], v[104:105], s[100:101]
    v_pk_mul_f32 v[162:163], v[106:107], s[100:101]
    v_pk_mul_f32 v[164:165], v[108:109], s[100:101]
    v_pk_mul_f32 v[166:167], v[110:111], s[100:101]
    v_exp_f32_e64 v160, v160 clamp
    v_exp_f32_e64 v161, v161 clamp
    v_exp_f32_e64 v162, v162 clamp
    v_exp_f32_e64 v163, v163 clamp
    v_exp_f32_e64 v164, v164 clamp
    v_exp_f32_e64 v165, v165 clamp
    v_exp_f32_e64 v166, v166 clamp
    v_exp_f32_e64 v167, v167 clamp
    v_max_f32 v104, s83, v104
    v_max_f32 v105, s83, v105
    v_max_f32 v106, s83, v106
    v_max_f32 v107, s83, v107
    v_max_f32 v108, s83, v108
    v_max_f32 v109, s83, v109
    v_max_f32 v110, s83, v110
    v_max_f32 v111, s83, v111
    v_pk_add_f32 v[104:105], v[104:105], v[160:161]
    v_pk_add_f32 v[106:107], v[106:107], v[162:163]
    v_pk_add_f32 v[108:109], v[108:109], v[164:165]
    v_pk_add_f32 v[110:111], v[110:111], v[166:167]
    v_cvt_pk_bf16_f32 v212, v104, v105
    v_cvt_pk_bf16_f32 v213, v106, v107
    v_cvt_pk_bf16_f32 v214, v108, v109
    v_cvt_pk_bf16_f32 v215, v110, v111
    buffer_store_dwordx4 v[212:215], v24, s[48:51], s77 offen offset:1024 sc1
    v_pk_mul_f32 v[160:161], v[112:113], s[100:101]
    v_pk_mul_f32 v[162:163], v[114:115], s[100:101]
    v_pk_mul_f32 v[164:165], v[116:117], s[100:101]
    v_pk_mul_f32 v[166:167], v[118:119], s[100:101]
    v_exp_f32_e64 v160, v160 clamp
    v_exp_f32_e64 v161, v161 clamp
    v_exp_f32_e64 v162, v162 clamp
    v_exp_f32_e64 v163, v163 clamp
    v_exp_f32_e64 v164, v164 clamp
    v_exp_f32_e64 v165, v165 clamp
    v_exp_f32_e64 v166, v166 clamp
    v_exp_f32_e64 v167, v167 clamp
    v_max_f32 v112, s83, v112
    v_max_f32 v113, s83, v113
    v_max_f32 v114, s83, v114
    v_max_f32 v115, s83, v115
    v_max_f32 v116, s83, v116
    v_max_f32 v117, s83, v117
    v_max_f32 v118, s83, v118
    v_max_f32 v119, s83, v119
    v_pk_add_f32 v[112:113], v[112:113], v[160:161]
    v_pk_add_f32 v[114:115], v[114:115], v[162:163]
    v_pk_add_f32 v[116:117], v[116:117], v[164:165]
    v_pk_add_f32 v[118:119], v[118:119], v[166:167]
    v_cvt_pk_bf16_f32 v216, v112, v113
    v_cvt_pk_bf16_f32 v217, v114, v115
    v_cvt_pk_bf16_f32 v218, v116, v117
    v_cvt_pk_bf16_f32 v219, v118, v119
    buffer_store_dwordx4 v[216:219], v24, s[48:51], s78 offen offset:0 sc1
    v_pk_mul_f32 v[160:161], v[120:121], s[100:101]
    v_pk_mul_f32 v[162:163], v[122:123], s[100:101]
    v_pk_mul_f32 v[164:165], v[124:125], s[100:101]
    v_pk_mul_f32 v[166:167], v[126:127], s[100:101]
    v_exp_f32_e64 v160, v160 clamp
    v_exp_f32_e64 v161, v161 clamp
    v_exp_f32_e64 v162, v162 clamp
    v_exp_f32_e64 v163, v163 clamp
    v_exp_f32_e64 v164, v164 clamp
    v_exp_f32_e64 v165, v165 clamp
    v_exp_f32_e64 v166, v166 clamp
    v_exp_f32_e64 v167, v167 clamp
    v_max_f32 v120, s83, v120
    v_max_f32 v121, s83, v121
    v_max_f32 v122, s83, v122
    v_max_f32 v123, s83, v123
    v_max_f32 v124, s83, v124
    v_max_f32 v125, s83, v125
    v_max_f32 v126, s83, v126
    v_max_f32 v127, s83, v127
    v_pk_add_f32 v[120:121], v[120:121], v[160:161]
    v_pk_add_f32 v[122:123], v[122:123], v[162:163]
    v_pk_add_f32 v[124:125], v[124:125], v[164:165]
    v_pk_add_f32 v[126:127], v[126:127], v[166:167]
    v_cvt_pk_bf16_f32 v220, v120, v121
    v_cvt_pk_bf16_f32 v221, v122, v123
    v_cvt_pk_bf16_f32 v222, v124, v125
    v_cvt_pk_bf16_f32 v223, v126, v127
    buffer_store_dwordx4 v[220:223], v24, s[48:51], s78 offen offset:1024 sc1
    s_waitcnt vmcnt(12)
    v_min3_u32 v160, v225, v227, v229
    v_max3_u32 v161, v225, v227, v229
    s_waitcnt vmcnt(10)
    v_min3_u32 v160, v160, v231, v233
    v_max3_u32 v161, v161, v231, v233
    s_waitcnt vmcnt(8)
    v_min3_u32 v160, v160, v235, v237
    v_max3_u32 v161, v161, v235, v237
    s_waitcnt vmcnt(6)
    v_min3_u32 v160, v160, v239, v241
    v_max3_u32 v161, v161, v239, v241
    s_waitcnt vmcnt(4)
    v_min3_u32 v160, v160, v243, v245
    v_max3_u32 v161, v161, v243, v245
    v_xor_b32 v160, s61, v160
    v_xor_b32 v161, s61, v161
    v_or_b32 v160, v160, v161
    v_cmp_ne_u32 vcc, 0, v160
    s_nop 0
    s_cbranch_vccnz ZS_4
ZC_3:
    v_add_f32 v160, v224, v226
    v_add_f32 v161, v228, v230
    v_add_f32 v160, v160, v232
    v_add_f32 v161, v161, v234
    v_add_f32 v160, v160, v236
    v_add_f32 v161, v161, v238
    v_add_f32 v160, v160, v240
    v_add_f32 v161, v161, v242
    v_add_f32 v160, v160, v244
    v_add_f32 v160, v160, v161
    v_mov_b32 v161, v160
    s_nop 1
    v_permlane32_swap_b32 v160, v161
    v_mul_f32 v160, 0x3abe82fa, v160
    v_mul_f32 v161, 0x3abe82fa, v161
    v_fma_f32 v161, -v160, v160, v161
    v_max_f32 v161, 0, v161
    v_add_f32 v161, 0x3727c5ac, v161
    v_rsq_f32 v161, v161
    s_nop 0
    v_mul_f32 v160, v160, v161
    v_sub_f32 v160, 0, v160
    v_fma_f32 v64, v64, v161, v160
    v_fma_f32 v65, v65, v161, v160
    v_fma_f32 v66, v66, v161, v160
    v_fma_f32 v67, v67, v161, v160
    v_cvt_pk_bf16_f32 v208, v64, v65
    v_cvt_pk_bf16_f32 v209, v66, v67
    ds_write_b64 v37, v[208:209]
    v_fma_f32 v68, v68, v161, v160
    v_fma_f32 v69, v69, v161, v160
    v_fma_f32 v70, v70, v161, v160
    v_fma_f32 v71, v71, v161, v160
    v_cvt_pk_bf16_f32 v210, v68, v69
    v_cvt_pk_bf16_f32 v211, v70, v71
    v_xor_b32 v163, 16, v37
    ds_write_b64 v163, v[210:211]
    v_fma_f32 v72, v72, v161, v160
    v_fma_f32 v73, v73, v161, v160
    v_fma_f32 v74, v74, v161, v160
    v_fma_f32 v75, v75, v161, v160
    v_cvt_pk_bf16_f32 v212, v72, v73
    v_cvt_pk_bf16_f32 v213, v74, v75
    v_xor_b32 v163, 32, v37
    ds_write_b64 v163, v[212:213]
    v_fma_f32 v76, v76, v161, v160
    v_fma_f32 v77, v77, v161, v160
    v_fma_f32 v78, v78, v161, v160
    v_fma_f32 v79, v79, v161, v160
    v_cvt_pk_bf16_f32 v214, v76, v77
    v_cvt_pk_bf16_f32 v215, v78, v79
    v_xor_b32 v163, 48, v37
    ds_write_b64 v163, v[214:215]
    v_fma_f32 v80, v80, v161, v160
    v_fma_f32 v81, v81, v161, v160
    v_fma_f32 v82, v82, v161, v160
    v_fma_f32 v83, v83, v161, v160
    v_cvt_pk_bf16_f32 v216, v80, v81
    v_cvt_pk_bf16_f32 v217, v82, v83
    v_xor_b32 v163, 64, v37
    ds_write_b64 v163, v[216:217]
    v_fma_f32 v84, v84, v161, v160
    v_fma_f32 v85, v85, v161, v160
    v_fma_f32 v86, v86, v161, v160
    v_fma_f32 v87, v87, v161, v160
    v_cvt_pk_bf16_f32 v218, v84, v85
    v_cvt_pk_bf16_f32 v219, v86, v87
    v_xor_b32 v163, 80, v37
    ds_write_b64 v163, v[218:219]
    v_fma_f32 v88, v88, v161, v160
    v_fma_f32 v89, v89, v161, v160
    v_fma_f32 v90, v90, v161, v160
    v_fma_f32 v91, v91, v161, v160
    v_cvt_pk_bf16_f32 v220, v88, v89
    v_cvt_pk_bf16_f32 v221, v90, v91
    v_xor_b32 v163, 96, v37
    ds_write_b64 v163, v[220:221]
    v_fma_f32 v92, v92, v161, v160
    v_fma_f32 v93, v93, v161, v160
    v_fma_f32 v94, v94, v161, v160
    v_fma_f32 v95, v95, v161, v160
    v_cvt_pk_bf16_f32 v222, v92, v93
    v_cvt_pk_bf16_f32 v223, v94, v95
    v_xor_b32 v163, 112, v37
    ds_write_b64 v163, v[222:223]
    s_waitcnt lgkmcnt(0)
    ds_read_b64_tr_b16 v[176:177], v60 offset:0
    ds_read_b64_tr_b16 v[178:179], v61 offset:512
    ds_read_b64_tr_b16 v[180:181], v60 offset:2048
    ds_read_b64_tr_b16 v[182:183], v61 offset:2560
    ds_read_b64_tr_b16 v[184:185], v62 offset:0
    ds_read_b64_tr_b16 v[186:187], v63 offset:512
    ds_read_b64_tr_b16 v[188:189], v62 offset:2048
    ds_read_b64_tr_b16 v[190:191], v63 offset:2560
    s_lshl_b32 s64, s58, 18
    s_lshl_b32 s65, s79, 11
    s_add_u32 s64, s64, s65
    s_add_u32 s64, s64, 2097152
    s_add_u32 s65, s64, 131072
    s_waitcnt lgkmcnt(6)
    buffer_store_dwordx4 v[176:179], v24, s[48:51], s64 offen offset:0 sc1
    s_waitcnt lgkmcnt(4)
    buffer_store_dwordx4 v[180:183], v24, s[48:51], s64 offen offset:1024 sc1
    s_waitcnt lgkmcnt(2)
    buffer_store_dwordx4 v[184:187], v24, s[48:51], s65 offen offset:0 sc1
    s_waitcnt lgkmcnt(0)
    buffer_store_dwordx4 v[188:191], v24, s[48:51], s65 offen offset:1024 sc1
    s_barrier
    v_subrev_u32 v22, 98304, v22
    v_subrev_u32 v23, 98304, v23
    ds_read_b64_tr_b16 v[128:129], v22 offset:0
    ds_read_b64_tr_b16 v[130:131], v22 offset:512
    ds_read_b64_tr_b16 v[132:133], v23 offset:0
    ds_read_b64_tr_b16 v[134:135], v23 offset:512
    ds_read_b64_tr_b16 v[136:137], v22 offset:2048
    s_waitcnt lgkmcnt(3)
    v_mfma_f32_32x32x16_bf16 v[96:111], v[128:131], a[128:131], 0
    ds_read_b64_tr_b16 v[138:139], v22 offset:2560
    ds_read_b64_tr_b16 v[140:141], v23 offset:2048
    ds_read_b64_tr_b16 v[142:143], v23 offset:2560
    ds_read_b64_tr_b16 v[144:145], v22 offset:4096
    ds_read_b64_tr_b16 v[146:147], v22 offset:4608
    s_waitcnt lgkmcnt(6)
    v_mfma_f32_32x32x16_bf16 v[112:127], v[132:135], a[128:131], 0
    ds_read_b64_tr_b16 v[148:149], v23 offset:4096
    ds_read_b64_tr_b16 v[150:151], v23 offset:4608
    s_add_u32 m0, s37, 0
    s_nop 0
    buffer_load_dwordx4 v40, s[4:7], s17 offen offset:0 lds
    ds_read_b64_tr_b16 v[152:153], v22 offset:6144
    s_waitcnt lgkmcnt(7)
    v_mfma_f32_32x32x16_bf16 v[96:111], v[136:139], a[132:135], v[96:111]
    ds_read_b64_tr_b16 v[154:155], v22 offset:6656
    ds_read_b64_tr_b16 v[156:157], v23 offset:6144
    ds_read_b64_tr_b16 v[158:159], v23 offset:6656
    buffer_load_dwordx4 v41, s[4:7], s17 offen offset:1024 lds
    ds_read_b64_tr_b16 v[128:129], v22 offset:8192
    s_waitcnt lgkmcnt(9)
    v_mfma_f32_32x32x16_bf16 v[112:127], v[140:143], a[132:135], v[112:127]
    ds_read_b64_tr_b16 v[130:131], v22 offset:8704
    ds_read_b64_tr_b16 v[132:133], v23 offset:8192
    ds_read_b64_tr_b16 v[134:135], v23 offset:8704
    s_mul_i32 s70, s60, 3
    s_min_u32 s70, s70, 20
    s_waitcnt lgkmcnt(10)
    v_mfma_f32_32x32x16_bf16 v[96:111], v[144:147], a[136:139], v[96:111]
    s_cmp_lt_u32 s60, 6
    s_cselect_b32 s71, 3, 2
    s_add_u32 s66, s70, s71
    s_sub_u32 s67, s66, 1
    s_mov_b32 s64, 0
    s_waitcnt lgkmcnt(8)
    v_mfma_f32_32x32x16_bf16 v[112:127], v[148:151], a[136:139], v[112:127]
    s_add_u32 s88, s70, s64
    s_cmp_ge_u32 s88, s66
    s_cselect_b32 s65, s71, 0
    s_sub_u32 s88, s88, s65
    s_add_u32 s89, s70, s64
    s_waitcnt lgkmcnt(6)
    v_mfma_f32_32x32x16_bf16 v[96:111], v[152:155], a[140:143], v[96:111]
    s_add_u32 s89, s89, 1
    s_cmp_ge_u32 s89, s66
    s_cselect_b32 s65, s71, 0
    s_sub_u32 s89, s89, s65
    s_add_u32 s90, s70, s64
    s_waitcnt lgkmcnt(4)
    v_mfma_f32_32x32x16_bf16 v[112:127], v[156:159], a[140:143], v[112:127]
    s_add_u32 s90, s90, 2
    s_cmp_ge_u32 s90, s66
    s_cselect_b32 s65, s71, 0
    s_sub_u32 s90, s90, s65
    s_lshr_b32 s64, s70, 1
    s_waitcnt lgkmcnt(2)
    v_mfma_f32_32x32x16_bf16 v[96:111], v[128:131], a[144:147], v[96:111]
    s_lshr_b32 s65, s67, 1
    s_sub_u32 s65, s65, s64
    v_bfe_u32 v1, v0, 3, 2
    v_bfe_u32 v2, v0, 2, 1
    v_mul_u32_u24 v2, s65, v2
    s_waitcnt lgkmcnt(0)
    v_mfma_f32_32x32x16_bf16 v[112:127], v[132:135], a[144:147], v[112:127]
    v_lshl_add_u32 v1, v1, 4, v2
    s_lshl_b32 s66, s56, 6
    s_add_u32 s66, s66, s64
    v_add_u32 v1, s66, v1
    v_and_b32 v2, 3, v0
    v_lshl_add_u32 v1, v1, 2, v2
    v_and_b32 v2, 3, v1
    v_lshrrev_b32 v1, 2, v1
    v_lshlrev_b32 v1, 4, v1
    v_add_lshl_u32 v8, v1, v2, 2
    buffer_load_dwordx4 v42, s[4:7], s17 offen offset:2048 lds
    ds_read_b64_tr_b16 v[136:137], v22 offset:10240
    ds_read_b64_tr_b16 v[138:139], v22 offset:10752
    s_waitcnt lgkmcnt(0)
    v_mfma_f32_32x32x16_bf16 v[96:111], v[136:139], a[148:151], v[96:111]
    ds_read_b64_tr_b16 v[140:141], v23 offset:10240
    ds_read_b64_tr_b16 v[142:143], v23 offset:10752
    buffer_load_dwordx4 v43, s[4:7], s17 offen offset:3072 lds
    ds_read_b64_tr_b16 v[144:145], v22 offset:12288
    ds_read_b64_tr_b16 v[146:147], v22 offset:12800
    s_waitcnt lgkmcnt(2)
    v_mfma_f32_32x32x16_bf16 v[112:127], v[140:143], a[148:151], v[112:127]
    ds_read_b64_tr_b16 v[148:149], v23 offset:12288
    ds_read_b64_tr_b16 v[150:151], v23 offset:12800
    s_add_u32 s12, s17, 131072
    s_add_u32 m0, s37, 4096
    s_nop 0
    buffer_load_dwordx4 v40, s[4:7], s12 offen offset:0 lds
    s_waitcnt lgkmcnt(2)
    v_mfma_f32_32x32x16_bf16 v[96:111], v[144:147], a[152:155], v[96:111]
    ds_read_b64_tr_b16 v[152:153], v22 offset:14336
    ds_read_b64_tr_b16 v[154:155], v22 offset:14848
    ds_read_b64_tr_b16 v[156:157], v23 offset:14336
    ds_read_b64_tr_b16 v[158:159], v23 offset:14848
    buffer_load_dwordx4 v41, s[4:7], s12 offen offset:1024 lds
    s_waitcnt lgkmcnt(4)
    v_mfma_f32_32x32x16_bf16 v[112:127], v[148:151], a[152:155], v[112:127]
    ds_read_b64_tr_b16 v[128:129], v22 offset:16384
    ds_read_b64_tr_b16 v[130:131], v22 offset:16896
    ds_read_b64_tr_b16 v[132:133], v23 offset:16384
    ds_read_b64_tr_b16 v[134:135], v23 offset:16896
    buffer_load_dwordx4 v42, s[4:7], s12 offen offset:2048 lds
    s_waitcnt lgkmcnt(6)
    v_mfma_f32_32x32x16_bf16 v[96:111], v[152:155], a[156:159], v[96:111]
    ds_read_b64_tr_b16 v[136:137], v22 offset:18432
    ds_read_b64_tr_b16 v[138:139], v22 offset:18944
    ds_read_b64_tr_b16 v[140:141], v23 offset:18432
    ds_read_b64_tr_b16 v[142:143], v23 offset:18944
    buffer_load_dwordx4 v43, s[4:7], s12 offen offset:3072 lds
    s_waitcnt lgkmcnt(8)
    v_mfma_f32_32x32x16_bf16 v[112:127], v[156:159], a[156:159], v[112:127]
    ds_read_b64_tr_b16 v[144:145], v22 offset:20480
    ds_read_b64_tr_b16 v[146:147], v22 offset:20992
    ds_read_b64_tr_b16 v[148:149], v23 offset:20480
    ds_read_b64_tr_b16 v[150:151], v23 offset:20992
    s_add_u32 m0, s37, 8192
    s_waitcnt lgkmcnt(10)
    v_mfma_f32_32x32x16_bf16 v[96:111], v[128:131], a[160:163], v[96:111]
    buffer_load_dwordx4 v40, s[4:7], s22 offen offset:0 lds
    ds_read_b64_tr_b16 v[152:153], v22 offset:22528
    ds_read_b64_tr_b16 v[154:155], v22 offset:23040
    ds_read_b64_tr_b16 v[156:157], v23 offset:22528
    ds_read_b64_tr_b16 v[158:159], v23 offset:23040
    s_waitcnt lgkmcnt(12)
    v_mfma_f32_32x32x16_bf16 v[112:127], v[132:135], a[160:163], v[112:127]
    buffer_load_dwordx4 v41, s[4:7], s22 offen offset:1024 lds
    ds_read_b64_tr_b16 v[128:129], v22 offset:24576
    ds_read_b64_tr_b16 v[130:131], v22 offset:25088
    ds_read_b64_tr_b16 v[132:133], v23 offset:24576
    ds_read_b64_tr_b16 v[134:135], v23 offset:25088
    s_waitcnt lgkmcnt(14)
    v_mfma_f32_32x32x16_bf16 v[96:111], v[136:139], a[164:167], v[96:111]
    s_waitcnt lgkmcnt(12)
    v_mfma_f32_32x32x16_bf16 v[112:127], v[140:143], a[164:167], v[112:127]
    buffer_load_dwordx4 v42, s[4:7], s22 offen offset:2048 lds
    ds_read_b64_tr_b16 v[136:137], v22 offset:26624
    ds_read_b64_tr_b16 v[138:139], v22 offset:27136
    ds_read_b64_tr_b16 v[140:141], v23 offset:26624
    ds_read_b64_tr_b16 v[142:143], v23 offset:27136
    s_waitcnt lgkmcnt(14)
    v_mfma_f32_32x32x16_bf16 v[96:111], v[144:147], a[168:171], v[96:111]
    s_waitcnt lgkmcnt(12)
    v_mfma_f32_32x32x16_bf16 v[112:127], v[148:151], a[168:171], v[112:127]
    buffer_load_dwordx4 v43, s[4:7], s22 offen offset:3072 lds
    ds_read_b64_tr_b16 v[144:145], v22 offset:28672
    ds_read_b64_tr_b16 v[146:147], v22 offset:29184
    ds_read_b64_tr_b16 v[148:149], v23 offset:28672
    ds_read_b64_tr_b16 v[150:151], v23 offset:29184
    s_waitcnt lgkmcnt(14)
    v_mfma_f32_32x32x16_bf16 v[96:111], v[152:155], a[172:175], v[96:111]
    s_waitcnt lgkmcnt(12)
    v_mfma_f32_32x32x16_bf16 v[112:127], v[156:159], a[172:175], v[112:127]
    s_waitcnt vmcnt(12)
    s_lshl4_add_u32 s64, s57, s58
    s_lshl4_add_u32 s64, s64, s56
    s_lshl_b32 s64, s64, 2
    s_add_u32 s64, s64, 65536
    v_mov_b32 v30, s61
    s_waitcnt lgkmcnt(10)
    v_mfma_f32_32x32x16_bf16 v[96:111], v[128:131], a[176:179], v[96:111]
    buffer_store_dword v30, off, s[48:51], s64 sc1
    s_add_u32 s12, s22, 131072
    s_add_u32 m0, s37, 12288
    s_nop 0
    buffer_load_dwordx4 v40, s[4:7], s12 offen offset:0 lds
    ds_read_b64_tr_b16 v[152:153], v22 offset:30720
    s_waitcnt lgkmcnt(9)
    v_mfma_f32_32x32x16_bf16 v[112:127], v[132:135], a[176:179], v[112:127]
    ds_read_b64_tr_b16 v[154:155], v22 offset:31232
    ds_read_b64_tr_b16 v[156:157], v23 offset:30720
    ds_read_b64_tr_b16 v[158:159], v23 offset:31232
    buffer_load_dwordx4 v41, s[4:7], s12 offen offset:1024 lds
    ds_read_b64_tr_b16 v[128:129], v22 offset:32768
    s_waitcnt lgkmcnt(11)
    v_mfma_f32_32x32x16_bf16 v[96:111], v[136:139], a[180:183], v[96:111]
    ds_read_b64_tr_b16 v[130:131], v22 offset:33280
    ds_read_b64_tr_b16 v[132:133], v23 offset:32768
    ds_read_b64_tr_b16 v[134:135], v23 offset:33280
    s_waitcnt lgkmcnt(12)
    v_mfma_f32_32x32x16_bf16 v[112:127], v[140:143], a[180:183], v[112:127]
    buffer_load_dwordx4 v42, s[4:7], s12 offen offset:2048 lds
    ds_read_b64_tr_b16 v[136:137], v22 offset:34816
    ds_read_b64_tr_b16 v[138:139], v22 offset:35328
    ds_read_b64_tr_b16 v[140:141], v23 offset:34816
    ds_read_b64_tr_b16 v[142:143], v23 offset:35328
    s_waitcnt lgkmcnt(14)
    v_mfma_f32_32x32x16_bf16 v[96:111], v[144:147], a[184:187], v[96:111]
    s_waitcnt lgkmcnt(12)
    v_mfma_f32_32x32x16_bf16 v[112:127], v[148:151], a[184:187], v[112:127]
    buffer_load_dwordx4 v43, s[4:7], s12 offen offset:3072 lds
    ds_read_b64_tr_b16 v[144:145], v22 offset:36864
    ds_read_b64_tr_b16 v[146:147], v22 offset:37376
    ds_read_b64_tr_b16 v[148:149], v23 offset:36864
    ds_read_b64_tr_b16 v[150:151], v23 offset:37376
    s_waitcnt lgkmcnt(14)
    v_mfma_f32_32x32x16_bf16 v[96:111], v[152:155], a[188:191], v[96:111]
    s_waitcnt lgkmcnt(12)
    v_mfma_f32_32x32x16_bf16 v[112:127], v[156:159], a[188:191], v[112:127]
    ds_read_b64_tr_b16 v[152:153], v22 offset:38912
    ds_read_b64_tr_b16 v[154:155], v22 offset:39424
    ds_read_b64_tr_b16 v[156:157], v23 offset:38912
    ds_read_b64_tr_b16 v[158:159], v23 offset:39424
    s_waitcnt lgkmcnt(14)
    v_mfma_f32_32x32x16_bf16 v[96:111], v[128:131], a[192:195], v[96:111]
    s_waitcnt lgkmcnt(12)
    v_mfma_f32_32x32x16_bf16 v[112:127], v[132:135], a[192:195], v[112:127]
    ds_read_b64_tr_b16 v[128:129], v22 offset:40960
    ds_read_b64_tr_b16 v[130:131], v22 offset:41472
    ds_read_b64_tr_b16 v[132:133], v23 offset:40960
    ds_read_b64_tr_b16 v[134:135], v23 offset:41472
    s_waitcnt lgkmcnt(14)
    v_mfma_f32_32x32x16_bf16 v[96:111], v[136:139], a[196:199], v[96:111]
    s_waitcnt lgkmcnt(12)
    v_mfma_f32_32x32x16_bf16 v[112:127], v[140:143], a[196:199], v[112:127]
    ds_read_b64_tr_b16 v[136:137], v22 offset:43008
    ds_read_b64_tr_b16 v[138:139], v22 offset:43520
    ds_read_b64_tr_b16 v[140:141], v23 offset:43008
    ds_read_b64_tr_b16 v[142:143], v23 offset:43520
    s_waitcnt lgkmcnt(14)
    v_mfma_f32_32x32x16_bf16 v[96:111], v[144:147], a[200:203], v[96:111]
    s_waitcnt lgkmcnt(12)
    v_mfma_f32_32x32x16_bf16 v[112:127], v[148:151], a[200:203], v[112:127]
    ds_read_b64_tr_b16 v[144:145], v22 offset:45056
    ds_read_b64_tr_b16 v[146:147], v22 offset:45568
    ds_read_b64_tr_b16 v[148:149], v23 offset:45056
    ds_read_b64_tr_b16 v[150:151], v23 offset:45568
    s_waitcnt lgkmcnt(14)
    v_mfma_f32_32x32x16_bf16 v[96:111], v[152:155], a[204:207], v[96:111]
    s_waitcnt lgkmcnt(12)
    v_mfma_f32_32x32x16_bf16 v[112:127], v[156:159], a[204:207], v[112:127]
    ds_read_b128 a[0:3], v48 offset:0
    ds_read_b128 a[4:7], v48 offset:4096
    ds_read_b128 a[8:11], v49 offset:0
    ds_read_b128 a[12:15], v49 offset:4096
    ds_read_b128 a[16:19], v50 offset:0
    s_waitcnt lgkmcnt(14)
    v_mfma_f32_32x32x16_bf16 v[96:111], v[128:131], a[208:211], v[96:111]
    ds_read_b128 a[20:23], v50 offset:4096
    ds_read_b128 a[24:27], v51 offset:0
    ds_read_b128 a[28:31], v51 offset:4096
    ds_read_b64_tr_b16 v[152:153], v22 offset:47104
    ds_read_b64_tr_b16 v[154:155], v22 offset:47616
    s_waitcnt lgkmcnt(14)
    v_mfma_f32_32x32x16_bf16 v[112:127], v[132:135], a[208:211], v[112:127]
    ds_read_b64_tr_b16 v[156:157], v23 offset:47104
    ds_read_b64_tr_b16 v[158:159], v23 offset:47616
    s_waitcnt lgkmcnt(4)
    s_add_u32 m0, s36, 0
    s_nop 0
    buffer_load_dwordx4 v40, s[4:7], s23 offen offset:0 lds
    v_mfma_f32_32x32x16_bf16 v[96:111], v[136:139], a[212:215], v[96:111]
    ds_read_b64_tr_b16 v[128:129], v22 offset:49152
    ds_read_b64_tr_b16 v[130:131], v22 offset:49664
    ds_read_b64_tr_b16 v[132:133], v23 offset:49152
    ds_read_b64_tr_b16 v[134:135], v23 offset:49664
    v_mfma_f32_32x32x16_bf16 v[112:127], v[140:143], a[212:215], v[112:127]
    buffer_load_dwordx4 v41, s[4:7], s23 offen offset:1024 lds
    ds_read_b64_tr_b16 v[136:137], v22 offset:51200
    ds_read_b64_tr_b16 v[138:139], v22 offset:51712
    ds_read_b64_tr_b16 v[140:141], v23 offset:51200
    ds_read_b64_tr_b16 v[142:143], v23 offset:51712
    v_mfma_f32_32x32x16_bf16 v[96:111], v[144:147], a[216:219], v[96:111]
    v_mfma_f32_32x32x16_bf16 v[112:127], v[148:151], a[216:219], v[112:127]
    buffer_load_dwordx4 v42, s[4:7], s23 offen offset:2048 lds
    ds_read_b64_tr_b16 v[144:145], v22 offset:53248
    ds_read_b64_tr_b16 v[146:147], v22 offset:53760
    ds_read_b64_tr_b16 v[148:149], v23 offset:53248
    ds_read_b64_tr_b16 v[150:151], v23 offset:53760
    s_waitcnt lgkmcnt(14)
    v_mfma_f32_32x32x16_bf16 v[96:111], v[152:155], a[220:223], v[96:111]
    s_waitcnt lgkmcnt(12)
    v_mfma_f32_32x32x16_bf16 v[112:127], v[156:159], a[220:223], v[112:127]
    s_waitcnt vmcnt(12)
    ds_read_b128 a[32:35], v52 offset:0
    ds_read_b128 a[36:39], v52 offset:4096
    ds_read_b128 a[40:43], v53 offset:0
    ds_read_b128 a[44:47], v53 offset:4096
    ds_read_b128 a[48:51], v54 offset:0
    s_waitcnt lgkmcnt(14)
    v_mfma_f32_32x32x16_bf16 v[96:111], v[128:131], a[224:227], v[96:111]
    ds_read_b128 a[52:55], v54 offset:4096
    ds_read_b128 a[56:59], v55 offset:0
    ds_read_b128 a[60:63], v55 offset:4096
    buffer_load_dwordx4 v43, s[4:7], s23 offen offset:3072 lds
    ds_read_b64_tr_b16 v[152:153], v22 offset:55296
    s_waitcnt lgkmcnt(14)
    v_mfma_f32_32x32x16_bf16 v[112:127], v[132:135], a[224:227], v[112:127]
    ds_read_b64_tr_b16 v[154:155], v22 offset:55808
    ds_read_b64_tr_b16 v[156:157], v23 offset:55296
    ds_read_b64_tr_b16 v[158:159], v23 offset:55808
    s_waitcnt lgkmcnt(4)
    s_add_u32 s12, s23, 131072
    v_mfma_f32_32x32x16_bf16 v[96:111], v[136:139], a[228:231], v[96:111]
    s_add_u32 m0, s36, 4096
    s_nop 0
    buffer_load_dwordx4 v40, s[4:7], s12 offen offset:0 lds
    ds_read_b64_tr_b16 v[128:129], v22 offset:57344
    ds_read_b64_tr_b16 v[130:131], v22 offset:57856
    ds_read_b64_tr_b16 v[132:133], v23 offset:57344
    v_mfma_f32_32x32x16_bf16 v[112:127], v[140:143], a[228:231], v[112:127]
    ds_read_b64_tr_b16 v[134:135], v23 offset:57856
    buffer_load_dwordx4 v41, s[4:7], s12 offen offset:1024 lds
    ds_read_b64_tr_b16 v[136:137], v22 offset:59392
    ds_read_b64_tr_b16 v[138:139], v22 offset:59904
    ds_read_b64_tr_b16 v[140:141], v23 offset:59392
    v_mfma_f32_32x32x16_bf16 v[96:111], v[144:147], a[232:235], v[96:111]
    ds_read_b64_tr_b16 v[142:143], v23 offset:59904
    v_mfma_f32_32x32x16_bf16 v[112:127], v[148:151], a[232:235], v[112:127]
    buffer_load_dwordx4 v42, s[4:7], s12 offen offset:2048 lds
    ds_read_b64_tr_b16 v[144:145], v22 offset:61440
    ds_read_b64_tr_b16 v[146:147], v22 offset:61952
    ds_read_b64_tr_b16 v[148:149], v23 offset:61440
    ds_read_b64_tr_b16 v[150:151], v23 offset:61952
    s_waitcnt lgkmcnt(14)
    v_mfma_f32_32x32x16_bf16 v[96:111], v[152:155], a[236:239], v[96:111]
    s_waitcnt lgkmcnt(12)
    v_mfma_f32_32x32x16_bf16 v[112:127], v[156:159], a[236:239], v[112:127]
    s_waitcnt vmcnt(7)
    ds_read_b128 a[64:67], v56 offset:0
    ds_read_b128 a[68:71], v56 offset:4096
    ds_read_b128 a[72:75], v57 offset:0
    ds_read_b128 a[76:79], v57 offset:4096
    ds_read_b128 a[80:83], v58 offset:0
    s_waitcnt lgkmcnt(14)
    v_mfma_f32_32x32x16_bf16 v[96:111], v[128:131], a[240:243], v[96:111]
    ds_read_b128 a[84:87], v58 offset:4096
    ds_read_b128 a[88:91], v59 offset:0
    ds_read_b128 a[92:95], v59 offset:4096
    buffer_load_dwordx4 v43, s[4:7], s12 offen offset:3072 lds
    ds_read_b64_tr_b16 v[152:153], v22 offset:63488
    s_waitcnt lgkmcnt(14)
    v_mfma_f32_32x32x16_bf16 v[112:127], v[132:135], a[240:243], v[112:127]
    ds_read_b64_tr_b16 v[154:155], v22 offset:64000
    ds_read_b64_tr_b16 v[156:157], v23 offset:63488
    ds_read_b64_tr_b16 v[158:159], v23 offset:64000
    s_waitcnt lgkmcnt(4)
    s_add_u32 m0, s37, 0
    v_mfma_f32_32x32x16_bf16 v[96:111], v[136:139], a[244:247], v[96:111]
    buffer_load_dwordx4 v40, s[4:7], s26 offen offset:0 lds
    v_mfma_f32_32x32x16_bf16 v[112:127], v[140:143], a[244:247], v[112:127]
    buffer_load_dwordx4 v41, s[4:7], s26 offen offset:1024 lds
    v_mfma_f32_32x32x16_bf16 v[96:111], v[144:147], a[248:251], v[96:111]
    v_mfma_f32_32x32x16_bf16 v[112:127], v[148:151], a[248:251], v[112:127]
    buffer_load_dwordx4 v42, s[4:7], s26 offen offset:2048 lds
    s_waitcnt lgkmcnt(2)
    v_mfma_f32_32x32x16_bf16 v[96:111], v[152:155], a[252:255], v[96:111]
    s_waitcnt lgkmcnt(0)
    v_mfma_f32_32x32x16_bf16 v[112:127], v[156:159], a[252:255], v[112:127]
    s_sub_u32 s68, s58, 8
    s_lshl_b32 s68, s68, 12
L_pad_roleB_H:
L_pad_roleB_2:
    s_cbranch_execz L_pad_pg0_0
    s_add_u32 s68, s68, 5242880
    s_mul_i32 s77, s79, 45056
    s_add_u32 s77, s77, s68
    s_add_u32 s78, s77, 2048
    s_nop 3
    v_pk_mul_f32 v[160:161], v[96:97], v[96:97]
    v_pk_mul_f32 v[162:163], v[98:99], v[98:99]
    v_pk_mul_f32 v[164:165], v[100:101], v[100:101]
    v_pk_mul_f32 v[166:167], v[102:103], v[102:103]
    v_pk_fma_f32 v[160:161], v[160:161], s[62:63], v[38:39]
    v_pk_fma_f32 v[162:163], v[162:163], s[62:63], v[38:39]
    v_pk_fma_f32 v[164:165], v[164:165], s[62:63], v[38:39]
    v_pk_fma_f32 v[166:167], v[166:167], s[62:63], v[38:39]
    buffer_load_dwordx4 v43, s[4:7], s26 offen offset:3072 lds
    v_pk_mul_f32 v[160:161], v[160:161], v[96:97]
    v_pk_mul_f32 v[162:163], v[162:163], v[98:99]
    v_pk_mul_f32 v[164:165], v[164:165], v[100:101]
    v_pk_mul_f32 v[166:167], v[166:167], v[102:103]
    v_exp_f32 v160, v160
    v_exp_f32 v161, v161
    v_exp_f32 v162, v162
    v_exp_f32 v163, v163
    s_add_u32 s12, s26, 131072
    s_add_u32 m0, s37, 4096
    s_nop 0
    buffer_load_dwordx4 v40, s[4:7], s12 offen offset:0 lds
    v_exp_f32 v164, v164
    v_exp_f32 v165, v165
    v_exp_f32 v166, v166
    v_exp_f32 v167, v167
    v_pk_add_f32 v[160:161], v[160:161], s[84:85]
    v_pk_add_f32 v[162:163], v[162:163], s[84:85]
    v_pk_add_f32 v[164:165], v[164:165], s[84:85]
    v_pk_add_f32 v[166:167], v[166:167], s[84:85]
    buffer_load_dwordx4 v41, s[4:7], s12 offen offset:1024 lds
    v_rcp_f32 v160, v160
    v_rcp_f32 v161, v161
    v_rcp_f32 v162, v162
    v_rcp_f32 v163, v163
    v_rcp_f32 v164, v164
    v_rcp_f32 v165, v165
    v_rcp_f32 v166, v166
    v_rcp_f32 v167, v167
    buffer_load_dwordx4 v42, s[4:7], s12 offen offset:2048 lds
    v_pk_mul_f32 v[96:97], v[96:97], v[160:161]
    v_pk_mul_f32 v[98:99], v[98:99], v[162:163]
    v_pk_mul_f32 v[100:101], v[100:101], v[164:165]
    v_pk_mul_f32 v[102:103], v[102:103], v[166:167]
    v_cvt_pk_bf16_f32 v208, v96, v97
    v_cvt_pk_bf16_f32 v209, v98, v99
    v_cvt_pk_bf16_f32 v210, v100, v101
    v_cvt_pk_bf16_f32 v211, v102, v103
    buffer_load_dwordx4 v43, s[4:7], s12 offen offset:3072 lds
    buffer_store_dwordx4 v[208:211], v24, s[48:51], s77 offen offset:0 sc1
    v_pk_mul_f32 v[160:161], v[104:105], v[104:105]
    v_pk_mul_f32 v[162:163], v[106:107], v[106:107]
    v_pk_mul_f32 v[164:165], v[108:109], v[108:109]
    v_pk_mul_f32 v[166:167], v[110:111], v[110:111]
    v_pk_fma_f32 v[160:161], v[160:161], s[62:63], v[38:39]
    v_pk_fma_f32 v[162:163], v[162:163], s[62:63], v[38:39]
    v_pk_fma_f32 v[164:165], v[164:165], s[62:63], v[38:39]
    s_add_u32 m0, s37, 8192
    s_nop 0
    buffer_load_dwordx4 v40, s[4:7], s27 offen offset:0 lds
    v_pk_fma_f32 v[166:167], v[166:167], s[62:63], v[38:39]
    v_pk_mul_f32 v[160:161], v[160:161], v[104:105]
    v_pk_mul_f32 v[162:163], v[162:163], v[106:107]
    v_pk_mul_f32 v[164:165], v[164:165], v[108:109]
    v_pk_mul_f32 v[166:167], v[166:167], v[110:111]
    v_exp_f32 v160, v160
    v_exp_f32 v161, v161
    v_exp_f32 v162, v162
    buffer_load_dwordx4 v41, s[4:7], s27 offen offset:1024 lds
    v_exp_f32 v163, v163
    v_exp_f32 v164, v164
    v_exp_f32 v165, v165
    v_exp_f32 v166, v166
    v_exp_f32 v167, v167
    v_pk_add_f32 v[160:161], v[160:161], s[84:85]
    v_pk_add_f32 v[162:163], v[162:163], s[84:85]
    v_pk_add_f32 v[164:165], v[164:165], s[84:85]
    buffer_load_dwordx4 v42, s[4:7], s27 offen offset:2048 lds
    v_pk_add_f32 v[166:167], v[166:167], s[84:85]
    v_rcp_f32 v160, v160
    v_rcp_f32 v161, v161
    v_rcp_f32 v162, v162
    v_rcp_f32 v163, v163
    v_rcp_f32 v164, v164
    v_rcp_f32 v165, v165
    v_rcp_f32 v166, v166
    buffer_load_dwordx4 v43, s[4:7], s27 offen offset:3072 lds
    v_rcp_f32 v167, v167
    v_pk_mul_f32 v[104:105], v[104:105], v[160:161]
    v_pk_mul_f32 v[106:107], v[106:107], v[162:163]
    v_pk_mul_f32 v[108:109], v[108:109], v[164:165]
    v_pk_mul_f32 v[110:111], v[110:111], v[166:167]
    v_cvt_pk_bf16_f32 v212, v104, v105
    v_cvt_pk_bf16_f32 v213, v106, v107
    v_cvt_pk_bf16_f32 v214, v108, v109
    s_add_u32 s12, s27, 131072
    s_add_u32 m0, s37, 12288
    s_nop 0
    buffer_load_dwordx4 v40, s[4:7], s12 offen offset:0 lds
    v_cvt_pk_bf16_f32 v215, v110, v111
    buffer_store_dwordx4 v[212:215], v24, s[48:51], s77 offen offset:1024 sc1
    s_mov_b32 s97, 65536
    buffer_load_dword v14, v8, s[48:51], s97 offen sc1
    v_pk_mul_f32 v[160:161], v[112:113], v[112:113]
    v_pk_mul_f32 v[162:163], v[114:115], v[114:115]
    v_pk_mul_f32 v[164:165], v[116:117], v[116:117]
    v_pk_mul_f32 v[166:167], v[118:119], v[118:119]
    v_pk_fma_f32 v[160:161], v[160:161], s[62:63], v[38:39]
    v_pk_fma_f32 v[162:163], v[162:163], s[62:63], v[38:39]
    buffer_load_dwordx4 v41, s[4:7], s12 offen offset:1024 lds
    v_pk_fma_f32 v[164:165], v[164:165], s[62:63], v[38:39]
    v_pk_fma_f32 v[166:167], v[166:167], s[62:63], v[38:39]
    v_pk_mul_f32 v[160:161], v[160:161], v[112:113]
    v_pk_mul_f32 v[162:163], v[162:163], v[114:115]
    v_pk_mul_f32 v[164:165], v[164:165], v[116:117]
    v_pk_mul_f32 v[166:167], v[166:167], v[118:119]
    v_exp_f32 v160, v160
    v_exp_f32 v161, v161
    buffer_load_dwordx4 v42, s[4:7], s12 offen offset:2048 lds
    v_exp_f32 v162, v162
    v_exp_f32 v163, v163
    v_exp_f32 v164, v164
    v_exp_f32 v165, v165
    v_exp_f32 v166, v166
    v_exp_f32 v167, v167
    v_pk_add_f32 v[160:161], v[160:161], s[84:85]
    v_pk_add_f32 v[162:163], v[162:163], s[84:85]
    buffer_load_dwordx4 v43, s[4:7], s12 offen offset:3072 lds
    v_pk_add_f32 v[164:165], v[164:165], s[84:85]
    v_pk_add_f32 v[166:167], v[166:167], s[84:85]
    v_rcp_f32 v160, v160
    v_rcp_f32 v161, v161
    v_rcp_f32 v162, v162
    v_rcp_f32 v163, v163
    v_rcp_f32 v164, v164
    v_rcp_f32 v165, v165
    v_rcp_f32 v166, v166
    v_rcp_f32 v167, v167
    v_pk_mul_f32 v[112:113], v[112:113], v[160:161]
    v_pk_mul_f32 v[114:115], v[114:115], v[162:163]
    v_pk_mul_f32 v[116:117], v[116:117], v[164:165]
    v_pk_mul_f32 v[118:119], v[118:119], v[166:167]
    v_cvt_pk_bf16_f32 v216, v112, v113
    v_cvt_pk_bf16_f32 v217, v114, v115
    v_cvt_pk_bf16_f32 v218, v116, v117
    v_cvt_pk_bf16_f32 v219, v118, v119
    buffer_store_dwordx4 v[216:219], v24, s[48:51], s78 offen offset:0 sc1
    v_pk_mul_f32 v[160:161], v[120:121], v[120:121]
    v_pk_mul_f32 v[162:163], v[122:123], v[122:123]
    v_pk_mul_f32 v[164:165], v[124:125], v[124:125]
    v_pk_mul_f32 v[166:167], v[126:127], v[126:127]
    v_pk_fma_f32 v[160:161], v[160:161], s[62:63], v[38:39]
    v_pk_fma_f32 v[162:163], v[162:163], s[62:63], v[38:39]
    v_pk_fma_f32 v[164:165], v[164:165], s[62:63], v[38:39]
    v_pk_fma_f32 v[166:167], v[166:167], s[62:63], v[38:39]
    v_pk_mul_f32 v[160:161], v[160:161], v[120:121]
    v_pk_mul_f32 v[162:163], v[162:163], v[122:123]
    v_pk_mul_f32 v[164:165], v[164:165], v[124:125]
    v_pk_mul_f32 v[166:167], v[166:167], v[126:127]
    v_exp_f32 v160, v160
    v_exp_f32 v161, v161
    v_exp_f32 v162, v162
    v_exp_f32 v163, v163
    v_exp_f32 v164, v164
    v_exp_f32 v165, v165
    v_exp_f32 v166, v166
    v_exp_f32 v167, v167
    v_pk_add_f32 v[160:161], v[160:161], s[84:85]
    v_pk_add_f32 v[162:163], v[162:163], s[84:85]
    v_pk_add_f32 v[164:165], v[164:165], s[84:85]
    v_pk_add_f32 v[166:167], v[166:167], s[84:85]
    v_rcp_f32 v160, v160
    v_rcp_f32 v161, v161
    v_rcp_f32 v162, v162
    v_rcp_f32 v163, v163
    v_rcp_f32 v164, v164
    v_rcp_f32 v165, v165
    v_rcp_f32 v166, v166
    v_rcp_f32 v167, v167
    v_pk_mul_f32 v[120:121], v[120:121], v[160:161]
    v_pk_mul_f32 v[122:123], v[122:123], v[162:163]
    v_pk_mul_f32 v[124:125], v[124:125], v[164:165]
    v_pk_mul_f32 v[126:127], v[126:127], v[166:167]
    v_cvt_pk_bf16_f32 v220, v120, v121
    v_cvt_pk_bf16_f32 v221, v122, v123
    v_cvt_pk_bf16_f32 v222, v124, v125
    v_cvt_pk_bf16_f32 v223, v126, v127
    buffer_store_dwordx4 v[220:223], v24, s[48:51], s78 offen offset:1024 sc1
    s_waitcnt vmcnt(0)
    s_lshl4_add_u32 s64, s57, s58
    s_lshl4_add_u32 s64, s64, s56
    s_lshl_b32 s64, s64, 2
    s_add_u32 s64, s64, 131072
    v_mov_b32 v30, s61
    buffer_store_dword v30, off, s[48:51], s64 sc1
    s_branch L_p1_done
L_roleC:
L_pad_roleC_0:
    s_cbranch_execz L_pad_roleC_1
    v_lshrrev_b32 v1, 3, v0
    v_lshlrev_b32 v1, 12, v1
    v_and_b32 v2, 7, v0
    v_lshl_add_u32 v44, v2, 7, v1
    v_lshlrev_b32 v46, 10, v0
    v_mov_b32 v47, v46
    v_mov_b32 v1, 0x40000000
    v_cmp_lt_u32 vcc, 21, v0
    s_nop 1
    v_cndmask_b32 v46, v46, v1, vcc
    v_cmp_lt_u32 vcc, 15, v0
    s_nop 1
    v_cndmask_b32 v47, v47, v1, vcc
    s_mov_b32 s8, s30
    s_mov_b32 s9, s31
    s_mov_b32 s10, 0xac000
    s_mov_b32 s11, 0x20000
    s_mov_b32 s40, s20
    s_mov_b32 s41, s21
    s_mov_b32 s42, 0x80000
    s_mov_b32 s43, 0x20000
    s_sub_u32 s68, s58, 8
    s_lshl_b32 s68, s68, 12
    s_add_u32 s68, s68, 8388608
    s_mul_i32 s77, s79, 32768
    s_add_u32 s77, s77, s68
    s_add_u32 s78, s77, 2048
    v_pk_mul_f32 v[160:161], v[64:65], s[100:101]
    v_pk_mul_f32 v[162:163], v[66:67], s[100:101]
    v_pk_mul_f32 v[164:165], v[68:69], s[100:101]
    v_pk_mul_f32 v[166:167], v[70:71], s[100:101]
    v_exp_f32_e64 v160, v160 clamp
    v_exp_f32_e64 v161, v161 clamp
    v_exp_f32_e64 v162, v162 clamp
    v_exp_f32_e64 v163, v163 clamp
    s_add_u32 s12, s15, 0
    s_and_b32 s12, s12, 7
    s_mul_i32 s12, s12, s80
    s_add_u32 s12, s12, s73
    s_add_u32 m0, s72, 98304
    s_nop 0
    buffer_load_dwordx4 v12, s[44:47], s12 offen lds
    v_exp_f32_e64 v164, v164 clamp
    v_exp_f32_e64 v165, v165 clamp
    v_exp_f32_e64 v166, v166 clamp
    v_exp_f32_e64 v167, v167 clamp
    v_max_f32 v64, s83, v64
    v_max_f32 v65, s83, v65
    v_max_f32 v66, s83, v66
    v_max_f32 v67, s83, v67
    buffer_load_dwordx4 v13, s[44:47], s12 offen offset:1024 lds
    v_max_f32 v68, s83, v68
    v_max_f32 v69, s83, v69
    v_max_f32 v70, s83, v70
    v_max_f32 v71, s83, v71
    v_pk_add_f32 v[64:65], v[64:65], v[160:161]
    v_pk_add_f32 v[66:67], v[66:67], v[162:163]
    v_pk_add_f32 v[68:69], v[68:69], v[164:165]
    v_pk_add_f32 v[70:71], v[70:71], v[166:167]
    s_add_u32 s12, s15, 1
    s_and_b32 s12, s12, 7
    s_mul_i32 s12, s12, s80
    s_add_u32 s12, s12, s73
    s_add_u32 m0, s72, 106496
    s_nop 0
    buffer_load_dwordx4 v12, s[44:47], s12 offen lds
    v_cvt_pk_bf16_f32 v208, v64, v65
    v_cvt_pk_bf16_f32 v209, v66, v67
    v_cvt_pk_bf16_f32 v210, v68, v69
    v_cvt_pk_bf16_f32 v211, v70, v71
    buffer_store_dwordx4 v[208:211], v24, s[48:51], s77 offen offset:0 sc1
    v_pk_mul_f32 v[160:161], v[72:73], s[100:101]
    v_pk_mul_f32 v[162:163], v[74:75], s[100:101]
    v_pk_mul_f32 v[164:165], v[76:77], s[100:101]
    buffer_load_dwordx4 v13, s[44:47], s12 offen offset:1024 lds
    v_pk_mul_f32 v[166:167], v[78:79], s[100:101]
    v_exp_f32_e64 v160, v160 clamp
    v_exp_f32_e64 v161, v161 clamp
    v_exp_f32_e64 v162, v162 clamp
    v_exp_f32_e64 v163, v163 clamp
    v_exp_f32_e64 v164, v164 clamp
    v_exp_f32_e64 v165, v165 clamp
    v_exp_f32_e64 v166, v166 clamp
    s_add_u32 s12, s15, 2
    s_and_b32 s12, s12, 7
    s_mul_i32 s12, s12, s80
    s_add_u32 s12, s12, s73
    s_add_u32 m0, s72, 114688
    s_nop 0
    buffer_load_dwordx4 v12, s[44:47], s12 offen lds
    v_exp_f32_e64 v167, v167 clamp
    v_max_f32 v72, s83, v72
    v_max_f32 v73, s83, v73
    v_max_f32 v74, s83, v74
    v_max_f32 v75, s83, v75
    v_max_f32 v76, s83, v76
    v_max_f32 v77, s83, v77
    v_max_f32 v78, s83, v78
    buffer_load_dwordx4 v13, s[44:47], s12 offen offset:1024 lds
    v_max_f32 v79, s83, v79
    v_pk_add_f32 v[72:73], v[72:73], v[160:161]
    v_pk_add_f32 v[74:75], v[74:75], v[162:163]
    v_pk_add_f32 v[76:77], v[76:77], v[164:165]
    v_pk_add_f32 v[78:79], v[78:79], v[166:167]
    v_cvt_pk_bf16_f32 v212, v72, v73
    v_cvt_pk_bf16_f32 v213, v74, v75
    v_cvt_pk_bf16_f32 v214, v76, v77
    s_add_u32 s12, s15, 3
    s_and_b32 s12, s12, 7
    s_mul_i32 s12, s12, s80
    s_add_u32 s12, s12, s73
    s_add_u32 m0, s72, 122880
    s_nop 0
    buffer_load_dwordx4 v12, s[44:47], s12 offen lds
    v_cvt_pk_bf16_f32 v215, v78, v79
    buffer_store_dwordx4 v[212:215], v24, s[48:51], s77 offen offset:1024 sc1
    v_pk_mul_f32 v[160:161], v[80:81], s[100:101]
    v_pk_mul_f32 v[162:163], v[82:83], s[100:101]
    v_pk_mul_f32 v[164:165], v[84:85], s[100:101]
    v_pk_mul_f32 v[166:167], v[86:87], s[100:101]
    v_exp_f32_e64 v160, v160 clamp
    v_exp_f32_e64 v161, v161 clamp
    buffer_load_dwordx4 v13, s[44:47], s12 offen offset:1024 lds
    v_exp_f32_e64 v162, v162 clamp
    v_exp_f32_e64 v163, v163 clamp
    v_exp_f32_e64 v164, v164 clamp
    v_exp_f32_e64 v165, v165 clamp
    v_exp_f32_e64 v166, v166 clamp
    v_exp_f32_e64 v167, v167 clamp
    v_max_f32 v80, s83, v80
    v_max_f32 v81, s83, v81
    s_add_u32 m0, s36, 0
    s_nop 0
    buffer_load_dwordx4 v40, s[4:7], s16 offen offset:0 lds
    v_max_f32 v82, s83, v82
    v_max_f32 v83, s83, v83
    v_max_f32 v84, s83, v84
    v_max_f32 v85, s83, v85
    v_max_f32 v86, s83, v86
    v_max_f32 v87, s83, v87
    v_pk_add_f32 v[80:81], v[80:81], v[160:161]
    v_pk_add_f32 v[82:83], v[82:83], v[162:163]
    buffer_load_dwordx4 v41, s[4:7], s16 offen offset:1024 lds
    v_pk_add_f32 v[84:85], v[84:85], v[164:165]
    v_pk_add_f32 v[86:87], v[86:87], v[166:167]
    v_cvt_pk_bf16_f32 v216, v80, v81
    v_cvt_pk_bf16_f32 v217, v82, v83
    v_cvt_pk_bf16_f32 v218, v84, v85
    v_cvt_pk_bf16_f32 v219, v86, v87
    buffer_store_dwordx4 v[216:219], v24, s[48:51], s78 offen offset:0 sc1
    v_pk_mul_f32 v[160:161], v[88:89], s[100:101]
    buffer_load_dwordx4 v42, s[4:7], s16 offen offset:2048 lds
    v_pk_mul_f32 v[162:163], v[90:91], s[100:101]
    v_pk_mul_f32 v[164:165], v[92:93], s[100:101]
    v_pk_mul_f32 v[166:167], v[94:95], s[100:101]
    v_exp_f32_e64 v160, v160 clamp
    v_exp_f32_e64 v161, v161 clamp
    v_exp_f32_e64 v162, v162 clamp
    v_exp_f32_e64 v163, v163 clamp
    v_exp_f32_e64 v164, v164 clamp
    buffer_load_dwordx4 v43, s[4:7], s16 offen offset:3072 lds
    v_exp_f32_e64 v165, v165 clamp
    v_exp_f32_e64 v166, v166 clamp
    v_exp_f32_e64 v167, v167 clamp
    v_max_f32 v88, s83, v88
    v_max_f32 v89, s83, v89
    v_max_f32 v90, s83, v90
    v_max_f32 v91, s83, v91
    v_max_f32 v92, s83, v92
    s_add_u32 s12, s16, 131072
    s_add_u32 m0, s36, 4096
    s_nop 0
    buffer_load_dwordx4 v40, s[4:7], s12 offen offset:0 lds
    v_max_f32 v93, s83, v93
    v_max_f32 v94, s83, v94
    v_max_f32 v95, s83, v95
    v_pk_add_f32 v[88:89], v[88:89], v[160:161]
    v_pk_add_f32 v[90:91], v[90:91], v[162:163]
    v_pk_add_f32 v[92:93], v[92:93], v[164:165]
    v_pk_add_f32 v[94:95], v[94:95], v[166:167]
    v_cvt_pk_bf16_f32 v220, v88, v89
    buffer_load_dwordx4 v41, s[4:7], s12 offen offset:1024 lds
    v_cvt_pk_bf16_f32 v221, v90, v91
    v_cvt_pk_bf16_f32 v222, v92, v93
    v_cvt_pk_bf16_f32 v223, v94, v95
    buffer_store_dwordx4 v[220:223], v24, s[48:51], s78 offen offset:1024 sc1
    s_waitcnt vmcnt(8)
    s_barrier
    v_add_u32 v22, 98304, v22
    v_add_u32 v23, 98304, v23
    buffer_load_dwordx4 v42, s[4:7], s12 offen offset:2048 lds
    buffer_load_dwordx4 v43, s[4:7], s12 offen offset:3072 lds
    s_cmp_eq_u32 s94, 0
    s_mov_b32 s74, 2752
    s_cmov_b32 s74, 3072
    s_mov_b32 s75, s92
    s_mov_b32 s76, s93
    s_cmp_eq_u32 s94, 0
    s_cselect_b32 s44, s18, s24
    s_cselect_b32 s45, s19, s25
    s_mov_b32 s46, 0x158000
    s_cmov_b32 s46, 0x180000
    s_mov_b32 s47, 0x20000
    v_bfe_u32 v1, v0, 2, 1
    v_bfe_u32 v2, v0, 4, 1
    v_xor_b32 v1, v1, v2
    v_and_b32 v2, 3, v0
    v_lshlrev_b32 v2, 4, v2
    v_lshl_add_u32 v1, v1, 6, v2
    v_lshrrev_b32 v2, 3, v0
    v_mul_lo_u32 v2, v2, s74
    v_add_u32 v2, v2, v1
    v_add_u32 v12, s75, v2
    s_lshl_b32 s64, s74, 3
    s_sub_u32 s64, s64, 1024
    v_add_u32 v13, s64, v12
    v_mov_b32 v3, 0x40000000
    v_cmp_gt_u32 vcc, s76, v1
    s_nop 1
    v_cndmask_b32 v12, v12, v3, vcc
    v_cndmask_b32 v13, v13, v3, vcc
    s_lshl_b32 s80, s74, 6
    s_lshl_b32 s64, s74, 4
    s_mul_i32 s73, s64, s56
    ds_read_b64_tr_b16 v[128:129], v22 offset:0
    ds_read_b64_tr_b16 v[130:131], v22 offset:512
    ds_read_b64_tr_b16 v[132:133], v23 offset:0
    ds_read_b64_tr_b16 v[134:135], v23 offset:512
    ds_read_b64_tr_b16 v[136:137], v22 offset:2048
    s_waitcnt lgkmcnt(3)
    v_mfma_f32_32x32x16_bf16 v[96:111], v[128:131], a[128:131], 0
    ds_read_b64_tr_b16 v[138:139], v22 offset:2560
    ds_read_b64_tr_b16 v[140:141], v23 offset:2048
    ds_read_b64_tr_b16 v[142:143], v23 offset:2560
    ds_read_b64_tr_b16 v[144:145], v22 offset:4096
    ds_read_b64_tr_b16 v[146:147], v22 offset:4608
    s_waitcnt lgkmcnt(6)
    v_mfma_f32_32x32x16_bf16 v[112:127], v[132:135], a[128:131], 0
    ds_read_b64_tr_b16 v[148:149], v23 offset:4096
    ds_read_b64_tr_b16 v[150:151], v23 offset:4608
    s_add_u32 s12, s15, 0
    s_and_b32 s12, s12, 7
    s_mul_i32 s12, s12, s80
    s_waitcnt lgkmcnt(6)
    v_mfma_f32_32x32x16_bf16 v[96:111], v[136:139], a[132:135], v[96:111]
    s_add_u32 s12, s12, s73
    s_add_u32 m0, s72, 0
    s_nop 0
    buffer_load_dwordx4 v12, s[44:47], s12 offen lds
    ds_read_b64_tr_b16 v[152:153], v22 offset:6144
    ds_read_b64_tr_b16 v[154:155], v22 offset:6656
    s_waitcnt lgkmcnt(6)
    v_mfma_f32_32x32x16_bf16 v[112:127], v[140:143], a[132:135], v[112:127]
    ds_read_b64_tr_b16 v[156:157], v23 offset:6144
    ds_read_b64_tr_b16 v[158:159], v23 offset:6656
    buffer_load_dwordx4 v13, s[44:47], s12 offen offset:1024 lds
    ds_read_b64_tr_b16 v[128:129], v22 offset:8192
    ds_read_b64_tr_b16 v[130:131], v22 offset:8704
    s_waitcnt lgkmcnt(8)
    v_mfma_f32_32x32x16_bf16 v[96:111], v[144:147], a[136:139], v[96:111]
    ds_read_b64_tr_b16 v[132:133], v23 offset:8192
    ds_read_b64_tr_b16 v[134:135], v23 offset:8704
    s_add_u32 s12, s15, 1
    s_and_b32 s12, s12, 7
    s_mul_i32 s12, s12, s80
    s_waitcnt lgkmcnt(8)
    v_mfma_f32_32x32x16_bf16 v[112:127], v[148:151], a[136:139], v[112:127]
    s_add_u32 s12, s12, s73
    s_add_u32 m0, s72, 8192
    s_nop 0
    buffer_load_dwordx4 v12, s[44:47], s12 offen lds
    ds_read_b64_tr_b16 v[136:137], v22 offset:10240
    ds_read_b64_tr_b16 v[138:139], v22 offset:10752
    s_waitcnt lgkmcnt(8)
    v_mfma_f32_32x32x16_bf16 v[96:111], v[152:155], a[140:143], v[96:111]
    ds_read_b64_tr_b16 v[140:141], v23 offset:10240
    ds_read_b64_tr_b16 v[142:143], v23 offset:10752
    buffer_load_dwordx4 v13, s[44:47], s12 offen offset:1024 lds
    ds_read_b64_tr_b16 v[144:145], v22 offset:12288
    ds_read_b64_tr_b16 v[146:147], v22 offset:12800
    s_waitcnt lgkmcnt(10)
    v_mfma_f32_32x32x16_bf16 v[112:127], v[156:159], a[140:143], v[112:127]
    ds_read_b64_tr_b16 v[148:149], v23 offset:12288
    ds_read_b64_tr_b16 v[150:151], v23 offset:12800
    s_add_u32 s12, s15, 2
    s_and_b32 s12, s12, 7
    s_mul_i32 s12, s12, s80
    s_waitcnt lgkmcnt(10)
    v_mfma_f32_32x32x16_bf16 v[96:111], v[128:131], a[144:147], v[96:111]
    s_add_u32 s12, s12, s73
    s_add_u32 m0, s72, 16384
    s_nop 0
    buffer_load_dwordx4 v12, s[44:47], s12 offen lds
    ds_read_b64_tr_b16 v[152:153], v22 offset:14336
    ds_read_b64_tr_b16 v[154:155], v22 offset:14848
    s_waitcnt lgkmcnt(10)
    v_mfma_f32_32x32x16_bf16 v[112:127], v[132:135], a[144:147], v[112:127]
    ds_read_b64_tr_b16 v[156:157], v23 offset:14336
    ds_read_b64_tr_b16 v[158:159], v23 offset:14848
    buffer_load_dwordx4 v13, s[44:47], s12 offen offset:1024 lds
    ds_read_b64_tr_b16 v[128:129], v22 offset:16384
    ds_read_b64_tr_b16 v[130:131], v22 offset:16896
    s_waitcnt lgkmcnt(12)
    v_mfma_f32_32x32x16_bf16 v[96:111], v[136:139], a[148:151], v[96:111]
    ds_read_b64_tr_b16 v[132:133], v23 offset:16384
    ds_read_b64_tr_b16 v[134:135], v23 offset:16896
    s_waitcnt lgkmcnt(12)
    v_mfma_f32_32x32x16_bf16 v[112:127], v[140:143], a[148:151], v[112:127]
    s_add_u32 s12, s15, 3
    s_and_b32 s12, s12, 7
    s_mul_i32 s12, s12, s80
    s_add_u32 s12, s12, s73
    s_add_u32 m0, s72, 24576
    s_waitcnt lgkmcnt(10)
    v_mfma_f32_32x32x16_bf16 v[96:111], v[144:147], a[152:155], v[96:111]
    buffer_load_dwordx4 v12, s[44:47], s12 offen lds
    ds_read_b64_tr_b16 v[136:137], v22 offset:18432
    ds_read_b64_tr_b16 v[138:139], v22 offset:18944
    ds_read_b64_tr_b16 v[140:141], v23 offset:18432
    ds_read_b64_tr_b16 v[142:143], v23 offset:18944
    s_waitcnt lgkmcnt(12)
    v_mfma_f32_32x32x16_bf16 v[112:127], v[148:151], a[152:155], v[112:127]
    buffer_load_dwordx4 v13, s[44:47], s12 offen offset:1024 lds
    ds_read_b64_tr_b16 v[144:145], v22 offset:20480
    ds_read_b64_tr_b16 v[146:147], v22 offset:20992
    ds_read_b64_tr_b16 v[148:149], v23 offset:20480
    ds_read_b64_tr_b16 v[150:151], v23 offset:20992
    s_waitcnt lgkmcnt(14)
    v_mfma_f32_32x32x16_bf16 v[96:111], v[152:155], a[156:159], v[96:111]
    s_waitcnt lgkmcnt(12)
    v_mfma_f32_32x32x16_bf16 v[112:127], v[156:159], a[156:159], v[112:127]
    s_add_u32 s12, s15, 4
    s_and_b32 s12, s12, 7
    s_mul_i32 s12, s12, s80
    s_add_u32 s12, s12, s73
    s_add_u32 m0, s72, 32768
    s_waitcnt lgkmcnt(10)
    v_mfma_f32_32x32x16_bf16 v[96:111], v[128:131], a[160:163], v[96:111]
    buffer_load_dwordx4 v12, s[44:47], s12 offen lds
    ds_read_b64_tr_b16 v[152:153], v22 offset:22528
    ds_read_b64_tr_b16 v[154:155], v22 offset:23040
    ds_read_b64_tr_b16 v[156:157], v23 offset:22528
    ds_read_b64_tr_b16 v[158:159], v23 offset:23040
    s_waitcnt lgkmcnt(12)
    v_mfma_f32_32x32x16_bf16 v[112:127], v[132:135], a[160:163], v[112:127]
    buffer_load_dwordx4 v13, s[44:47], s12 offen offset:1024 lds
    ds_read_b64_tr_b16 v[128:129], v22 offset:24576
    ds_read_b64_tr_b16 v[130:131], v22 offset:25088
    ds_read_b64_tr_b16 v[132:133], v23 offset:24576
    ds_read_b64_tr_b16 v[134:135], v23 offset:25088
    s_waitcnt lgkmcnt(14)
    v_mfma_f32_32x32x16_bf16 v[96:111], v[136:139], a[164:167], v[96:111]
    s_waitcnt lgkmcnt(12)
    v_mfma_f32_32x32x16_bf16 v[112:127], v[140:143], a[164:167], v[112:127]
    s_add_u32 s12, s15, 5
    s_and_b32 s12, s12, 7
    s_mul_i32 s12, s12, s80
    s_add_u32 s12, s12, s73
    s_add_u32 m0, s72, 40960
    s_waitcnt lgkmcnt(10)
    v_mfma_f32_32x32x16_bf16 v[96:111], v[144:147], a[168:171], v[96:111]
    buffer_load_dwordx4 v12, s[44:47], s12 offen lds
    ds_read_b64_tr_b16 v[136:137], v22 offset:26624
    ds_read_b64_tr_b16 v[138:139], v22 offset:27136
    ds_read_b64_tr_b16 v[140:141], v23 offset:26624
    ds_read_b64_tr_b16 v[142:143], v23 offset:27136
    s_waitcnt lgkmcnt(12)
    v_mfma_f32_32x32x16_bf16 v[112:127], v[148:151], a[168:171], v[112:127]
    buffer_load_dwordx4 v13, s[44:47], s12 offen offset:1024 lds
    ds_read_b64_tr_b16 v[144:145], v22 offset:28672
    ds_read_b64_tr_b16 v[146:147], v22 offset:29184
    ds_read_b64_tr_b16 v[148:149], v23 offset:28672
    ds_read_b64_tr_b16 v[150:151], v23 offset:29184
    s_waitcnt lgkmcnt(14)
    v_mfma_f32_32x32x16_bf16 v[96:111], v[152:155], a[172:175], v[96:111]
    s_waitcnt lgkmcnt(12)
    v_mfma_f32_32x32x16_bf16 v[112:127], v[156:159], a[172:175], v[112:127]
    s_add_u32 s12, s15, 6
    s_and_b32 s12, s12, 7
    s_mul_i32 s12, s12, s80
    s_add_u32 s12, s12, s73
    s_add_u32 m0, s72, 49152
    s_waitcnt lgkmcnt(10)
    v_mfma_f32_32x32x16_bf16 v[96:111], v[128:131], a[176:179], v[96:111]
    buffer_load_dwordx4 v12, s[44:47], s12 offen lds
    ds_read_b64_tr_b16 v[152:153], v22 offset:30720
    ds_read_b64_tr_b16 v[154:155], v22 offset:31232
    ds_read_b64_tr_b16 v[156:157], v23 offset:30720
    ds_read_b64_tr_b16 v[158:159], v23 offset:31232
    s_waitcnt lgkmcnt(12)
    v_mfma_f32_32x32x16_bf16 v[112:127], v[132:135], a[176:179], v[112:127]
    buffer_load_dwordx4 v13, s[44:47], s12 offen offset:1024 lds
    ds_read_b64_tr_b16 v[128:129], v22 offset:32768
    ds_read_b64_tr_b16 v[130:131], v22 offset:33280
    ds_read_b64_tr_b16 v[132:133], v23 offset:32768
    ds_read_b64_tr_b16 v[134:135], v23 offset:33280
    s_waitcnt lgkmcnt(14)
    v_mfma_f32_32x32x16_bf16 v[96:111], v[136:139], a[180:183], v[96:111]
    s_waitcnt lgkmcnt(12)
    v_mfma_f32_32x32x16_bf16 v[112:127], v[140:143], a[180:183], v[112:127]
    s_add_u32 s12, s15, 7
    s_and_b32 s12, s12, 7
    s_mul_i32 s12, s12, s80
    s_add_u32 s12, s12, s73
    s_add_u32 m0, s72, 57344
    s_waitcnt lgkmcnt(10)
    v_mfma_f32_32x32x16_bf16 v[96:111], v[144:147], a[184:187], v[96:111]
    buffer_load_dwordx4 v12, s[44:47], s12 offen lds
    ds_read_b64_tr_b16 v[136:137], v22 offset:34816
    ds_read_b64_tr_b16 v[138:139], v22 offset:35328
    ds_read_b64_tr_b16 v[140:141], v23 offset:34816
    ds_read_b64_tr_b16 v[142:143], v23 offset:35328
    s_waitcnt lgkmcnt(12)
    v_mfma_f32_32x32x16_bf16 v[112:127], v[148:151], a[184:187], v[112:127]
    buffer_load_dwordx4 v13, s[44:47], s12 offen offset:1024 lds
    ds_read_b64_tr_b16 v[144:145], v22 offset:36864
    ds_read_b64_tr_b16 v[146:147], v22 offset:37376
    ds_read_b64_tr_b16 v[148:149], v23 offset:36864
    ds_read_b64_tr_b16 v[150:151], v23 offset:37376
    s_waitcnt lgkmcnt(14)
    v_mfma_f32_32x32x16_bf16 v[96:111], v[152:155], a[188:191], v[96:111]
    s_waitcnt lgkmcnt(12)
    v_mfma_f32_32x32x16_bf16 v[112:127], v[156:159], a[188:191], v[112:127]
    ds_read_b64_tr_b16 v[152:153], v22 offset:38912
    ds_read_b64_tr_b16 v[154:155], v22 offset:39424
    ds_read_b64_tr_b16 v[156:157], v23 offset:38912
    ds_read_b64_tr_b16 v[158:159], v23 offset:39424
    s_waitcnt lgkmcnt(14)
    v_mfma_f32_32x32x16_bf16 v[96:111], v[128:131], a[192:195], v[96:111]
    s_waitcnt lgkmcnt(12)
    v_mfma_f32_32x32x16_bf16 v[112:127], v[132:135], a[192:195], v[112:127]
    ds_read_b64_tr_b16 v[128:129], v22 offset:40960
    ds_read_b64_tr_b16 v[130:131], v22 offset:41472
L_pad_roleC_1:
    s_cbranch_execz L_hopret
    ds_read_b64_tr_b16 v[132:133], v23 offset:40960
    ds_read_b64_tr_b16 v[134:135], v23 offset:41472
    s_waitcnt lgkmcnt(14)
    v_mfma_f32_32x32x16_bf16 v[96:111], v[136:139], a[196:199], v[96:111]
    s_waitcnt lgkmcnt(12)
    v_mfma_f32_32x32x16_bf16 v[112:127], v[140:143], a[196:199], v[112:127]
    ds_read_b64_tr_b16 v[136:137], v22 offset:43008
    ds_read_b64_tr_b16 v[138:139], v22 offset:43520
    ds_read_b64_tr_b16 v[140:141], v23 offset:43008
    ds_read_b64_tr_b16 v[142:143], v23 offset:43520
    s_waitcnt lgkmcnt(14)
    v_mfma_f32_32x32x16_bf16 v[96:111], v[144:147], a[200:203], v[96:111]
    s_waitcnt lgkmcnt(12)
    v_mfma_f32_32x32x16_bf16 v[112:127], v[148:151], a[200:203], v[112:127]
    ds_read_b64_tr_b16 v[144:145], v22 offset:45056
    ds_read_b64_tr_b16 v[146:147], v22 offset:45568
    ds_read_b64_tr_b16 v[148:149], v23 offset:45056
    ds_read_b64_tr_b16 v[150:151], v23 offset:45568
    s_waitcnt lgkmcnt(14)
    v_mfma_f32_32x32x16_bf16 v[96:111], v[152:155], a[204:207], v[96:111]
    s_waitcnt lgkmcnt(12)
    v_mfma_f32_32x32x16_bf16 v[112:127], v[156:159], a[204:207], v[112:127]
    ds_read_b64_tr_b16 v[152:153], v22 offset:47104
    ds_read_b64_tr_b16 v[154:155], v22 offset:47616
    ds_read_b64_tr_b16 v[156:157], v23 offset:47104
    ds_read_b64_tr_b16 v[158:159], v23 offset:47616
    s_waitcnt lgkmcnt(14)
    v_mfma_f32_32x32x16_bf16 v[96:111], v[128:131], a[208:211], v[96:111]
    s_waitcnt lgkmcnt(12)
    v_mfma_f32_32x32x16_bf16 v[112:127], v[132:135], a[208:211], v[112:127]
    ds_read_b64_tr_b16 v[128:129], v22 offset:49152
    ds_read_b64_tr_b16 v[130:131], v22 offset:49664
    ds_read_b64_tr_b16 v[132:133], v23 offset:49152
    ds_read_b64_tr_b16 v[134:135], v23 offset:49664
    s_waitcnt lgkmcnt(14)
    v_mfma_f32_32x32x16_bf16 v[96:111], v[136:139], a[212:215], v[96:111]
    s_waitcnt lgkmcnt(12)
    v_mfma_f32_32x32x16_bf16 v[112:127], v[140:143], a[212:215], v[112:127]
    ds_read_b64_tr_b16 v[136:137], v22 offset:51200
    ds_read_b64_tr_b16 v[138:139], v22 offset:51712
    ds_read_b64_tr_b16 v[140:141], v23 offset:51200
    ds_read_b64_tr_b16 v[142:143], v23 offset:51712
    s_waitcnt lgkmcnt(14)
    v_mfma_f32_32x32x16_bf16 v[96:111], v[144:147], a[216:219], v[96:111]
    s_waitcnt lgkmcnt(12)
    v_mfma_f32_32x32x16_bf16 v[112:127], v[148:151], a[216:219], v[112:127]
    ds_read_b64_tr_b16 v[144:145], v22 offset:53248
    ds_read_b64_tr_b16 v[146:147], v22 offset:53760
    ds_read_b64_tr_b16 v[148:149], v23 offset:53248
    ds_read_b64_tr_b16 v[150:151], v23 offset:53760
    s_waitcnt lgkmcnt(14)
    v_mfma_f32_32x32x16_bf16 v[96:111], v[152:155], a[220:223], v[96:111]
    s_waitcnt lgkmcnt(12)
    v_mfma_f32_32x32x16_bf16 v[112:127], v[156:159], a[220:223], v[112:127]
    ds_read_b64_tr_b16 v[152:153], v22 offset:55296
    ds_read_b64_tr_b16 v[154:155], v22 offset:55808
    ds_read_b64_tr_b16 v[156:157], v23 offset:55296
    ds_read_b64_tr_b16 v[158:159], v23 offset:55808
    s_waitcnt lgkmcnt(14)
    v_mfma_f32_32x32x16_bf16 v[96:111], v[128:131], a[224:227], v[96:111]
    s_waitcnt lgkmcnt(12)
    v_mfma_f32_32x32x16_bf16 v[112:127], v[132:135], a[224:227], v[112:127]
    ds_read_b64_tr_b16 v[128:129], v22 offset:57344
    ds_read_b64_tr_b16 v[130:131], v22 offset:57856
    ds_read_b64_tr_b16 v[132:133], v23 offset:57344
    ds_read_b64_tr_b16 v[134:135], v23 offset:57856
    s_waitcnt lgkmcnt(14)
    v_mfma_f32_32x32x16_bf16 v[96:111], v[136:139], a[228:231], v[96:111]
    s_waitcnt lgkmcnt(12)
    v_mfma_f32_32x32x16_bf16 v[112:127], v[140:143], a[228:231], v[112:127]
    ds_read_b64_tr_b16 v[136:137], v22 offset:59392
    ds_read_b64_tr_b16 v[138:139], v22 offset:59904
    ds_read_b64_tr_b16 v[140:141], v23 offset:59392
    ds_read_b64_tr_b16 v[142:143], v23 offset:59904
    s_waitcnt lgkmcnt(14)
    v_mfma_f32_32x32x16_bf16 v[96:111], v[144:147], a[232:235], v[96:111]
    s_waitcnt lgkmcnt(12)
    v_mfma_f32_32x32x16_bf16 v[112:127], v[148:151], a[232:235], v[112:127]
    ds_read_b64_tr_b16 v[144:145], v22 offset:61440
    ds_read_b64_tr_b16 v[146:147], v22 offset:61952
    ds_read_b64_tr_b16 v[148:149], v23 offset:61440
    ds_read_b64_tr_b16 v[150:151], v23 offset:61952
    s_waitcnt lgkmcnt(14)
    v_mfma_f32_32x32x16_bf16 v[96:111], v[152:155], a[236:239], v[96:111]
    s_waitcnt lgkmcnt(12)
    v_mfma_f32_32x32x16_bf16 v[112:127], v[156:159], a[236:239], v[112:127]
    ds_read_b64_tr_b16 v[152:153], v22 offset:63488
    ds_read_b64_tr_b16 v[154:155], v22 offset:64000
    ds_read_b64_tr_b16 v[156:157], v23 offset:63488
    ds_read_b64_tr_b16 v[158:159], v23 offset:64000
    s_waitcnt lgkmcnt(14)
    v_mfma_f32_32x32x16_bf16 v[96:111], v[128:131], a[240:243], v[96:111]
    s_waitcnt lgkmcnt(12)
    v_mfma_f32_32x32x16_bf16 v[112:127], v[132:135], a[240:243], v[112:127]
    s_waitcnt lgkmcnt(10)
    v_mfma_f32_32x32x16_bf16 v[96:111], v[136:139], a[244:247], v[96:111]
    s_waitcnt lgkmcnt(8)
    v_mfma_f32_32x32x16_bf16 v[112:127], v[140:143], a[244:247], v[112:127]
    s_waitcnt lgkmcnt(6)
    v_mfma_f32_32x32x16_bf16 v[96:111], v[144:147], a[248:251], v[96:111]
    s_waitcnt lgkmcnt(4)
    v_mfma_f32_32x32x16_bf16 v[112:127], v[148:151], a[248:251], v[112:127]
    s_waitcnt lgkmcnt(2)
    v_mfma_f32_32x32x16_bf16 v[96:111], v[152:155], a[252:255], v[96:111]
    s_waitcnt lgkmcnt(0)
    v_mfma_f32_32x32x16_bf16 v[112:127], v[156:159], a[252:255], v[112:127]
    s_barrier
    s_lshl_b32 s68, s58, 1
    s_sub_u32 s68, s68, 19
    s_lshl_b32 s68, s68, 12
    s_add_u32 s68, s68, 5242880
    s_mul_i32 s77, s79, 45056
    s_add_u32 s77, s77, s68
    s_add_u32 s78, s77, 2048
    s_nop 1
    v_pk_mul_f32 v[160:161], v[96:97], v[96:97]
    v_pk_mul_f32 v[162:163], v[98:99], v[98:99]
    v_pk_mul_f32 v[164:165], v[100:101], v[100:101]
    v_pk_mul_f32 v[166:167], v[102:103], v[102:103]
    v_pk_fma_f32 v[160:161], v[160:161], s[62:63], v[38:39]
    v_pk_fma_f32 v[162:163], v[162:163], s[62:63], v[38:39]
    v_pk_fma_f32 v[164:165], v[164:165], s[62:63], v[38:39]
    v_pk_fma_f32 v[166:167], v[166:167], s[62:63], v[38:39]
    v_pk_mul_f32 v[160:161], v[160:161], v[96:97]
    v_pk_mul_f32 v[162:163], v[162:163], v[98:99]
    v_pk_mul_f32 v[164:165], v[164:165], v[100:101]
    v_pk_mul_f32 v[166:167], v[166:167], v[102:103]
    s_add_u32 m0, s37, 0
    s_nop 0
    buffer_load_dwordx4 v40, s[4:7], s17 offen offset:0 lds
    v_exp_f32 v160, v160
    v_exp_f32 v161, v161
    v_exp_f32 v162, v162
    v_exp_f32 v163, v163
    v_exp_f32 v164, v164
    v_exp_f32 v165, v165
    v_exp_f32 v166, v166
    v_exp_f32 v167, v167
    v_pk_add_f32 v[160:161], v[160:161], s[84:85]
    v_pk_add_f32 v[162:163], v[162:163], s[84:85]
    v_pk_add_f32 v[164:165], v[164:165], s[84:85]
    v_pk_add_f32 v[166:167], v[166:167], s[84:85]
    buffer_load_dwordx4 v41, s[4:7], s17 offen offset:1024 lds
    v_rcp_f32 v160, v160
    v_rcp_f32 v161, v161
    v_rcp_f32 v162, v162
    v_rcp_f32 v163, v163
    v_rcp_f32 v164, v164
    v_rcp_f32 v165, v165
    v_rcp_f32 v166, v166
    v_rcp_f32 v167, v167
    v_pk_mul_f32 v[96:97], v[96:97], v[160:161]
    v_pk_mul_f32 v[98:99], v[98:99], v[162:163]
    v_pk_mul_f32 v[100:101], v[100:101], v[164:165]
    v_pk_mul_f32 v[102:103], v[102:103], v[166:167]
    buffer_load_dwordx4 v42, s[4:7], s17 offen offset:2048 lds
    v_cvt_pk_bf16_f32 v208, v96, v97
    v_cvt_pk_bf16_f32 v209, v98, v99
    v_cvt_pk_bf16_f32 v210, v100, v101
    v_cvt_pk_bf16_f32 v211, v102, v103
    buffer_store_dwordx4 v[208:211], v24, s[48:51], s77 offen offset:0 sc1
    v_pk_mul_f32 v[160:161], v[104:105], v[104:105]
    v_pk_mul_f32 v[162:163], v[106:107], v[106:107]
    v_pk_mul_f32 v[164:165], v[108:109], v[108:109]
    v_pk_mul_f32 v[166:167], v[110:111], v[110:111]
    v_pk_fma_f32 v[160:161], v[160:161], s[62:63], v[38:39]
    v_pk_fma_f32 v[162:163], v[162:163], s[62:63], v[38:39]
    v_pk_fma_f32 v[164:165], v[164:165], s[62:63], v[38:39]
    buffer_load_dwordx4 v43, s[4:7], s17 offen offset:3072 lds
    v_pk_fma_f32 v[166:167], v[166:167], s[62:63], v[38:39]
    v_pk_mul_f32 v[160:161], v[160:161], v[104:105]
    v_pk_mul_f32 v[162:163], v[162:163], v[106:107]
    v_pk_mul_f32 v[164:165], v[164:165], v[108:109]
    v_pk_mul_f32 v[166:167], v[166:167], v[110:111]
    v_exp_f32 v160, v160
    v_exp_f32 v161, v161
    v_exp_f32 v162, v162
    v_exp_f32 v163, v163
    v_exp_f32 v164, v164
    v_exp_f32 v165, v165
    v_exp_f32 v166, v166
    s_add_u32 s12, s17, 131072
    s_add_u32 m0, s37, 4096
    s_nop 0
    buffer_load_dwordx4 v40, s[4:7], s12 offen offset:0 lds
    v_exp_f32 v167, v167
    v_pk_add_f32 v[160:161], v[160:161], s[84:85]
    v_pk_add_f32 v[162:163], v[162:163], s[84:85]
    v_pk_add_f32 v[164:165], v[164:165], s[84:85]
    v_pk_add_f32 v[166:167], v[166:167], s[84:85]
    v_rcp_f32 v160, v160
    v_rcp_f32 v161, v161
    v_rcp_f32 v162, v162
    v_rcp_f32 v163, v163
    v_rcp_f32 v164, v164
    v_rcp_f32 v165, v165
    v_rcp_f32 v166, v166
    buffer_load_dwordx4 v41, s[4:7], s12 offen offset:1024 lds
    v_rcp_f32 v167, v167
    v_pk_mul_f32 v[104:105], v[104:105], v[160:161]
    v_pk_mul_f32 v[106:107], v[106:107], v[162:163]
    v_pk_mul_f32 v[108:109], v[108:109], v[164:165]
    v_pk_mul_f32 v[110:111], v[110:111], v[166:167]
    v_cvt_pk_bf16_f32 v212, v104, v105
    v_cvt_pk_bf16_f32 v213, v106, v107
    v_cvt_pk_bf16_f32 v214, v108, v109
    v_cvt_pk_bf16_f32 v215, v110, v111
    buffer_store_dwordx4 v[212:215], v24, s[48:51], s77 offen offset:1024 sc1
    v_pk_mul_f32 v[160:161], v[112:113], v[112:113]
    v_pk_mul_f32 v[162:163], v[114:115], v[114:115]
    buffer_load_dwordx4 v42, s[4:7], s12 offen offset:2048 lds
    v_pk_mul_f32 v[164:165], v[116:117], v[116:117]
    v_pk_mul_f32 v[166:167], v[118:119], v[118:119]
    v_pk_fma_f32 v[160:161], v[160:161], s[62:63], v[38:39]
    v_pk_fma_f32 v[162:163], v[162:163], s[62:63], v[38:39]
    v_pk_fma_f32 v[164:165], v[164:165], s[62:63], v[38:39]
    v_pk_fma_f32 v[166:167], v[166:167], s[62:63], v[38:39]
    v_pk_mul_f32 v[160:161], v[160:161], v[112:113]
    v_pk_mul_f32 v[162:163], v[162:163], v[114:115]
    v_pk_mul_f32 v[164:165], v[164:165], v[116:117]
    v_pk_mul_f32 v[166:167], v[166:167], v[118:119]
    v_exp_f32 v160, v160
    v_exp_f32 v161, v161
    buffer_load_dwordx4 v43, s[4:7], s12 offen offset:3072 lds
    v_exp_f32 v162, v162
    v_exp_f32 v163, v163
    v_exp_f32 v164, v164
    v_exp_f32 v165, v165
    v_exp_f32 v166, v166
    v_exp_f32 v167, v167
    v_pk_add_f32 v[160:161], v[160:161], s[84:85]
    v_pk_add_f32 v[162:163], v[162:163], s[84:85]
    v_pk_add_f32 v[164:165], v[164:165], s[84:85]
    v_pk_add_f32 v[166:167], v[166:167], s[84:85]
    v_rcp_f32 v160, v160
    v_rcp_f32 v161, v161
    s_add_u32 m0, s37, 8192
    s_nop 0
    buffer_load_dwordx4 v40, s[4:7], s22 offen offset:0 lds
    v_rcp_f32 v162, v162
    v_rcp_f32 v163, v163
    v_rcp_f32 v164, v164
    v_rcp_f32 v165, v165
    v_rcp_f32 v166, v166
    v_rcp_f32 v167, v167
    v_pk_mul_f32 v[112:113], v[112:113], v[160:161]
    v_pk_mul_f32 v[114:115], v[114:115], v[162:163]
    v_pk_mul_f32 v[116:117], v[116:117], v[164:165]
    v_pk_mul_f32 v[118:119], v[118:119], v[166:167]
    v_cvt_pk_bf16_f32 v216, v112, v113
    v_cvt_pk_bf16_f32 v217, v114, v115
    buffer_load_dwordx4 v41, s[4:7], s22 offen offset:1024 lds
    v_cvt_pk_bf16_f32 v218, v116, v117
    v_cvt_pk_bf16_f32 v219, v118, v119
    buffer_store_dwordx4 v[216:219], v24, s[48:51], s78 offen offset:0 sc1
    v_pk_mul_f32 v[160:161], v[120:121], v[120:121]
    v_pk_mul_f32 v[162:163], v[122:123], v[122:123]
    v_pk_mul_f32 v[164:165], v[124:125], v[124:125]
    v_pk_mul_f32 v[166:167], v[126:127], v[126:127]
    v_pk_fma_f32 v[160:161], v[160:161], s[62:63], v[38:39]
    v_pk_fma_f32 v[162:163], v[162:163], s[62:63], v[38:39]
    v_pk_fma_f32 v[164:165], v[164:165], s[62:63], v[38:39]
    v_pk_fma_f32 v[166:167], v[166:167], s[62:63], v[38:39]
    v_pk_mul_f32 v[160:161], v[160:161], v[120:121]
    buffer_load_dwordx4 v42, s[4:7], s22 offen offset:2048 lds
    v_pk_mul_f32 v[162:163], v[162:163], v[122:123]
    v_pk_mul_f32 v[164:165], v[164:165], v[124:125]
    v_pk_mul_f32 v[166:167], v[166:167], v[126:127]
    v_exp_f32 v160, v160
    v_exp_f32 v161, v161
    v_exp_f32 v162, v162
    v_exp_f32 v163, v163
    v_exp_f32 v164, v164
    v_exp_f32 v165, v165
    v_exp_f32 v166, v166
    v_exp_f32 v167, v167
    v_pk_add_f32 v[160:161], v[160:161], s[84:85]
    buffer_load_dwordx4 v43, s[4:7], s22 offen offset:3072 lds
    v_pk_add_f32 v[162:163], v[162:163], s[84:85]
    v_pk_add_f32 v[164:165], v[164:165], s[84:85]
    v_pk_add_f32 v[166:167], v[166:167], s[84:85]
    v_rcp_f32 v160, v160
    v_rcp_f32 v161, v161
    v_rcp_f32 v162, v162
    v_rcp_f32 v163, v163
    v_rcp_f32 v164, v164
    v_rcp_f32 v165, v165
    v_rcp_f32 v166, v166
    v_rcp_f32 v167, v167
    v_pk_mul_f32 v[120:121], v[120:121], v[160:161]
    s_add_u32 s12, s22, 131072
    s_add_u32 m0, s37, 12288
    s_nop 0
    buffer_load_dwordx4 v40, s[4:7], s12 offen offset:0 lds
    v_pk_mul_f32 v[122:123], v[122:123], v[162:163]
    v_pk_mul_f32 v[124:125], v[124:125], v[164:165]
    v_pk_mul_f32 v[126:127], v[126:127], v[166:167]
    v_cvt_pk_bf16_f32 v220, v120, v121
    v_cvt_pk_bf16_f32 v221, v122, v123
    v_cvt_pk_bf16_f32 v222, v124, v125
    v_cvt_pk_bf16_f32 v223, v126, v127
    buffer_store_dwordx4 v[220:223], v24, s[48:51], s78 offen offset:1024 sc1
    s_waitcnt vmcnt(17)
    s_barrier
    v_subrev_u32 v22, 98304, v22
    v_subrev_u32 v23, 98304, v23
    ds_read_b64_tr_b16 v[128:129], v22 offset:0
    ds_read_b64_tr_b16 v[130:131], v22 offset:512
    ds_read_b64_tr_b16 v[132:133], v23 offset:0
    ds_read_b64_tr_b16 v[134:135], v23 offset:512
    ds_read_b64_tr_b16 v[136:137], v22 offset:2048
    s_waitcnt lgkmcnt(3)
    v_mfma_f32_32x32x16_bf16 v[96:111], v[128:131], a[128:131], 0
    ds_read_b64_tr_b16 v[138:139], v22 offset:2560
    ds_read_b64_tr_b16 v[140:141], v23 offset:2048
    ds_read_b64_tr_b16 v[142:143], v23 offset:2560
    ds_read_b64_tr_b16 v[144:145], v22 offset:4096
    ds_read_b64_tr_b16 v[146:147], v22 offset:4608
    s_waitcnt lgkmcnt(6)
    v_mfma_f32_32x32x16_bf16 v[112:127], v[132:135], a[128:131], 0
    ds_read_b64_tr_b16 v[148:149], v23 offset:4096
    ds_read_b64_tr_b16 v[150:151], v23 offset:4608
    buffer_load_dwordx4 v41, s[4:7], s12 offen offset:1024 lds
    ds_read_b64_tr_b16 v[152:153], v22 offset:6144
    ds_read_b64_tr_b16 v[154:155], v22 offset:6656
    s_waitcnt lgkmcnt(8)
    v_mfma_f32_32x32x16_bf16 v[96:111], v[136:139], a[132:135], v[96:111]
    ds_read_b64_tr_b16 v[156:157], v23 offset:6144
    ds_read_b64_tr_b16 v[158:159], v23 offset:6656
    buffer_load_dwordx4 v42, s[4:7], s12 offen offset:2048 lds
    ds_read_b64_tr_b16 v[128:129], v22 offset:8192
    ds_read_b64_tr_b16 v[130:131], v22 offset:8704
    s_waitcnt lgkmcnt(10)
    v_mfma_f32_32x32x16_bf16 v[112:127], v[140:143], a[132:135], v[112:127]
    ds_read_b64_tr_b16 v[132:133], v23 offset:8192
    ds_read_b64_tr_b16 v[134:135], v23 offset:8704
    s_mul_i32 s70, s60, 3
    s_min_u32 s70, s70, 20
    s_cmp_lt_u32 s60, 6
    s_waitcnt lgkmcnt(10)
    v_mfma_f32_32x32x16_bf16 v[96:111], v[144:147], a[136:139], v[96:111]
    s_cselect_b32 s71, 3, 2
    s_add_u32 s66, s70, s71
    s_sub_u32 s67, s66, 1
    s_mov_b32 s64, 0
    s_add_u32 s88, s70, s64
    s_waitcnt lgkmcnt(8)
    v_mfma_f32_32x32x16_bf16 v[112:127], v[148:151], a[136:139], v[112:127]
    s_cmp_ge_u32 s88, s66
    s_cselect_b32 s65, s71, 0
    s_sub_u32 s88, s88, s65
    s_add_u32 s89, s70, s64
    s_add_u32 s89, s89, 1
    s_waitcnt lgkmcnt(6)
    v_mfma_f32_32x32x16_bf16 v[96:111], v[152:155], a[140:143], v[96:111]
    s_cmp_ge_u32 s89, s66
    s_cselect_b32 s65, s71, 0
    s_sub_u32 s89, s89, s65
    s_add_u32 s90, s70, s64
    s_add_u32 s90, s90, 2
    s_waitcnt lgkmcnt(4)
    v_mfma_f32_32x32x16_bf16 v[112:127], v[156:159], a[140:143], v[112:127]
    s_cmp_ge_u32 s90, s66
    s_cselect_b32 s65, s71, 0
    s_sub_u32 s90, s90, s65
    s_lshr_b32 s64, s70, 1
    s_lshr_b32 s65, s67, 1
    s_waitcnt lgkmcnt(2)
    v_mfma_f32_32x32x16_bf16 v[96:111], v[128:131], a[144:147], v[96:111]
    s_sub_u32 s65, s65, s64
    v_bfe_u32 v1, v0, 3, 2
    v_bfe_u32 v2, v0, 2, 1
    v_mul_u32_u24 v2, s65, v2
    v_lshl_add_u32 v1, v1, 4, v2
    s_waitcnt lgkmcnt(0)
    v_mfma_f32_32x32x16_bf16 v[112:127], v[132:135], a[144:147], v[112:127]
    s_lshl_b32 s66, s56, 6
    s_add_u32 s66, s66, s64
    v_add_u32 v1, s66, v1
    v_and_b32 v2, 3, v0
    v_lshl_add_u32 v1, v1, 2, v2
    v_and_b32 v2, 3, v1
    v_lshrrev_b32 v1, 2, v1
    v_lshlrev_b32 v1, 4, v1
    v_add_lshl_u32 v8, v1, v2, 2
    buffer_load_dwordx4 v43, s[4:7], s12 offen offset:3072 lds
    ds_read_b64_tr_b16 v[136:137], v22 offset:10240
    ds_read_b64_tr_b16 v[138:139], v22 offset:10752
    s_waitcnt lgkmcnt(0)
    v_mfma_f32_32x32x16_bf16 v[96:111], v[136:139], a[148:151], v[96:111]
    ds_read_b64_tr_b16 v[140:141], v23 offset:10240
    ds_read_b64_tr_b16 v[142:143], v23 offset:10752
    ds_read_b64_tr_b16 v[144:145], v22 offset:12288
    ds_read_b64_tr_b16 v[146:147], v22 offset:12800
    ds_read_b64_tr_b16 v[148:149], v23 offset:12288
    s_waitcnt lgkmcnt(3)
    v_mfma_f32_32x32x16_bf16 v[112:127], v[140:143], a[148:151], v[112:127]
    ds_read_b64_tr_b16 v[150:151], v23 offset:12800
    ds_read_b64_tr_b16 v[152:153], v22 offset:14336
    ds_read_b64_tr_b16 v[154:155], v22 offset:14848
    ds_read_b64_tr_b16 v[156:157], v23 offset:14336
    ds_read_b64_tr_b16 v[158:159], v23 offset:14848
    s_waitcnt lgkmcnt(6)
    v_mfma_f32_32x32x16_bf16 v[96:111], v[144:147], a[152:155], v[96:111]
    ds_read_b64_tr_b16 v[128:129], v22 offset:16384
    ds_read_b64_tr_b16 v[130:131], v22 offset:16896
    ds_read_b64_tr_b16 v[132:133], v23 offset:16384
    ds_read_b64_tr_b16 v[134:135], v23 offset:16896
    ds_read_b64_tr_b16 v[136:137], v22 offset:18432
    s_waitcnt lgkmcnt(9)
    v_mfma_f32_32x32x16_bf16 v[112:127], v[148:151], a[152:155], v[112:127]
    ds_read_b64_tr_b16 v[138:139], v22 offset:18944
    ds_read_b64_tr_b16 v[140:141], v23 offset:18432
    ds_read_b64_tr_b16 v[142:143], v23 offset:18944
    ds_read_b64_tr_b16 v[144:145], v22 offset:20480
    ds_read_b64_tr_b16 v[146:147], v22 offset:20992
    s_waitcnt lgkmcnt(12)
    v_mfma_f32_32x32x16_bf16 v[96:111], v[152:155], a[156:159], v[96:111]
    ds_read_b64_tr_b16 v[148:149], v23 offset:20480
    ds_read_b64_tr_b16 v[150:151], v23 offset:20992
    s_waitcnt lgkmcnt(12)
    v_mfma_f32_32x32x16_bf16 v[112:127], v[156:159], a[156:159], v[112:127]
    ds_read_b64_tr_b16 v[152:153], v22 offset:22528
    ds_read_b64_tr_b16 v[154:155], v22 offset:23040
    ds_read_b64_tr_b16 v[156:157], v23 offset:22528
    ds_read_b64_tr_b16 v[158:159], v23 offset:23040
    s_waitcnt lgkmcnt(14)
    v_mfma_f32_32x32x16_bf16 v[96:111], v[128:131], a[160:163], v[96:111]
    s_waitcnt lgkmcnt(12)
    v_mfma_f32_32x32x16_bf16 v[112:127], v[132:135], a[160:163], v[112:127]
    ds_read_b64_tr_b16 v[128:129], v22 offset:24576
    ds_read_b64_tr_b16 v[130:131], v22 offset:25088
    ds_read_b64_tr_b16 v[132:133], v23 offset:24576
    ds_read_b64_tr_b16 v[134:135], v23 offset:25088
    s_waitcnt lgkmcnt(14)
    v_mfma_f32_32x32x16_bf16 v[96:111], v[136:139], a[164:167], v[96:111]
    s_waitcnt lgkmcnt(12)
    v_mfma_f32_32x32x16_bf16 v[112:127], v[140:143], a[164:167], v[112:127]
    ds_read_b64_tr_b16 v[136:137], v22 offset:26624
    ds_read_b64_tr_b16 v[138:139], v22 offset:27136
    ds_read_b64_tr_b16 v[140:141], v23 offset:26624
    ds_read_b64_tr_b16 v[142:143], v23 offset:27136
    s_waitcnt lgkmcnt(14)
    v_mfma_f32_32x32x16_bf16 v[96:111], v[144:147], a[168:171], v[96:111]
    s_waitcnt lgkmcnt(12)
    v_mfma_f32_32x32x16_bf16 v[112:127], v[148:151], a[168:171], v[112:127]
    ds_read_b64_tr_b16 v[144:145], v22 offset:28672
    ds_read_b64_tr_b16 v[146:147], v22 offset:29184
    ds_read_b64_tr_b16 v[148:149], v23 offset:28672
    ds_read_b64_tr_b16 v[150:151], v23 offset:29184
    s_waitcnt lgkmcnt(14)
    v_mfma_f32_32x32x16_bf16 v[96:111], v[152:155], a[172:175], v[96:111]
    s_waitcnt lgkmcnt(12)
    v_mfma_f32_32x32x16_bf16 v[112:127], v[156:159], a[172:175], v[112:127]
    ds_read_b64_tr_b16 v[152:153], v22 offset:30720
    ds_read_b64_tr_b16 v[154:155], v22 offset:31232
    ds_read_b64_tr_b16 v[156:157], v23 offset:30720
    ds_read_b64_tr_b16 v[158:159], v23 offset:31232
    s_waitcnt lgkmcnt(14)
    v_mfma_f32_32x32x16_bf16 v[96:111], v[128:131], a[176:179], v[96:111]
    s_waitcnt lgkmcnt(12)
    v_mfma_f32_32x32x16_bf16 v[112:127], v[132:135], a[176:179], v[112:127]
    ds_read_b64_tr_b16 v[128:129], v22 offset:32768
    ds_read_b64_tr_b16 v[130:131], v22 offset:33280
    ds_read_b64_tr_b16 v[132:133], v23 offset:32768
    ds_read_b64_tr_b16 v[134:135], v23 offset:33280
    s_waitcnt lgkmcnt(14)
    v_mfma_f32_32x32x16_bf16 v[96:111], v[136:139], a[180:183], v[96:111]
    s_waitcnt lgkmcnt(12)
    v_mfma_f32_32x32x16_bf16 v[112:127], v[140:143], a[180:183], v[112:127]
    ds_read_b64_tr_b16 v[136:137], v22 offset:34816
    ds_read_b64_tr_b16 v[138:139], v22 offset:35328
    ds_read_b64_tr_b16 v[140:141], v23 offset:34816
    ds_read_b64_tr_b16 v[142:143], v23 offset:35328
    s_waitcnt lgkmcnt(14)
    v_mfma_f32_32x32x16_bf16 v[96:111], v[144:147], a[184:187], v[96:111]
    s_waitcnt lgkmcnt(12)
    v_mfma_f32_32x32x16_bf16 v[112:127], v[148:151], a[184:187], v[112:127]
    ds_read_b64_tr_b16 v[144:145], v22 offset:36864
    ds_read_b64_tr_b16 v[146:147], v22 offset:37376
    ds_read_b64_tr_b16 v[148:149], v23 offset:36864
    ds_read_b64_tr_b16 v[150:151], v23 offset:37376
    s_waitcnt lgkmcnt(14)
    v_mfma_f32_32x32x16_bf16 v[96:111], v[152:155], a[188:191], v[96:111]
    s_waitcnt lgkmcnt(12)
    v_mfma_f32_32x32x16_bf16 v[112:127], v[156:159], a[188:191], v[112:127]
    ds_read_b64_tr_b16 v[152:153], v22 offset:38912
    ds_read_b64_tr_b16 v[154:155], v22 offset:39424
    ds_read_b64_tr_b16 v[156:157], v23 offset:38912
    ds_read_b64_tr_b16 v[158:159], v23 offset:39424
    s_waitcnt lgkmcnt(14)
    v_mfma_f32_32x32x16_bf16 v[96:111], v[128:131], a[192:195], v[96:111]
    s_waitcnt lgkmcnt(12)
    v_mfma_f32_32x32x16_bf16 v[112:127], v[132:135], a[192:195], v[112:127]
    ds_read_b64_tr_b16 v[128:129], v22 offset:40960
    ds_read_b64_tr_b16 v[130:131], v22 offset:41472
    ds_read_b64_tr_b16 v[132:133], v23 offset:40960
    ds_read_b64_tr_b16 v[134:135], v23 offset:41472
    s_waitcnt lgkmcnt(14)
    v_mfma_f32_32x32x16_bf16 v[96:111], v[136:139], a[196:199], v[96:111]
    s_waitcnt lgkmcnt(12)
    v_mfma_f32_32x32x16_bf16 v[112:127], v[140:143], a[196:199], v[112:127]
    ds_read_b64_tr_b16 v[136:137], v22 offset:43008
    ds_read_b64_tr_b16 v[138:139], v22 offset:43520
    ds_read_b64_tr_b16 v[140:141], v23 offset:43008
    ds_read_b64_tr_b16 v[142:143], v23 offset:43520
    s_waitcnt lgkmcnt(14)
    v_mfma_f32_32x32x16_bf16 v[96:111], v[144:147], a[200:203], v[96:111]
    s_waitcnt lgkmcnt(12)
    v_mfma_f32_32x32x16_bf16 v[112:127], v[148:151], a[200:203], v[112:127]
    ds_read_b64_tr_b16 v[144:145], v22 offset:45056
    ds_read_b64_tr_b16 v[146:147], v22 offset:45568
    ds_read_b64_tr_b16 v[148:149], v23 offset:45056
    ds_read_b64_tr_b16 v[150:151], v23 offset:45568
    s_waitcnt lgkmcnt(14)
    v_mfma_f32_32x32x16_bf16 v[96:111], v[152:155], a[204:207], v[96:111]
    s_waitcnt lgkmcnt(12)
    v_mfma_f32_32x32x16_bf16 v[112:127], v[156:159], a[204:207], v[112:127]
    ds_read_b128 a[0:3], v48 offset:0
    ds_read_b128 a[4:7], v48 offset:4096
    ds_read_b128 a[8:11], v49 offset:0
    ds_read_b128 a[12:15], v49 offset:4096
    ds_read_b128 a[16:19], v50 offset:0
    s_waitcnt lgkmcnt(14)
    v_mfma_f32_32x32x16_bf16 v[96:111], v[128:131], a[208:211], v[96:111]
    ds_read_b128 a[20:23], v50 offset:4096
    ds_read_b128 a[24:27], v51 offset:0
    ds_read_b128 a[28:31], v51 offset:4096
    ds_read_b64_tr_b16 v[152:153], v22 offset:47104
    ds_read_b64_tr_b16 v[154:155], v22 offset:47616
    s_waitcnt lgkmcnt(14)
    v_mfma_f32_32x32x16_bf16 v[112:127], v[132:135], a[208:211], v[112:127]
    ds_read_b64_tr_b16 v[156:157], v23 offset:47104
    ds_read_b64_tr_b16 v[158:159], v23 offset:47616
    s_waitcnt lgkmcnt(4)
    s_add_u32 m0, s36, 0
    s_nop 0
    buffer_load_dwordx4 v40, s[4:7], s23 offen offset:0 lds
    v_mfma_f32_32x32x16_bf16 v[96:111], v[136:139], a[212:215], v[96:111]
    ds_read_b64_tr_b16 v[128:129], v22 offset:49152
    ds_read_b64_tr_b16 v[130:131], v22 offset:49664
    ds_read_b64_tr_b16 v[132:133], v23 offset:49152
    ds_read_b64_tr_b16 v[134:135], v23 offset:49664
    v_mfma_f32_32x32x16_bf16 v[112:127], v[140:143], a[212:215], v[112:127]
    buffer_load_dwordx4 v41, s[4:7], s23 offen offset:1024 lds
    ds_read_b64_tr_b16 v[136:137], v22 offset:51200
    ds_read_b64_tr_b16 v[138:139], v22 offset:51712
    ds_read_b64_tr_b16 v[140:141], v23 offset:51200
    ds_read_b64_tr_b16 v[142:143], v23 offset:51712
    v_mfma_f32_32x32x16_bf16 v[96:111], v[144:147], a[216:219], v[96:111]
    v_mfma_f32_32x32x16_bf16 v[112:127], v[148:151], a[216:219], v[112:127]
    buffer_load_dwordx4 v42, s[4:7], s23 offen offset:2048 lds
    ds_read_b64_tr_b16 v[144:145], v22 offset:53248
    ds_read_b64_tr_b16 v[146:147], v22 offset:53760
    ds_read_b64_tr_b16 v[148:149], v23 offset:53248
    ds_read_b64_tr_b16 v[150:151], v23 offset:53760
    s_waitcnt lgkmcnt(14)
    v_mfma_f32_32x32x16_bf16 v[96:111], v[152:155], a[220:223], v[96:111]
    s_waitcnt lgkmcnt(12)
    v_mfma_f32_32x32x16_bf16 v[112:127], v[156:159], a[220:223], v[112:127]
    s_waitcnt vmcnt(13)
    ds_read_b128 a[32:35], v52 offset:0
    ds_read_b128 a[36:39], v52 offset:4096
    ds_read_b128 a[40:43], v53 offset:0
    ds_read_b128 a[44:47], v53 offset:4096
    ds_read_b128 a[48:51], v54 offset:0
    s_waitcnt lgkmcnt(14)
    v_mfma_f32_32x32x16_bf16 v[96:111], v[128:131], a[224:227], v[96:111]
    ds_read_b128 a[52:55], v54 offset:4096
    ds_read_b128 a[56:59], v55 offset:0
    ds_read_b128 a[60:63], v55 offset:4096
    buffer_load_dwordx4 v43, s[4:7], s23 offen offset:3072 lds
    ds_read_b64_tr_b16 v[152:153], v22 offset:55296
    s_waitcnt lgkmcnt(14)
    v_mfma_f32_32x32x16_bf16 v[112:127], v[132:135], a[224:227], v[112:127]
    ds_read_b64_tr_b16 v[154:155], v22 offset:55808
    ds_read_b64_tr_b16 v[156:157], v23 offset:55296
    ds_read_b64_tr_b16 v[158:159], v23 offset:55808
    s_waitcnt lgkmcnt(4)
    s_add_u32 s12, s23, 131072
    v_mfma_f32_32x32x16_bf16 v[96:111], v[136:139], a[228:231], v[96:111]
    s_add_u32 m0, s36, 4096
    s_nop 0
    buffer_load_dwordx4 v40, s[4:7], s12 offen offset:0 lds
    ds_read_b64_tr_b16 v[128:129], v22 offset:57344
    ds_read_b64_tr_b16 v[130:131], v22 offset:57856
    ds_read_b64_tr_b16 v[132:133], v23 offset:57344
    v_mfma_f32_32x32x16_bf16 v[112:127], v[140:143], a[228:231], v[112:127]
    ds_read_b64_tr_b16 v[134:135], v23 offset:57856
    buffer_load_dwordx4 v41, s[4:7], s12 offen offset:1024 lds
    ds_read_b64_tr_b16 v[136:137], v22 offset:59392
    ds_read_b64_tr_b16 v[138:139], v22 offset:59904
    ds_read_b64_tr_b16 v[140:141], v23 offset:59392
    v_mfma_f32_32x32x16_bf16 v[96:111], v[144:147], a[232:235], v[96:111]
    ds_read_b64_tr_b16 v[142:143], v23 offset:59904
    v_mfma_f32_32x32x16_bf16 v[112:127], v[148:151], a[232:235], v[112:127]
    buffer_load_dwordx4 v42, s[4:7], s12 offen offset:2048 lds
    ds_read_b64_tr_b16 v[144:145], v22 offset:61440
    ds_read_b64_tr_b16 v[146:147], v22 offset:61952
    ds_read_b64_tr_b16 v[148:149], v23 offset:61440
    ds_read_b64_tr_b16 v[150:151], v23 offset:61952
    s_waitcnt lgkmcnt(14)
    v_mfma_f32_32x32x16_bf16 v[96:111], v[152:155], a[236:239], v[96:111]
    s_waitcnt lgkmcnt(12)
    v_mfma_f32_32x32x16_bf16 v[112:127], v[156:159], a[236:239], v[112:127]
    s_waitcnt vmcnt(7)
    ds_read_b128 a[64:67], v56 offset:0
    ds_read_b128 a[68:71], v56 offset:4096
L_pad_roleC_H:
L_pad_roleC_2:
    s_cbranch_execz L_pad_pg0_0
    ds_read_b128 a[72:75], v57 offset:0
    ds_read_b128 a[76:79], v57 offset:4096
    ds_read_b128 a[80:83], v58 offset:0
    s_waitcnt lgkmcnt(14)
    v_mfma_f32_32x32x16_bf16 v[96:111], v[128:131], a[240:243], v[96:111]
    ds_read_b128 a[84:87], v58 offset:4096
    ds_read_b128 a[88:91], v59 offset:0
    ds_read_b128 a[92:95], v59 offset:4096
    buffer_load_dwordx4 v43, s[4:7], s12 offen offset:3072 lds
    ds_read_b64_tr_b16 v[152:153], v22 offset:63488
    s_waitcnt lgkmcnt(14)
    v_mfma_f32_32x32x16_bf16 v[112:127], v[132:135], a[240:243], v[112:127]
    ds_read_b64_tr_b16 v[154:155], v22 offset:64000
    ds_read_b64_tr_b16 v[156:157], v23 offset:63488
    ds_read_b64_tr_b16 v[158:159], v23 offset:64000
    s_waitcnt lgkmcnt(4)
    s_add_u32 m0, s37, 0
    v_mfma_f32_32x32x16_bf16 v[96:111], v[136:139], a[244:247], v[96:111]
    buffer_load_dwordx4 v40, s[4:7], s26 offen offset:0 lds
    v_mfma_f32_32x32x16_bf16 v[112:127], v[140:143], a[244:247], v[112:127]
    buffer_load_dwordx4 v41, s[4:7], s26 offen offset:1024 lds
    v_mfma_f32_32x32x16_bf16 v[96:111], v[144:147], a[248:251], v[96:111]
    v_mfma_f32_32x32x16_bf16 v[112:127], v[148:151], a[248:251], v[112:127]
    buffer_load_dwordx4 v42, s[4:7], s26 offen offset:2048 lds
    s_waitcnt lgkmcnt(2)
    v_mfma_f32_32x32x16_bf16 v[96:111], v[152:155], a[252:255], v[96:111]
    s_waitcnt lgkmcnt(0)
    v_mfma_f32_32x32x16_bf16 v[112:127], v[156:159], a[252:255], v[112:127]
    s_lshl_b32 s68, s58, 1
    s_sub_u32 s68, s68, 18
    s_lshl_b32 s68, s68, 12
    s_add_u32 s68, s68, 5242880
    s_mul_i32 s77, s79, 45056
    s_add_u32 s77, s77, s68
    s_add_u32 s78, s77, 2048
    s_nop 2
    v_pk_mul_f32 v[160:161], v[96:97], v[96:97]
    v_pk_mul_f32 v[162:163], v[98:99], v[98:99]
    v_pk_mul_f32 v[164:165], v[100:101], v[100:101]
    v_pk_mul_f32 v[166:167], v[102:103], v[102:103]
    v_pk_fma_f32 v[160:161], v[160:161], s[62:63], v[38:39]
    v_pk_fma_f32 v[162:163], v[162:163], s[62:63], v[38:39]
    v_pk_fma_f32 v[164:165], v[164:165], s[62:63], v[38:39]
    v_pk_fma_f32 v[166:167], v[166:167], s[62:63], v[38:39]
    buffer_load_dwordx4 v43, s[4:7], s26 offen offset:3072 lds
    v_pk_mul_f32 v[160:161], v[160:161], v[96:97]
    v_pk_mul_f32 v[162:163], v[162:163], v[98:99]
    v_pk_mul_f32 v[164:165], v[164:165], v[100:101]
    v_pk_mul_f32 v[166:167], v[166:167], v[102:103]
    v_exp_f32 v160, v160
    v_exp_f32 v161, v161
    v_exp_f32 v162, v162
    v_exp_f32 v163, v163
    s_add_u32 s12, s26, 131072
    s_add_u32 m0, s37, 4096
    s_nop 0
    buffer_load_dwordx4 v40, s[4:7], s12 offen offset:0 lds
    v_exp_f32 v164, v164
    v_exp_f32 v165, v165
    v_exp_f32 v166, v166
    v_exp_f32 v167, v167
    v_pk_add_f32 v[160:161], v[160:161], s[84:85]
    v_pk_add_f32 v[162:163], v[162:163], s[84:85]
    v_pk_add_f32 v[164:165], v[164:165], s[84:85]
    v_pk_add_f32 v[166:167], v[166:167], s[84:85]
    buffer_load_dwordx4 v41, s[4:7], s12 offen offset:1024 lds
    v_rcp_f32 v160, v160
    v_rcp_f32 v161, v161
    v_rcp_f32 v162, v162
    v_rcp_f32 v163, v163
    v_rcp_f32 v164, v164
    v_rcp_f32 v165, v165
    v_rcp_f32 v166, v166
    v_rcp_f32 v167, v167
    buffer_load_dwordx4 v42, s[4:7], s12 offen offset:2048 lds
    v_pk_mul_f32 v[96:97], v[96:97], v[160:161]
    v_pk_mul_f32 v[98:99], v[98:99], v[162:163]
    v_pk_mul_f32 v[100:101], v[100:101], v[164:165]
    v_pk_mul_f32 v[102:103], v[102:103], v[166:167]
    v_cvt_pk_bf16_f32 v208, v96, v97
    v_cvt_pk_bf16_f32 v209, v98, v99
    v_cvt_pk_bf16_f32 v210, v100, v101
    v_cvt_pk_bf16_f32 v211, v102, v103
    buffer_load_dwordx4 v43, s[4:7], s12 offen offset:3072 lds
    buffer_store_dwordx4 v[208:211], v24, s[48:51], s77 offen offset:0 sc1
    v_pk_mul_f32 v[160:161], v[104:105], v[104:105]
    v_pk_mul_f32 v[162:163], v[106:107], v[106:107]
    v_pk_mul_f32 v[164:165], v[108:109], v[108:109]
    v_pk_mul_f32 v[166:167], v[110:111], v[110:111]
    v_pk_fma_f32 v[160:161], v[160:161], s[62:63], v[38:39]
    v_pk_fma_f32 v[162:163], v[162:163], s[62:63], v[38:39]
    v_pk_fma_f32 v[164:165], v[164:165], s[62:63], v[38:39]
    s_add_u32 m0, s37, 8192
    s_nop 0
    buffer_load_dwordx4 v40, s[4:7], s27 offen offset:0 lds
    v_pk_fma_f32 v[166:167], v[166:167], s[62:63], v[38:39]
    v_pk_mul_f32 v[160:161], v[160:161], v[104:105]
    v_pk_mul_f32 v[162:163], v[162:163], v[106:107]
    v_pk_mul_f32 v[164:165], v[164:165], v[108:109]
    v_pk_mul_f32 v[166:167], v[166:167], v[110:111]
    v_exp_f32 v160, v160
    v_exp_f32 v161, v161
    v_exp_f32 v162, v162
    buffer_load_dwordx4 v41, s[4:7], s27 offen offset:1024 lds
    v_exp_f32 v163, v163
    v_exp_f32 v164, v164
    v_exp_f32 v165, v165
    v_exp_f32 v166, v166
    v_exp_f32 v167, v167
    v_pk_add_f32 v[160:161], v[160:161], s[84:85]
    v_pk_add_f32 v[162:163], v[162:163], s[84:85]
    v_pk_add_f32 v[164:165], v[164:165], s[84:85]
    buffer_load_dwordx4 v42, s[4:7], s27 offen offset:2048 lds
    v_pk_add_f32 v[166:167], v[166:167], s[84:85]
    v_rcp_f32 v160, v160
    v_rcp_f32 v161, v161
    v_rcp_f32 v162, v162
    v_rcp_f32 v163, v163
    v_rcp_f32 v164, v164
    v_rcp_f32 v165, v165
    v_rcp_f32 v166, v166
    buffer_load_dwordx4 v43, s[4:7], s27 offen offset:3072 lds
    v_rcp_f32 v167, v167
    v_pk_mul_f32 v[104:105], v[104:105], v[160:161]
    v_pk_mul_f32 v[106:107], v[106:107], v[162:163]
    v_pk_mul_f32 v[108:109], v[108:109], v[164:165]
    v_pk_mul_f32 v[110:111], v[110:111], v[166:167]
    v_cvt_pk_bf16_f32 v212, v104, v105
    v_cvt_pk_bf16_f32 v213, v106, v107
    v_cvt_pk_bf16_f32 v214, v108, v109
    s_add_u32 s12, s27, 131072
    s_add_u32 m0, s37, 12288
    s_nop 0
    buffer_load_dwordx4 v40, s[4:7], s12 offen offset:0 lds
    v_cvt_pk_bf16_f32 v215, v110, v111
    buffer_store_dwordx4 v[212:215], v24, s[48:51], s77 offen offset:1024 sc1
    s_mov_b32 s97, 65536
    buffer_load_dword v14, v8, s[48:51], s97 offen sc1
    v_pk_mul_f32 v[160:161], v[112:113], v[112:113]
    v_pk_mul_f32 v[162:163], v[114:115], v[114:115]
    v_pk_mul_f32 v[164:165], v[116:117], v[116:117]
    v_pk_mul_f32 v[166:167], v[118:119], v[118:119]
    v_pk_fma_f32 v[160:161], v[160:161], s[62:63], v[38:39]
    v_pk_fma_f32 v[162:163], v[162:163], s[62:63], v[38:39]
    buffer_load_dwordx4 v41, s[4:7], s12 offen offset:1024 lds
    v_pk_fma_f32 v[164:165], v[164:165], s[62:63], v[38:39]
    v_pk_fma_f32 v[166:167], v[166:167], s[62:63], v[38:39]
    v_pk_mul_f32 v[160:161], v[160:161], v[112:113]
    v_pk_mul_f32 v[162:163], v[162:163], v[114:115]
    v_pk_mul_f32 v[164:165], v[164:165], v[116:117]
    v_pk_mul_f32 v[166:167], v[166:167], v[118:119]
    v_exp_f32 v160, v160
    v_exp_f32 v161, v161
    buffer_load_dwordx4 v42, s[4:7], s12 offen offset:2048 lds
    v_exp_f32 v162, v162
    v_exp_f32 v163, v163
    v_exp_f32 v164, v164
    v_exp_f32 v165, v165
    v_exp_f32 v166, v166
    v_exp_f32 v167, v167
    v_pk_add_f32 v[160:161], v[160:161], s[84:85]
    v_pk_add_f32 v[162:163], v[162:163], s[84:85]
    buffer_load_dwordx4 v43, s[4:7], s12 offen offset:3072 lds
    v_pk_add_f32 v[164:165], v[164:165], s[84:85]
    v_pk_add_f32 v[166:167], v[166:167], s[84:85]
    v_rcp_f32 v160, v160
    v_rcp_f32 v161, v161
    v_rcp_f32 v162, v162
    v_rcp_f32 v163, v163
    v_rcp_f32 v164, v164
    v_rcp_f32 v165, v165
    v_rcp_f32 v166, v166
    v_rcp_f32 v167, v167
    v_pk_mul_f32 v[112:113], v[112:113], v[160:161]
    v_pk_mul_f32 v[114:115], v[114:115], v[162:163]
    v_pk_mul_f32 v[116:117], v[116:117], v[164:165]
    v_pk_mul_f32 v[118:119], v[118:119], v[166:167]
    v_cvt_pk_bf16_f32 v216, v112, v113
    v_cvt_pk_bf16_f32 v217, v114, v115
    v_cvt_pk_bf16_f32 v218, v116, v117
    v_cvt_pk_bf16_f32 v219, v118, v119
    buffer_store_dwordx4 v[216:219], v24, s[48:51], s78 offen offset:0 sc1
    v_pk_mul_f32 v[160:161], v[120:121], v[120:121]
    v_pk_mul_f32 v[162:163], v[122:123], v[122:123]
    v_pk_mul_f32 v[164:165], v[124:125], v[124:125]
    v_pk_mul_f32 v[166:167], v[126:127], v[126:127]
    v_pk_fma_f32 v[160:161], v[160:161], s[62:63], v[38:39]
    v_pk_fma_f32 v[162:163], v[162:163], s[62:63], v[38:39]
    v_pk_fma_f32 v[164:165], v[164:165], s[62:63], v[38:39]
    v_pk_fma_f32 v[166:167], v[166:167], s[62:63], v[38:39]
    v_pk_mul_f32 v[160:161], v[160:161], v[120:121]
    v_pk_mul_f32 v[162:163], v[162:163], v[122:123]
    v_pk_mul_f32 v[164:165], v[164:165], v[124:125]
    v_pk_mul_f32 v[166:167], v[166:167], v[126:127]
    v_exp_f32 v160, v160
    v_exp_f32 v161, v161
    v_exp_f32 v162, v162
    v_exp_f32 v163, v163
    v_exp_f32 v164, v164
    v_exp_f32 v165, v165
    v_exp_f32 v166, v166
    v_exp_f32 v167, v167
    v_pk_add_f32 v[160:161], v[160:161], s[84:85]
    v_pk_add_f32 v[162:163], v[162:163], s[84:85]
    v_pk_add_f32 v[164:165], v[164:165], s[84:85]
    v_pk_add_f32 v[166:167], v[166:167], s[84:85]
    v_rcp_f32 v160, v160
    v_rcp_f32 v161, v161
    v_rcp_f32 v162, v162
    v_rcp_f32 v163, v163
    v_rcp_f32 v164, v164
    v_rcp_f32 v165, v165
    v_rcp_f32 v166, v166
    v_rcp_f32 v167, v167
    v_pk_mul_f32 v[120:121], v[120:121], v[160:161]
    v_pk_mul_f32 v[122:123], v[122:123], v[162:163]
    v_pk_mul_f32 v[124:125], v[124:125], v[164:165]
    v_pk_mul_f32 v[126:127], v[126:127], v[166:167]
    v_cvt_pk_bf16_f32 v220, v120, v121
    v_cvt_pk_bf16_f32 v221, v122, v123
    v_cvt_pk_bf16_f32 v222, v124, v125
    v_cvt_pk_bf16_f32 v223, v126, v127
    buffer_store_dwordx4 v[220:223], v24, s[48:51], s78 offen offset:1024 sc1
    s_waitcnt vmcnt(0)
    s_lshl4_add_u32 s64, s57, s58
    s_lshl4_add_u32 s64, s64, s56
    s_lshl_b32 s64, s64, 2
    s_add_u32 s64, s64, 131072
    v_mov_b32 v30, s61
    buffer_store_dword v30, off, s[48:51], s64 sc1
    s_branch L_p1_done
L_roleD:
L_pad_roleD_0:
    s_cbranch_execz L_hopret
    v_lshrrev_b32 v1, 3, v0
    v_lshlrev_b32 v1, 12, v1
    v_and_b32 v2, 7, v0
    v_lshl_add_u32 v44, v2, 7, v1
    v_lshlrev_b32 v46, 10, v0
    v_mov_b32 v47, v46
    v_mov_b32 v1, 0x40000000
    v_cmp_lt_u32 vcc, 21, v0
    s_nop 1
    v_cndmask_b32 v46, v46, v1, vcc
    v_cmp_lt_u32 vcc, 15, v0
    s_nop 1
    v_cndmask_b32 v47, v47, v1, vcc
    s_mov_b32 s8, s30
    s_mov_b32 s9, s31
    s_mov_b32 s10, 0xac000
    s_mov_b32 s11, 0x20000
    s_mov_b32 s40, s20
    s_mov_b32 s41, s21
    s_mov_b32 s42, 0x80000
    s_mov_b32 s43, 0x20000
    s_sub_u32 s68, s58, 8
    s_lshl_b32 s68, s68, 12
    s_add_u32 s68, s68, 8388608
    s_mul_i32 s77, s79, 32768
    s_add_u32 s77, s77, s68
    s_add_u32 s78, s77, 2048
    v_pk_mul_f32 v[160:161], v[64:65], s[100:101]
    v_pk_mul_f32 v[162:163], v[66:67], s[100:101]
    v_pk_mul_f32 v[164:165], v[68:69], s[100:101]
    v_pk_mul_f32 v[166:167], v[70:71], s[100:101]
    v_exp_f32_e64 v160, v160 clamp
    v_exp_f32_e64 v161, v161 clamp
    v_exp_f32_e64 v162, v162 clamp
    v_exp_f32_e64 v163, v163 clamp
    s_add_u32 s12, s15, 0
    s_and_b32 s12, s12, 7
    s_mul_i32 s12, s12, s80
    s_add_u32 s12, s12, s73
    s_add_u32 m0, s72, 98304
    s_nop 0
    buffer_load_dwordx4 v12, s[44:47], s12 offen lds
    v_exp_f32_e64 v164, v164 clamp
    v_exp_f32_e64 v165, v165 clamp
    v_exp_f32_e64 v166, v166 clamp
    v_exp_f32_e64 v167, v167 clamp
    v_max_f32 v64, s83, v64
    v_max_f32 v65, s83, v65
    v_max_f32 v66, s83, v66
    v_max_f32 v67, s83, v67
    buffer_load_dwordx4 v13, s[44:47], s12 offen offset:1024 lds
    v_max_f32 v68, s83, v68
    v_max_f32 v69, s83, v69
    v_max_f32 v70, s83, v70
    v_max_f32 v71, s83, v71
    v_pk_add_f32 v[64:65], v[64:65], v[160:161]
    v_pk_add_f32 v[66:67], v[66:67], v[162:163]
    v_pk_add_f32 v[68:69], v[68:69], v[164:165]
    v_pk_add_f32 v[70:71], v[70:71], v[166:167]
    s_add_u32 s12, s15, 1
    s_and_b32 s12, s12, 7
    s_mul_i32 s12, s12, s80
    s_add_u32 s12, s12, s73
    s_add_u32 m0, s72, 106496
    s_nop 0
    buffer_load_dwordx4 v12, s[44:47], s12 offen lds
    v_cvt_pk_bf16_f32 v208, v64, v65
    v_cvt_pk_bf16_f32 v209, v66, v67
    v_cvt_pk_bf16_f32 v210, v68, v69
    v_cvt_pk_bf16_f32 v211, v70, v71
    buffer_store_dwordx4 v[208:211], v24, s[48:51], s77 offen offset:0 sc1
    v_pk_mul_f32 v[160:161], v[72:73], s[100:101]
    v_pk_mul_f32 v[162:163], v[74:75], s[100:101]
    v_pk_mul_f32 v[164:165], v[76:77], s[100:101]
    buffer_load_dwordx4 v13, s[44:47], s12 offen offset:1024 lds
    v_pk_mul_f32 v[166:167], v[78:79], s[100:101]
    v_exp_f32_e64 v160, v160 clamp
    v_exp_f32_e64 v161, v161 clamp
    v_exp_f32_e64 v162, v162 clamp
    v_exp_f32_e64 v163, v163 clamp
    v_exp_f32_e64 v164, v164 clamp
    v_exp_f32_e64 v165, v165 clamp
    v_exp_f32_e64 v166, v166 clamp
    s_add_u32 s12, s15, 2
    s_and_b32 s12, s12, 7
    s_mul_i32 s12, s12, s80
    s_add_u32 s12, s12, s73
    s_add_u32 m0, s72, 114688
    s_nop 0
    buffer_load_dwordx4 v12, s[44:47], s12 offen lds
    v_exp_f32_e64 v167, v167 clamp
    v_max_f32 v72, s83, v72
    v_max_f32 v73, s83, v73
    v_max_f32 v74, s83, v74
    v_max_f32 v75, s83, v75
    v_max_f32 v76, s83, v76
    v_max_f32 v77, s83, v77
    v_max_f32 v78, s83, v78
    buffer_load_dwordx4 v13, s[44:47], s12 offen offset:1024 lds
    v_max_f32 v79, s83, v79
    v_pk_add_f32 v[72:73], v[72:73], v[160:161]
    v_pk_add_f32 v[74:75], v[74:75], v[162:163]
    v_pk_add_f32 v[76:77], v[76:77], v[164:165]
    v_pk_add_f32 v[78:79], v[78:79], v[166:167]
    v_cvt_pk_bf16_f32 v212, v72, v73
    v_cvt_pk_bf16_f32 v213, v74, v75
    v_cvt_pk_bf16_f32 v214, v76, v77
    s_add_u32 s12, s15, 3
    s_and_b32 s12, s12, 7
    s_mul_i32 s12, s12, s80
    s_add_u32 s12, s12, s73
    s_add_u32 m0, s72, 122880
    s_nop 0
    buffer_load_dwordx4 v12, s[44:47], s12 offen lds
    v_cvt_pk_bf16_f32 v215, v78, v79
    buffer_store_dwordx4 v[212:215], v24, s[48:51], s77 offen offset:1024 sc1
    v_pk_mul_f32 v[160:161], v[80:81], s[100:101]
    v_pk_mul_f32 v[162:163], v[82:83], s[100:101]
    v_pk_mul_f32 v[164:165], v[84:85], s[100:101]
    v_pk_mul_f32 v[166:167], v[86:87], s[100:101]
    v_exp_f32_e64 v160, v160 clamp
    v_exp_f32_e64 v161, v161 clamp
    buffer_load_dwordx4 v13, s[44:47], s12 offen offset:1024 lds
    v_exp_f32_e64 v162, v162 clamp
    v_exp_f32_e64 v163, v163 clamp
    v_exp_f32_e64 v164, v164 clamp
    v_exp_f32_e64 v165, v165 clamp
    v_exp_f32_e64 v166, v166 clamp
    v_exp_f32_e64 v167, v167 clamp
    v_max_f32 v80, s83, v80
    v_max_f32 v81, s83, v81
    s_add_u32 m0, s36, 0
    s_nop 0
    buffer_load_dwordx4 v40, s[4:7], s16 offen offset:0 lds
    v_max_f32 v82, s83, v82
    v_max_f32 v83, s83, v83
    v_max_f32 v84, s83, v84
    v_max_f32 v85, s83, v85
    v_max_f32 v86, s83, v86
    v_max_f32 v87, s83, v87
    v_pk_add_f32 v[80:81], v[80:81], v[160:161]
    v_pk_add_f32 v[82:83], v[82:83], v[162:163]
    buffer_load_dwordx4 v41, s[4:7], s16 offen offset:1024 lds
    v_pk_add_f32 v[84:85], v[84:85], v[164:165]
    v_pk_add_f32 v[86:87], v[86:87], v[166:167]
    v_cvt_pk_bf16_f32 v216, v80, v81
    v_cvt_pk_bf16_f32 v217, v82, v83
    v_cvt_pk_bf16_f32 v218, v84, v85
    v_cvt_pk_bf16_f32 v219, v86, v87
    buffer_store_dwordx4 v[216:219], v24, s[48:51], s78 offen offset:0 sc1
    v_pk_mul_f32 v[160:161], v[88:89], s[100:101]
    buffer_load_dwordx4 v42, s[4:7], s16 offen offset:2048 lds
    v_pk_mul_f32 v[162:163], v[90:91], s[100:101]
    v_pk_mul_f32 v[164:165], v[92:93], s[100:101]
    v_pk_mul_f32 v[166:167], v[94:95], s[100:101]
    v_exp_f32_e64 v160, v160 clamp
    v_exp_f32_e64 v161, v161 clamp
    v_exp_f32_e64 v162, v162 clamp
    v_exp_f32_e64 v163, v163 clamp
    v_exp_f32_e64 v164, v164 clamp
    buffer_load_dwordx4 v43, s[4:7], s16 offen offset:3072 lds
    v_exp_f32_e64 v165, v165 clamp
    v_exp_f32_e64 v166, v166 clamp
    v_exp_f32_e64 v167, v167 clamp
    v_max_f32 v88, s83, v88
    v_max_f32 v89, s83, v89
    v_max_f32 v90, s83, v90
    v_max_f32 v91, s83, v91
    v_max_f32 v92, s83, v92
    s_add_u32 s12, s16, 131072
    s_add_u32 m0, s36, 4096
    s_nop 0
    buffer_load_dwordx4 v40, s[4:7], s12 offen offset:0 lds
    v_max_f32 v93, s83, v93
    v_max_f32 v94, s83, v94
    v_max_f32 v95, s83, v95
    v_pk_add_f32 v[88:89], v[88:89], v[160:161]
    v_pk_add_f32 v[90:91], v[90:91], v[162:163]
    v_pk_add_f32 v[92:93], v[92:93], v[164:165]
    v_pk_add_f32 v[94:95], v[94:95], v[166:167]
    v_cvt_pk_bf16_f32 v220, v88, v89
    buffer_load_dwordx4 v41, s[4:7], s12 offen offset:1024 lds
    v_cvt_pk_bf16_f32 v221, v90, v91
    v_cvt_pk_bf16_f32 v222, v92, v93
    v_cvt_pk_bf16_f32 v223, v94, v95
    buffer_store_dwordx4 v[220:223], v24, s[48:51], s78 offen offset:1024 sc1
    s_waitcnt vmcnt(8)
    s_barrier
    v_add_u32 v22, 98304, v22
    v_add_u32 v23, 98304, v23
    buffer_load_dwordx4 v42, s[4:7], s12 offen offset:2048 lds
    buffer_load_dwordx4 v43, s[4:7], s12 offen offset:3072 lds
    s_mov_b32 s52, s32
    s_mov_b32 s53, s33
    s_mov_b32 s54, 0x400
    s_mov_b32 s55, 0x20000
    s_lshl_b32 s64, s56, 10
    s_add_u32 m0, s64, 0
    s_lshl_b32 s64, s15, 7
    v_add_u32 v1, s64, v24
    v_and_b32 v1, 1023, v1
    buffer_load_dwordx4 v1, s[52:55], 0 offen lds
    ds_read_b64_tr_b16 v[128:129], v22 offset:0
    ds_read_b64_tr_b16 v[130:131], v22 offset:512
    ds_read_b64_tr_b16 v[132:133], v23 offset:0
    ds_read_b64_tr_b16 v[134:135], v23 offset:512
    ds_read_b64_tr_b16 v[136:137], v22 offset:2048
    s_waitcnt lgkmcnt(3)
    v_mfma_f32_32x32x16_bf16 v[96:111], v[128:131], a[128:131], 0
    ds_read_b64_tr_b16 v[138:139], v22 offset:2560
    ds_read_b64_tr_b16 v[140:141], v23 offset:2048
    ds_read_b64_tr_b16 v[142:143], v23 offset:2560
    ds_read_b64_tr_b16 v[144:145], v22 offset:4096
    ds_read_b64_tr_b16 v[146:147], v22 offset:4608
    s_waitcnt lgkmcnt(6)
    v_mfma_f32_32x32x16_bf16 v[112:127], v[132:135], a[128:131], 0
    ds_read_b64_tr_b16 v[148:149], v23 offset:4096
    ds_read_b64_tr_b16 v[150:151], v23 offset:4608
    ds_read_b64_tr_b16 v[152:153], v22 offset:6144
    ds_read_b64_tr_b16 v[154:155], v22 offset:6656
    ds_read_b64_tr_b16 v[156:157], v23 offset:6144
    s_waitcnt lgkmcnt(9)
    v_mfma_f32_32x32x16_bf16 v[96:111], v[136:139], a[132:135], v[96:111]
    ds_read_b64_tr_b16 v[158:159], v23 offset:6656
    ds_read_b64_tr_b16 v[128:129], v22 offset:8192
    ds_read_b64_tr_b16 v[130:131], v22 offset:8704
    ds_read_b64_tr_b16 v[132:133], v23 offset:8192
    ds_read_b64_tr_b16 v[134:135], v23 offset:8704
    s_waitcnt lgkmcnt(12)
    v_mfma_f32_32x32x16_bf16 v[112:127], v[140:143], a[132:135], v[112:127]
    ds_read_b64_tr_b16 v[136:137], v22 offset:10240
    ds_read_b64_tr_b16 v[138:139], v22 offset:10752
    ds_read_b64_tr_b16 v[140:141], v23 offset:10240
    ds_read_b64_tr_b16 v[142:143], v23 offset:10752
    s_waitcnt lgkmcnt(14)
    v_mfma_f32_32x32x16_bf16 v[96:111], v[144:147], a[136:139], v[96:111]
    s_waitcnt lgkmcnt(12)
    v_mfma_f32_32x32x16_bf16 v[112:127], v[148:151], a[136:139], v[112:127]
    ds_read_b64_tr_b16 v[144:145], v22 offset:12288
    ds_read_b64_tr_b16 v[146:147], v22 offset:12800
    ds_read_b64_tr_b16 v[148:149], v23 offset:12288
    ds_read_b64_tr_b16 v[150:151], v23 offset:12800
    s_waitcnt lgkmcnt(14)
    v_mfma_f32_32x32x16_bf16 v[96:111], v[152:155], a[140:143], v[96:111]
    s_waitcnt lgkmcnt(12)
    v_mfma_f32_32x32x16_bf16 v[112:127], v[156:159], a[140:143], v[112:127]
    ds_read_b64_tr_b16 v[152:153], v22 offset:14336
    ds_read_b64_tr_b16 v[154:155], v22 offset:14848
    ds_read_b64_tr_b16 v[156:157], v23 offset:14336
    ds_read_b64_tr_b16 v[158:159], v23 offset:14848
    s_waitcnt lgkmcnt(14)
    v_mfma_f32_32x32x16_bf16 v[96:111], v[128:131], a[144:147], v[96:111]
    s_waitcnt lgkmcnt(12)
    v_mfma_f32_32x32x16_bf16 v[112:127], v[132:135], a[144:147], v[112:127]
    ds_read_b64_tr_b16 v[128:129], v22 offset:16384
    ds_read_b64_tr_b16 v[130:131], v22 offset:16896
    ds_read_b64_tr_b16 v[132:133], v23 offset:16384
    ds_read_b64_tr_b16 v[134:135], v23 offset:16896
    s_waitcnt lgkmcnt(14)
    v_mfma_f32_32x32x16_bf16 v[96:111], v[136:139], a[148:151], v[96:111]
    s_waitcnt lgkmcnt(12)
    v_mfma_f32_32x32x16_bf16 v[112:127], v[140:143], a[148:151], v[112:127]
    ds_read_b64_tr_b16 v[136:137], v22 offset:18432
    ds_read_b64_tr_b16 v[138:139], v22 offset:18944
    ds_read_b64_tr_b16 v[140:141], v23 offset:18432
    ds_read_b64_tr_b16 v[142:143], v23 offset:18944
    s_waitcnt lgkmcnt(14)
    v_mfma_f32_32x32x16_bf16 v[96:111], v[144:147], a[152:155], v[96:111]
    s_waitcnt lgkmcnt(12)
    v_mfma_f32_32x32x16_bf16 v[112:127], v[148:151], a[152:155], v[112:127]
    ds_read_b64_tr_b16 v[144:145], v22 offset:20480
    ds_read_b64_tr_b16 v[146:147], v22 offset:20992
    ds_read_b64_tr_b16 v[148:149], v23 offset:20480
    ds_read_b64_tr_b16 v[150:151], v23 offset:20992
    s_waitcnt lgkmcnt(14)
    v_mfma_f32_32x32x16_bf16 v[96:111], v[152:155], a[156:159], v[96:111]
    s_waitcnt lgkmcnt(12)
    v_mfma_f32_32x32x16_bf16 v[112:127], v[156:159], a[156:159], v[112:127]
    ds_read_b64_tr_b16 v[152:153], v22 offset:22528
    ds_read_b64_tr_b16 v[154:155], v22 offset:23040
    ds_read_b64_tr_b16 v[156:157], v23 offset:22528
    ds_read_b64_tr_b16 v[158:159], v23 offset:23040
    s_waitcnt lgkmcnt(14)
    v_mfma_f32_32x32x16_bf16 v[96:111], v[128:131], a[160:163], v[96:111]
    s_waitcnt lgkmcnt(12)
    v_mfma_f32_32x32x16_bf16 v[112:127], v[132:135], a[160:163], v[112:127]
    ds_read_b64_tr_b16 v[128:129], v22 offset:24576
    ds_read_b64_tr_b16 v[130:131], v22 offset:25088
    ds_read_b64_tr_b16 v[132:133], v23 offset:24576
    ds_read_b64_tr_b16 v[134:135], v23 offset:25088
    s_waitcnt lgkmcnt(14)
    v_mfma_f32_32x32x16_bf16 v[96:111], v[136:139], a[164:167], v[96:111]
    s_waitcnt lgkmcnt(12)
    v_mfma_f32_32x32x16_bf16 v[112:127], v[140:143], a[164:167], v[112:127]
    ds_read_b64_tr_b16 v[136:137], v22 offset:26624
    ds_read_b64_tr_b16 v[138:139], v22 offset:27136
    ds_read_b64_tr_b16 v[140:141], v23 offset:26624
    ds_read_b64_tr_b16 v[142:143], v23 offset:27136
    s_waitcnt lgkmcnt(14)
    v_mfma_f32_32x32x16_bf16 v[96:111], v[144:147], a[168:171], v[96:111]
    s_waitcnt lgkmcnt(12)
    v_mfma_f32_32x32x16_bf16 v[112:127], v[148:151], a[168:171], v[112:127]
    ds_read_b64_tr_b16 v[144:145], v22 offset:28672
    ds_read_b64_tr_b16 v[146:147], v22 offset:29184
    ds_read_b64_tr_b16 v[148:149], v23 offset:28672
    ds_read_b64_tr_b16 v[150:151], v23 offset:29184
    s_waitcnt lgkmcnt(14)
    v_mfma_f32_32x32x16_bf16 v[96:111], v[152:155], a[172:175], v[96:111]
    s_waitcnt lgkmcnt(12)
    v_mfma_f32_32x32x16_bf16 v[112:127], v[156:159], a[172:175], v[112:127]
    ds_read_b64_tr_b16 v[152:153], v22 offset:30720
    ds_read_b64_tr_b16 v[154:155], v22 offset:31232
    ds_read_b64_tr_b16 v[156:157], v23 offset:30720
    ds_read_b64_tr_b16 v[158:159], v23 offset:31232
    s_waitcnt lgkmcnt(14)
    v_mfma_f32_32x32x16_bf16 v[96:111], v[128:131], a[176:179], v[96:111]
    s_waitcnt lgkmcnt(12)
    v_mfma_f32_32x32x16_bf16 v[112:127], v[132:135], a[176:179], v[112:127]
    ds_read_b64_tr_b16 v[128:129], v22 offset:32768
    ds_read_b64_tr_b16 v[130:131], v22 offset:33280
    ds_read_b64_tr_b16 v[132:133], v23 offset:32768
    ds_read_b64_tr_b16 v[134:135], v23 offset:33280
    s_waitcnt lgkmcnt(14)
    v_mfma_f32_32x32x16_bf16 v[96:111], v[136:139], a[180:183], v[96:111]
    s_waitcnt lgkmcnt(12)
    v_mfma_f32_32x32x16_bf16 v[112:127], v[140:143], a[180:183], v[112:127]
    ds_read_b64_tr_b16 v[136:137], v22 offset:34816
    ds_read_b64_tr_b16 v[138:139], v22 offset:35328
    ds_read_b64_tr_b16 v[140:141], v23 offset:34816
    ds_read_b64_tr_b16 v[142:143], v23 offset:35328
    s_waitcnt lgkmcnt(14)
    v_mfma_f32_32x32x16_bf16 v[96:111], v[144:147], a[184:187], v[96:111]
    s_waitcnt lgkmcnt(12)
    v_mfma_f32_32x32x16_bf16 v[112:127], v[148:151], a[184:187], v[112:127]
    ds_read_b64_tr_b16 v[144:145], v22 offset:36864
    ds_read_b64_tr_b16 v[146:147], v22 offset:37376
    ds_read_b64_tr_b16 v[148:149], v23 offset:36864
    ds_read_b64_tr_b16 v[150:151], v23 offset:37376
    s_waitcnt lgkmcnt(14)
    v_mfma_f32_32x32x16_bf16 v[96:111], v[152:155], a[188:191], v[96:111]
    s_waitcnt lgkmcnt(12)
    v_mfma_f32_32x32x16_bf16 v[112:127], v[156:159], a[188:191], v[112:127]
    ds_read_b64_tr_b16 v[152:153], v22 offset:38912
    ds_read_b64_tr_b16 v[154:155], v22 offset:39424
    ds_read_b64_tr_b16 v[156:157], v23 offset:38912
    ds_read_b64_tr_b16 v[158:159], v23 offset:39424
    s_waitcnt lgkmcnt(14)
    v_mfma_f32_32x32x16_bf16 v[96:111], v[128:131], a[192:195], v[96:111]
    s_waitcnt lgkmcnt(12)
    v_mfma_f32_32x32x16_bf16 v[112:127], v[132:135], a[192:195], v[112:127]
    ds_read_b64_tr_b16 v[128:129], v22 offset:40960
    ds_read_b64_tr_b16 v[130:131], v22 offset:41472
    ds_read_b64_tr_b16 v[132:133], v23 offset:40960
    ds_read_b64_tr_b16 v[134:135], v23 offset:41472
    s_waitcnt lgkmcnt(14)
    v_mfma_f32_32x32x16_bf16 v[96:111], v[136:139], a[196:199], v[96:111]
    s_waitcnt lgkmcnt(12)
    v_mfma_f32_32x32x16_bf16 v[112:127], v[140:143], a[196:199], v[112:127]
    ds_read_b64_tr_b16 v[136:137], v22 offset:43008
    ds_read_b64_tr_b16 v[138:139], v22 offset:43520
    ds_read_b64_tr_b16 v[140:141], v23 offset:43008
    ds_read_b64_tr_b16 v[142:143], v23 offset:43520
    s_waitcnt lgkmcnt(14)
    v_mfma_f32_32x32x16_bf16 v[96:111], v[144:147], a[200:203], v[96:111]
    s_waitcnt lgkmcnt(12)
    v_mfma_f32_32x32x16_bf16 v[112:127], v[148:151], a[200:203], v[112:127]
    ds_read_b64_tr_b16 v[144:145], v22 offset:45056
    ds_read_b64_tr_b16 v[146:147], v22 offset:45568
    ds_read_b64_tr_b16 v[148:149], v23 offset:45056
    ds_read_b64_tr_b16 v[150:151], v23 offset:45568
    s_waitcnt lgkmcnt(14)
    v_mfma_f32_32x32x16_bf16 v[96:111], v[152:155], a[204:207], v[96:111]
    s_waitcnt lgkmcnt(12)
    v_mfma_f32_32x32x16_bf16 v[112:127], v[156:159], a[204:207], v[112:127]
    ds_read_b64_tr_b16 v[152:153], v22 offset:47104
    ds_read_b64_tr_b16 v[154:155], v22 offset:47616
    ds_read_b64_tr_b16 v[156:157], v23 offset:47104
    ds_read_b64_tr_b16 v[158:159], v23 offset:47616
    s_waitcnt lgkmcnt(14)
    v_mfma_f32_32x32x16_bf16 v[96:111], v[128:131], a[208:211], v[96:111]
    s_waitcnt lgkmcnt(12)
    v_mfma_f32_32x32x16_bf16 v[112:127], v[132:135], a[208:211], v[112:127]
    ds_read_b64_tr_b16 v[128:129], v22 offset:49152
    ds_read_b64_tr_b16 v[130:131], v22 offset:49664
L_pad_roleD_H:
L_pad_roleD_1:
    s_cbranch_execz L_pad_pg0_0
    ds_read_b64_tr_b16 v[132:133], v23 offset:49152
    ds_read_b64_tr_b16 v[134:135], v23 offset:49664
    s_waitcnt lgkmcnt(14)
    v_mfma_f32_32x32x16_bf16 v[96:111], v[136:139], a[212:215], v[96:111]
    s_waitcnt lgkmcnt(12)
    v_mfma_f32_32x32x16_bf16 v[112:127], v[140:143], a[212:215], v[112:127]
    ds_read_b64_tr_b16 v[136:137], v22 offset:51200
    ds_read_b64_tr_b16 v[138:139], v22 offset:51712
    ds_read_b64_tr_b16 v[140:141], v23 offset:51200
    ds_read_b64_tr_b16 v[142:143], v23 offset:51712
    s_waitcnt lgkmcnt(14)
    v_mfma_f32_32x32x16_bf16 v[96:111], v[144:147], a[216:219], v[96:111]
    s_waitcnt lgkmcnt(12)
    v_mfma_f32_32x32x16_bf16 v[112:127], v[148:151], a[216:219], v[112:127]
    ds_read_b64_tr_b16 v[144:145], v22 offset:53248
    ds_read_b64_tr_b16 v[146:147], v22 offset:53760
    ds_read_b64_tr_b16 v[148:149], v23 offset:53248
    ds_read_b64_tr_b16 v[150:151], v23 offset:53760
    s_waitcnt lgkmcnt(14)
    v_mfma_f32_32x32x16_bf16 v[96:111], v[152:155], a[220:223], v[96:111]
    s_waitcnt lgkmcnt(12)
    v_mfma_f32_32x32x16_bf16 v[112:127], v[156:159], a[220:223], v[112:127]
    ds_read_b64_tr_b16 v[152:153], v22 offset:55296
    ds_read_b64_tr_b16 v[154:155], v22 offset:55808
    ds_read_b64_tr_b16 v[156:157], v23 offset:55296
    ds_read_b64_tr_b16 v[158:159], v23 offset:55808
    s_waitcnt lgkmcnt(14)
    v_mfma_f32_32x32x16_bf16 v[96:111], v[128:131], a[224:227], v[96:111]
    s_waitcnt lgkmcnt(12)
    v_mfma_f32_32x32x16_bf16 v[112:127], v[132:135], a[224:227], v[112:127]
    ds_read_b64_tr_b16 v[128:129], v22 offset:57344
    ds_read_b64_tr_b16 v[130:131], v22 offset:57856
    ds_read_b64_tr_b16 v[132:133], v23 offset:57344
    ds_read_b64_tr_b16 v[134:135], v23 offset:57856
    s_waitcnt lgkmcnt(14)
    v_mfma_f32_32x32x16_bf16 v[96:111], v[136:139], a[228:231], v[96:111]
    s_waitcnt lgkmcnt(12)
    v_mfma_f32_32x32x16_bf16 v[112:127], v[140:143], a[228:231], v[112:127]
    ds_read_b64_tr_b16 v[136:137], v22 offset:59392
    ds_read_b64_tr_b16 v[138:139], v22 offset:59904
    ds_read_b64_tr_b16 v[140:141], v23 offset:59392
    ds_read_b64_tr_b16 v[142:143], v23 offset:59904
    s_waitcnt lgkmcnt(14)
    v_mfma_f32_32x32x16_bf16 v[96:111], v[144:147], a[232:235], v[96:111]
    s_waitcnt lgkmcnt(12)
    v_mfma_f32_32x32x16_bf16 v[112:127], v[148:151], a[232:235], v[112:127]
    ds_read_b64_tr_b16 v[144:145], v22 offset:61440
    ds_read_b64_tr_b16 v[146:147], v22 offset:61952
    ds_read_b64_tr_b16 v[148:149], v23 offset:61440
    ds_read_b64_tr_b16 v[150:151], v23 offset:61952
    s_waitcnt lgkmcnt(14)
    v_mfma_f32_32x32x16_bf16 v[96:111], v[152:155], a[236:239], v[96:111]
    s_waitcnt lgkmcnt(12)
    v_mfma_f32_32x32x16_bf16 v[112:127], v[156:159], a[236:239], v[112:127]
    ds_read_b64_tr_b16 v[152:153], v22 offset:63488
    ds_read_b64_tr_b16 v[154:155], v22 offset:64000
    ds_read_b64_tr_b16 v[156:157], v23 offset:63488
    ds_read_b64_tr_b16 v[158:159], v23 offset:64000
    s_waitcnt lgkmcnt(14)
    v_mfma_f32_32x32x16_bf16 v[96:111], v[128:131], a[240:243], v[96:111]
    s_waitcnt lgkmcnt(12)
    v_mfma_f32_32x32x16_bf16 v[112:127], v[132:135], a[240:243], v[112:127]
    s_waitcnt lgkmcnt(10)
    v_mfma_f32_32x32x16_bf16 v[96:111], v[136:139], a[244:247], v[96:111]
    s_waitcnt lgkmcnt(8)
    v_mfma_f32_32x32x16_bf16 v[112:127], v[140:143], a[244:247], v[112:127]
    s_waitcnt lgkmcnt(6)
    v_mfma_f32_32x32x16_bf16 v[96:111], v[144:147], a[248:251], v[96:111]
    s_waitcnt lgkmcnt(4)
    v_mfma_f32_32x32x16_bf16 v[112:127], v[148:151], a[248:251], v[112:127]
    s_waitcnt lgkmcnt(2)
    v_mfma_f32_32x32x16_bf16 v[96:111], v[152:155], a[252:255], v[96:111]
    s_waitcnt lgkmcnt(0)
    v_mfma_f32_32x32x16_bf16 v[112:127], v[156:159], a[252:255], v[112:127]
    s_barrier
    s_sub_u32 s68, s58, 5
    s_lshl_b32 s68, s68, 12
    s_add_u32 s68, s68, 5242880
    s_mul_i32 s77, s79, 45056
    s_add_u32 s77, s77, s68
    s_add_u32 s78, s77, 2048
    s_nop 2
    v_pk_mul_f32 v[160:161], v[96:97], v[96:97]
    v_pk_mul_f32 v[162:163], v[98:99], v[98:99]
    v_pk_mul_f32 v[164:165], v[100:101], v[100:101]
    v_pk_mul_f32 v[166:167], v[102:103], v[102:103]
    v_pk_fma_f32 v[160:161], v[160:161], s[62:63], v[38:39]
    v_pk_fma_f32 v[162:163], v[162:163], s[62:63], v[38:39]
    v_pk_fma_f32 v[164:165], v[164:165], s[62:63], v[38:39]
    v_pk_fma_f32 v[166:167], v[166:167], s[62:63], v[38:39]
    v_pk_mul_f32 v[160:161], v[160:161], v[96:97]
    v_pk_mul_f32 v[162:163], v[162:163], v[98:99]
    v_pk_mul_f32 v[164:165], v[164:165], v[100:101]
    v_pk_mul_f32 v[166:167], v[166:167], v[102:103]
    s_add_u32 m0, s37, 0
    s_nop 0
    buffer_load_dwordx4 v40, s[4:7], s17 offen offset:0 lds
    v_exp_f32 v160, v160
    v_exp_f32 v161, v161
    v_exp_f32 v162, v162
    v_exp_f32 v163, v163
    v_exp_f32 v164, v164
    v_exp_f32 v165, v165
    v_exp_f32 v166, v166
    v_exp_f32 v167, v167
    v_pk_add_f32 v[160:161], v[160:161], s[84:85]
    v_pk_add_f32 v[162:163], v[162:163], s[84:85]
    v_pk_add_f32 v[164:165], v[164:165], s[84:85]
    v_pk_add_f32 v[166:167], v[166:167], s[84:85]
    buffer_load_dwordx4 v41, s[4:7], s17 offen offset:1024 lds
    v_rcp_f32 v160, v160
    v_rcp_f32 v161, v161
    v_rcp_f32 v162, v162
    v_rcp_f32 v163, v163
    v_rcp_f32 v164, v164
    v_rcp_f32 v165, v165
    v_rcp_f32 v166, v166
    v_rcp_f32 v167, v167
    v_pk_mul_f32 v[96:97], v[96:97], v[160:161]
    v_pk_mul_f32 v[98:99], v[98:99], v[162:163]
    v_pk_mul_f32 v[100:101], v[100:101], v[164:165]
    v_pk_mul_f32 v[102:103], v[102:103], v[166:167]
    buffer_load_dwordx4 v42, s[4:7], s17 offen offset:2048 lds
    v_cvt_pk_bf16_f32 v208, v96, v97
    v_cvt_pk_bf16_f32 v209, v98, v99
    v_cvt_pk_bf16_f32 v210, v100, v101
    v_cvt_pk_bf16_f32 v211, v102, v103
    buffer_store_dwordx4 v[208:211], v24, s[48:51], s77 offen offset:0 sc1
    v_pk_mul_f32 v[160:161], v[104:105], v[104:105]
    v_pk_mul_f32 v[162:163], v[106:107], v[106:107]
    v_pk_mul_f32 v[164:165], v[108:109], v[108:109]
    v_pk_mul_f32 v[166:167], v[110:111], v[110:111]
    v_pk_fma_f32 v[160:161], v[160:161], s[62:63], v[38:39]
    v_pk_fma_f32 v[162:163], v[162:163], s[62:63], v[38:39]
    v_pk_fma_f32 v[164:165], v[164:165], s[62:63], v[38:39]
    buffer_load_dwordx4 v43, s[4:7], s17 offen offset:3072 lds
    v_pk_fma_f32 v[166:167], v[166:167], s[62:63], v[38:39]
    v_pk_mul_f32 v[160:161], v[160:161], v[104:105]
    v_pk_mul_f32 v[162:163], v[162:163], v[106:107]
    v_pk_mul_f32 v[164:165], v[164:165], v[108:109]
    v_pk_mul_f32 v[166:167], v[166:167], v[110:111]
    v_exp_f32 v160, v160
    v_exp_f32 v161, v161
    v_exp_f32 v162, v162
    v_exp_f32 v163, v163
    v_exp_f32 v164, v164
    v_exp_f32 v165, v165
    v_exp_f32 v166, v166
    s_add_u32 s12, s17, 131072
    s_add_u32 m0, s37, 4096
    s_nop 0
    buffer_load_dwordx4 v40, s[4:7], s12 offen offset:0 lds
    v_exp_f32 v167, v167
    v_pk_add_f32 v[160:161], v[160:161], s[84:85]
    v_pk_add_f32 v[162:163], v[162:163], s[84:85]
    v_pk_add_f32 v[164:165], v[164:165], s[84:85]
    v_pk_add_f32 v[166:167], v[166:167], s[84:85]
    v_rcp_f32 v160, v160
    v_rcp_f32 v161, v161
    v_rcp_f32 v162, v162
    v_rcp_f32 v163, v163
    v_rcp_f32 v164, v164
    v_rcp_f32 v165, v165
    v_rcp_f32 v166, v166
    buffer_load_dwordx4 v41, s[4:7], s12 offen offset:1024 lds
    v_rcp_f32 v167, v167
    v_pk_mul_f32 v[104:105], v[104:105], v[160:161]
    v_pk_mul_f32 v[106:107], v[106:107], v[162:163]
    v_pk_mul_f32 v[108:109], v[108:109], v[164:165]
    v_pk_mul_f32 v[110:111], v[110:111], v[166:167]
    v_cvt_pk_bf16_f32 v212, v104, v105
    v_cvt_pk_bf16_f32 v213, v106, v107
    v_cvt_pk_bf16_f32 v214, v108, v109
    v_cvt_pk_bf16_f32 v215, v110, v111
    buffer_store_dwordx4 v[212:215], v24, s[48:51], s77 offen offset:1024 sc1
    v_pk_mul_f32 v[160:161], v[112:113], v[112:113]
    v_pk_mul_f32 v[162:163], v[114:115], v[114:115]
    buffer_load_dwordx4 v42, s[4:7], s12 offen offset:2048 lds
    v_pk_mul_f32 v[164:165], v[116:117], v[116:117]
    v_pk_mul_f32 v[166:167], v[118:119], v[118:119]
    v_pk_fma_f32 v[160:161], v[160:161], s[62:63], v[38:39]
    v_pk_fma_f32 v[162:163], v[162:163], s[62:63], v[38:39]
    v_pk_fma_f32 v[164:165], v[164:165], s[62:63], v[38:39]
    v_pk_fma_f32 v[166:167], v[166:167], s[62:63], v[38:39]
    v_pk_mul_f32 v[160:161], v[160:161], v[112:113]
    v_pk_mul_f32 v[162:163], v[162:163], v[114:115]
    v_pk_mul_f32 v[164:165], v[164:165], v[116:117]
    v_pk_mul_f32 v[166:167], v[166:167], v[118:119]
    v_exp_f32 v160, v160
    v_exp_f32 v161, v161
    buffer_load_dwordx4 v43, s[4:7], s12 offen offset:3072 lds
    v_exp_f32 v162, v162
    v_exp_f32 v163, v163
    v_exp_f32 v164, v164
    v_exp_f32 v165, v165
    v_exp_f32 v166, v166
    v_exp_f32 v167, v167
    v_pk_add_f32 v[160:161], v[160:161], s[84:85]
    v_pk_add_f32 v[162:163], v[162:163], s[84:85]
    v_pk_add_f32 v[164:165], v[164:165], s[84:85]
    v_pk_add_f32 v[166:167], v[166:167], s[84:85]
    v_rcp_f32 v160, v160
    v_rcp_f32 v161, v161
    s_add_u32 m0, s37, 8192
    s_nop 0
    buffer_load_dwordx4 v40, s[4:7], s22 offen offset:0 lds
    v_rcp_f32 v162, v162
    v_rcp_f32 v163, v163
    v_rcp_f32 v164, v164
    v_rcp_f32 v165, v165
    v_rcp_f32 v166, v166
    v_rcp_f32 v167, v167
    v_pk_mul_f32 v[112:113], v[112:113], v[160:161]
    v_pk_mul_f32 v[114:115], v[114:115], v[162:163]
    v_pk_mul_f32 v[116:117], v[116:117], v[164:165]
    v_pk_mul_f32 v[118:119], v[118:119], v[166:167]
    v_cvt_pk_bf16_f32 v216, v112, v113
    v_cvt_pk_bf16_f32 v217, v114, v115
    buffer_load_dwordx4 v41, s[4:7], s22 offen offset:1024 lds
    v_cvt_pk_bf16_f32 v218, v116, v117
    v_cvt_pk_bf16_f32 v219, v118, v119
    buffer_store_dwordx4 v[216:219], v24, s[48:51], s78 offen offset:0 sc1
    v_pk_mul_f32 v[160:161], v[120:121], v[120:121]
    v_pk_mul_f32 v[162:163], v[122:123], v[122:123]
    v_pk_mul_f32 v[164:165], v[124:125], v[124:125]
    v_pk_mul_f32 v[166:167], v[126:127], v[126:127]
    v_pk_fma_f32 v[160:161], v[160:161], s[62:63], v[38:39]
    v_pk_fma_f32 v[162:163], v[162:163], s[62:63], v[38:39]
    v_pk_fma_f32 v[164:165], v[164:165], s[62:63], v[38:39]
    v_pk_fma_f32 v[166:167], v[166:167], s[62:63], v[38:39]
    v_pk_mul_f32 v[160:161], v[160:161], v[120:121]
    buffer_load_dwordx4 v42, s[4:7], s22 offen offset:2048 lds
    v_pk_mul_f32 v[162:163], v[162:163], v[122:123]
    v_pk_mul_f32 v[164:165], v[164:165], v[124:125]
    v_pk_mul_f32 v[166:167], v[166:167], v[126:127]
    v_exp_f32 v160, v160
    v_exp_f32 v161, v161
    v_exp_f32 v162, v162
    v_exp_f32 v163, v163
    v_exp_f32 v164, v164
    v_exp_f32 v165, v165
    v_exp_f32 v166, v166
    v_exp_f32 v167, v167
    v_pk_add_f32 v[160:161], v[160:161], s[84:85]
    buffer_load_dwordx4 v43, s[4:7], s22 offen offset:3072 lds
    v_pk_add_f32 v[162:163], v[162:163], s[84:85]
    v_pk_add_f32 v[164:165], v[164:165], s[84:85]
    v_pk_add_f32 v[166:167], v[166:167], s[84:85]
    v_rcp_f32 v160, v160
    v_rcp_f32 v161, v161
    v_rcp_f32 v162, v162
    v_rcp_f32 v163, v163
    v_rcp_f32 v164, v164
    v_rcp_f32 v165, v165
    v_rcp_f32 v166, v166
    v_rcp_f32 v167, v167
    v_pk_mul_f32 v[120:121], v[120:121], v[160:161]
    s_add_u32 s12, s22, 131072
    s_add_u32 m0, s37, 12288
    s_nop 0
    buffer_load_dwordx4 v40, s[4:7], s12 offen offset:0 lds
    v_pk_mul_f32 v[122:123], v[122:123], v[162:163]
    v_pk_mul_f32 v[124:125], v[124:125], v[164:165]
    v_pk_mul_f32 v[126:127], v[126:127], v[166:167]
    v_cvt_pk_bf16_f32 v220, v120, v121
    v_cvt_pk_bf16_f32 v221, v122, v123
    v_cvt_pk_bf16_f32 v222, v124, v125
    v_cvt_pk_bf16_f32 v223, v126, v127
    buffer_store_dwordx4 v[220:223], v24, s[48:51], s78 offen offset:1024 sc1
    s_waitcnt vmcnt(17)
    v_lshrrev_b32 v5, 5, v0
    v_lshlrev_b32 v5, 4, v5
    s_lshl_b32 s64, s56, 10
    s_add_u32 s64, s64, 0
    v_add_u32 v5, s64, v5
    ds_read_b128 v[128:131], v5 offset:0
    ds_read_b128 v[132:135], v5 offset:32
    ds_read_b128 v[136:139], v5 offset:64
    ds_read_b128 v[140:143], v5 offset:96
    s_waitcnt lgkmcnt(3)
    v_mfma_f32_32x32x16_bf16 v[96:111], v[128:131], a[128:131], 0
    buffer_load_dwordx4 v41, s[4:7], s12 offen offset:1024 lds
    ds_read_b128 v[128:131], v5 offset:128
    s_waitcnt lgkmcnt(3)
    v_mfma_f32_32x32x16_bf16 v[96:111], v[132:135], a[132:135], v[96:111]
    buffer_load_dwordx4 v42, s[4:7], s12 offen offset:2048 lds
    ds_read_b128 v[132:135], v5 offset:160
    s_waitcnt lgkmcnt(3)
    v_mfma_f32_32x32x16_bf16 v[96:111], v[136:139], a[136:139], v[96:111]
    buffer_load_dwordx4 v43, s[4:7], s12 offen offset:3072 lds
    ds_read_b128 v[136:139], v5 offset:192
    s_waitcnt lgkmcnt(3)
    v_mfma_f32_32x32x16_bf16 v[96:111], v[140:143], a[140:143], v[96:111]
    ds_read_b128 v[140:143], v5 offset:224
    s_waitcnt lgkmcnt(3)
    v_mfma_f32_32x32x16_bf16 v[96:111], v[128:131], a[144:147], v[96:111]
    ds_read_b128 v[128:131], v5 offset:256
    s_waitcnt lgkmcnt(3)
    v_mfma_f32_32x32x16_bf16 v[96:111], v[132:135], a[148:151], v[96:111]
    ds_read_b128 v[132:135], v5 offset:288
    s_waitcnt lgkmcnt(3)
    v_mfma_f32_32x32x16_bf16 v[96:111], v[136:139], a[152:155], v[96:111]
    ds_read_b128 v[136:139], v5 offset:320
    s_waitcnt lgkmcnt(3)
    v_mfma_f32_32x32x16_bf16 v[96:111], v[140:143], a[156:159], v[96:111]
    ds_read_b128 v[140:143], v5 offset:352
    s_waitcnt lgkmcnt(3)
    v_mfma_f32_32x32x16_bf16 v[96:111], v[128:131], a[160:163], v[96:111]
    ds_read_b128 v[128:131], v5 offset:384
    s_waitcnt lgkmcnt(3)
    v_mfma_f32_32x32x16_bf16 v[96:111], v[132:135], a[164:167], v[96:111]
    ds_read_b128 v[132:135], v5 offset:416
    s_waitcnt lgkmcnt(3)
    v_mfma_f32_32x32x16_bf16 v[96:111], v[136:139], a[168:171], v[96:111]
    ds_read_b128 v[136:139], v5 offset:448
    s_waitcnt lgkmcnt(3)
    v_mfma_f32_32x32x16_bf16 v[96:111], v[140:143], a[172:175], v[96:111]
    ds_read_b128 v[140:143], v5 offset:480
    s_waitcnt lgkmcnt(3)
    v_mfma_f32_32x32x16_bf16 v[96:111], v[128:131], a[176:179], v[96:111]
    ds_read_b128 v[128:131], v5 offset:512
    s_waitcnt lgkmcnt(3)
    v_mfma_f32_32x32x16_bf16 v[96:111], v[132:135], a[180:183], v[96:111]
    ds_read_b128 v[132:135], v5 offset:544
    s_waitcnt lgkmcnt(3)
    v_mfma_f32_32x32x16_bf16 v[96:111], v[136:139], a[184:187], v[96:111]
    ds_read_b128 v[136:139], v5 offset:576
    s_waitcnt lgkmcnt(3)
    v_mfma_f32_32x32x16_bf16 v[96:111], v[140:143], a[188:191], v[96:111]
    ds_read_b128 v[140:143], v5 offset:608
    s_waitcnt lgkmcnt(3)
    v_mfma_f32_32x32x16_bf16 v[96:111], v[128:131], a[192:195], v[96:111]
    ds_read_b128 v[128:131], v5 offset:640
    s_waitcnt lgkmcnt(3)
    v_mfma_f32_32x32x16_bf16 v[96:111], v[132:135], a[196:199], v[96:111]
    ds_read_b128 v[132:135], v5 offset:672
    s_waitcnt lgkmcnt(3)
    v_mfma_f32_32x32x16_bf16 v[96:111], v[136:139], a[200:203], v[96:111]
    ds_read_b128 v[136:139], v5 offset:704
    s_waitcnt lgkmcnt(3)
    v_mfma_f32_32x32x16_bf16 v[96:111], v[140:143], a[204:207], v[96:111]
    ds_read_b128 v[140:143], v5 offset:736
    s_waitcnt lgkmcnt(3)
    v_mfma_f32_32x32x16_bf16 v[96:111], v[128:131], a[208:211], v[96:111]
    ds_read_b128 a[0:3], v48 offset:0
    ds_read_b128 a[4:7], v48 offset:4096
    ds_read_b128 a[8:11], v49 offset:0
    ds_read_b128 a[12:15], v49 offset:4096
    ds_read_b128 a[16:19], v50 offset:0
    ds_read_b128 a[20:23], v50 offset:4096
    ds_read_b128 a[24:27], v51 offset:0
    ds_read_b128 a[28:31], v51 offset:4096
    ds_read_b128 v[128:131], v5 offset:768
    s_waitcnt lgkmcnt(11)
    v_mfma_f32_32x32x16_bf16 v[96:111], v[132:135], a[212:215], v[96:111]
    s_waitcnt lgkmcnt(1)
    s_add_u32 m0, s36, 0
    s_nop 0
    buffer_load_dwordx4 v40, s[4:7], s23 offen offset:0 lds
    ds_read_b128 v[132:135], v5 offset:800
    v_mfma_f32_32x32x16_bf16 v[96:111], v[136:139], a[216:219], v[96:111]
    buffer_load_dwordx4 v41, s[4:7], s23 offen offset:1024 lds
    ds_read_b128 v[136:139], v5 offset:832
    v_mfma_f32_32x32x16_bf16 v[96:111], v[140:143], a[220:223], v[96:111]
    buffer_load_dwordx4 v42, s[4:7], s23 offen offset:2048 lds
    ds_read_b128 v[140:143], v5 offset:864
    s_waitcnt lgkmcnt(3)
    v_mfma_f32_32x32x16_bf16 v[96:111], v[128:131], a[224:227], v[96:111]
    s_waitcnt vmcnt(13)
    ds_read_b128 a[32:35], v52 offset:0
    ds_read_b128 a[36:39], v52 offset:4096
    ds_read_b128 a[40:43], v53 offset:0
    ds_read_b128 a[44:47], v53 offset:4096
    ds_read_b128 a[48:51], v54 offset:0
    ds_read_b128 a[52:55], v54 offset:4096
    ds_read_b128 a[56:59], v55 offset:0
    ds_read_b128 a[60:63], v55 offset:4096
    buffer_load_dwordx4 v43, s[4:7], s23 offen offset:3072 lds
    ds_read_b128 v[128:131], v5 offset:896
    s_waitcnt lgkmcnt(11)
    v_mfma_f32_32x32x16_bf16 v[96:111], v[132:135], a[228:231], v[96:111]
    s_waitcnt lgkmcnt(1)
    s_add_u32 s12, s23, 131072
    s_add_u32 m0, s36, 4096
    s_nop 0
    buffer_load_dwordx4 v40, s[4:7], s12 offen offset:0 lds
    ds_read_b128 v[132:135], v5 offset:928
    v_mfma_f32_32x32x16_bf16 v[96:111], v[136:139], a[232:235], v[96:111]
    buffer_load_dwordx4 v41, s[4:7], s12 offen offset:1024 lds
    ds_read_b128 v[136:139], v5 offset:960
    v_mfma_f32_32x32x16_bf16 v[96:111], v[140:143], a[236:239], v[96:111]
    buffer_load_dwordx4 v42, s[4:7], s12 offen offset:2048 lds
    ds_read_b128 v[140:143], v5 offset:992
    s_waitcnt lgkmcnt(3)
    v_mfma_f32_32x32x16_bf16 v[96:111], v[128:131], a[240:243], v[96:111]
    s_waitcnt vmcnt(7)
    ds_read_b128 a[64:67], v56 offset:0
    ds_read_b128 a[68:71], v56 offset:4096
    ds_read_b128 a[72:75], v57 offset:0
    ds_read_b128 a[76:79], v57 offset:4096
    ds_read_b128 a[80:83], v58 offset:0
    ds_read_b128 a[84:87], v58 offset:4096
    ds_read_b128 a[88:91], v59 offset:0
    ds_read_b128 a[92:95], v59 offset:4096
    buffer_load_dwordx4 v43, s[4:7], s12 offen offset:3072 lds
    s_waitcnt lgkmcnt(10)
    v_mfma_f32_32x32x16_bf16 v[96:111], v[132:135], a[244:247], v[96:111]
    s_waitcnt lgkmcnt(0)
    s_add_u32 m0, s37, 0
    s_nop 0
    buffer_load_dwordx4 v40, s[4:7], s26 offen offset:0 lds
    v_mfma_f32_32x32x16_bf16 v[96:111], v[136:139], a[248:251], v[96:111]
    buffer_load_dwordx4 v41, s[4:7], s26 offen offset:1024 lds
    v_mfma_f32_32x32x16_bf16 v[96:111], v[140:143], a[252:255], v[96:111]
    buffer_load_dwordx4 v42, s[4:7], s26 offen offset:2048 lds
    s_nop 10
    v_mul_f32 v160, 0xbfb8aa3b, v96
    v_exp_f32 v160, v160
    s_nop 0
    v_add_f32 v160, 1.0, v160
    v_rcp_f32 v160, v160
    v_and_b32 v161, 31, v0
    v_lshlrev_b32 v161, 2, v161
    s_lshl_b32 s64, s79, 7
    s_add_u32 s64, s64, 327680
    s_cmp_eq_u32 s58, 14
    s_cselect_b32 s64, s64, 0x40000000
    buffer_store_dword v160, v161, s[48:51], s64 offen sc1
    s_mul_i32 s70, s60, 3
    s_min_u32 s70, s70, 20
    s_cmp_lt_u32 s60, 6
    s_cselect_b32 s71, 3, 2
    s_add_u32 s66, s70, s71
    s_sub_u32 s67, s66, 1
    s_mov_b32 s64, 0
    s_add_u32 s88, s70, s64
    s_cmp_ge_u32 s88, s66
    s_cselect_b32 s65, s71, 0
    s_sub_u32 s88, s88, s65
    s_add_u32 s89, s70, s64
    s_add_u32 s89, s89, 1
    s_cmp_ge_u32 s89, s66
    s_cselect_b32 s65, s71, 0
    s_sub_u32 s89, s89, s65
    s_add_u32 s90, s70, s64
    s_add_u32 s90, s90, 2
    s_cmp_ge_u32 s90, s66
    s_cselect_b32 s65, s71, 0
    s_sub_u32 s90, s90, s65
    s_lshr_b32 s64, s70, 1
    s_lshr_b32 s65, s67, 1
    s_sub_u32 s65, s65, s64
    v_bfe_u32 v1, v0, 3, 2
    v_bfe_u32 v2, v0, 2, 1
    v_mul_u32_u24 v2, s65, v2
    v_lshl_add_u32 v1, v1, 4, v2
    s_lshl_b32 s66, s56, 6
    s_add_u32 s66, s66, s64
    v_add_u32 v1, s66, v1
    v_and_b32 v2, 3, v0
    v_lshl_add_u32 v1, v1, 2, v2
    v_and_b32 v2, 3, v1
    v_lshrrev_b32 v1, 2, v1
    v_lshlrev_b32 v1, 4, v1
    v_add_lshl_u32 v8, v1, v2, 2
    s_mov_b32 s97, 65536
    buffer_load_dword v14, v8, s[48:51], s97 offen sc1
    buffer_load_dwordx4 v43, s[4:7], s26 offen offset:3072 lds
    s_add_u32 s12, s26, 131072
    s_add_u32 m0, s37, 4096
    s_nop 0
    buffer_load_dwordx4 v40, s[4:7], s12 offen offset:0 lds
    buffer_load_dwordx4 v41, s[4:7], s12 offen offset:1024 lds
    buffer_load_dwordx4 v42, s[4:7], s12 offen offset:2048 lds
    buffer_load_dwordx4 v43, s[4:7], s12 offen offset:3072 lds
    s_add_u32 m0, s37, 8192
    s_nop 0
    buffer_load_dwordx4 v40, s[4:7], s27 offen offset:0 lds
    buffer_load_dwordx4 v41, s[4:7], s27 offen offset:1024 lds
    buffer_load_dwordx4 v42, s[4:7], s27 offen offset:2048 lds
    buffer_load_dwordx4 v43, s[4:7], s27 offen offset:3072 lds
    s_add_u32 s12, s27, 131072
    s_add_u32 m0, s37, 12288
    s_nop 0
    buffer_load_dwordx4 v40, s[4:7], s12 offen offset:0 lds
    buffer_load_dwordx4 v41, s[4:7], s12 offen offset:1024 lds
    buffer_load_dwordx4 v42, s[4:7], s12 offen offset:2048 lds
    buffer_load_dwordx4 v43, s[4:7], s12 offen offset:3072 lds
    s_waitcnt vmcnt(14)
    s_lshl4_add_u32 s64, s57, s58
    s_lshl4_add_u32 s64, s64, s56
    s_lshl_b32 s64, s64, 2
    s_add_u32 s64, s64, 131072
    v_mov_b32 v30, s61
    buffer_store_dword v30, off, s[48:51], s64 sc1
    s_branch L_p1_done
L_p1_done:
L_pad_p1_done_0:
    s_cbranch_execz L_pad_p1_done_1
    s_mov_b32 s97, 65536
    s_waitcnt vmcnt(14)
    v_cmp_ne_u32 vcc, s61, v14
    s_nop 0
    s_cbranch_vccnz PS_6
PC_5:
    s_lshl_b32 s64, s56, 15
    s_add_u32 s80, s64, 2097152
    s_add_u32 s72, s3, 0
    s_and_b32 s72, s72, 7
    s_lshl_b32 s72, s72, 12
    s_add_u32 s72, s72, s80
    s_lshl_b32 s13, s88, 17
    s_add_u32 s72, s72, s13
    buffer_load_dwordx4 v[128:131], v24, s[48:51], s72 offen offset:0 sc1
    buffer_load_dwordx4 v[132:135], v24, s[48:51], s72 offen offset:1024 sc1
    buffer_load_dwordx4 v[136:139], v24, s[48:51], s72 offen offset:2048 sc1
    buffer_load_dwordx4 v[140:143], v24, s[48:51], s72 offen offset:3072 sc1
    s_add_u32 s72, s3, 1
    s_and_b32 s72, s72, 7
    s_lshl_b32 s72, s72, 12
    s_add_u32 s72, s72, s80
    s_lshl_b32 s13, s88, 17
    s_add_u32 s72, s72, s13
    buffer_load_dwordx4 v[144:147], v24, s[48:51], s72 offen offset:0 sc1
    buffer_load_dwordx4 v[148:151], v24, s[48:51], s72 offen offset:1024 sc1
    buffer_load_dwordx4 v[152:155], v24, s[48:51], s72 offen offset:2048 sc1
    buffer_load_dwordx4 v[156:159], v24, s[48:51], s72 offen offset:3072 sc1
    s_add_u32 s72, s3, 2
    s_and_b32 s72, s72, 7
    s_lshl_b32 s72, s72, 12
    s_add_u32 s72, s72, s80
    s_lshl_b32 s13, s88, 17
    s_add_u32 s72, s72, s13
    buffer_load_dwordx4 v[160:163], v24, s[48:51], s72 offen offset:0 sc1
    buffer_load_dwordx4 v[164:167], v24, s[48:51], s72 offen offset:1024 sc1
    buffer_load_dwordx4 v[168:171], v24, s[48:51], s72 offen offset:2048 sc1
    buffer_load_dwordx4 v[172:175], v24, s[48:51], s72 offen offset:3072 sc1
    v_lshlrev_b32 v21, 16, v45
    s_lshr_b32 s64, s59, 1
    s_lshl_b32 s64, s64, 6
    v_add_u32 v1, s64, v0
    v_and_b32 v2, 3, v1
    v_lshrrev_b32 v1, 2, v1
    v_lshlrev_b32 v1, 4, v1
    v_add_lshl_u32 v9, v1, v2, 2
    s_lshl_b32 s64, s56, 11
    v_add_u32 v1, s64, v24
    v_add_u32 v16, 22528, v1
    v_add_u32 v17, 63488, v1
    v_add_u32 v18, 104448, v1
    v_add_u32 v19, 145408, v1
    s_mul_i32 s64, s56, 40960
    s_add_u32 s64, s64, 22528
    v_add_u32 v20, s64, v24
    v_and_b32 v1, 31, v0
    v_lshlrev_b32 v13, 2, v1
    s_and_b32 s64, s56, 1
    s_lshl1_add_u32 s64, s59, s64
    s_mul_i32 s64, s64, 45056
    s_lshr_b32 s65, s56, 1
    s_lshl_b32 s65, s65, 10
    s_add_u32 s64, s64, s65
    s_add_u32 s76, s64, 5242880
    s_add_u32 s75, s64, 11534336
    s_cmp_ge_u32 s60, 6
    s_cbranch_scc1 L_P2L
    s_add_u32 s72, s3, 3
    s_and_b32 s72, s72, 7
    s_lshl_b32 s72, s72, 12
    s_add_u32 s72, s72, s80
    s_lshl_b32 s13, s88, 17
    s_waitcnt vmcnt(11)
    v_mfma_f32_32x32x16_bf16 v[64:79], v[128:131], a[0:3], 0
    s_add_u32 s72, s72, s13
    v_mfma_f32_32x32x16_bf16 v[80:95], v[128:131], a[4:7], 0
    buffer_load_dwordx4 v[128:131], v24, s[48:51], s72 offen offset:0 sc1
    s_waitcnt vmcnt(11)
    v_mfma_f32_32x32x16_bf16 v[64:79], v[132:135], a[8:11], v[64:79]
    v_mfma_f32_32x32x16_bf16 v[80:95], v[132:135], a[12:15], v[80:95]
    buffer_load_dwordx4 v[132:135], v24, s[48:51], s72 offen offset:1024 sc1
    s_waitcnt vmcnt(11)
    v_mfma_f32_32x32x16_bf16 v[64:79], v[136:139], a[16:19], v[64:79]
    v_mfma_f32_32x32x16_bf16 v[80:95], v[136:139], a[20:23], v[80:95]
    buffer_load_dwordx4 v[136:139], v24, s[48:51], s72 offen offset:2048 sc1
    s_waitcnt vmcnt(11)
    v_mfma_f32_32x32x16_bf16 v[64:79], v[140:143], a[24:27], v[64:79]
    v_mfma_f32_32x32x16_bf16 v[80:95], v[140:143], a[28:31], v[80:95]
    buffer_load_dwordx4 v[140:143], v24, s[48:51], s72 offen offset:3072 sc1
    s_add_u32 s72, s3, 4
    s_and_b32 s72, s72, 7
    s_lshl_b32 s72, s72, 12
    s_add_u32 s72, s72, s80
    s_waitcnt vmcnt(11)
    v_mfma_f32_32x32x16_bf16 v[64:79], v[144:147], a[32:35], v[64:79]
    s_lshl_b32 s13, s88, 17
    s_add_u32 s72, s72, s13
    v_mfma_f32_32x32x16_bf16 v[80:95], v[144:147], a[36:39], v[80:95]
    buffer_load_dwordx4 v[144:147], v24, s[48:51], s72 offen offset:0 sc1
    ds_read_b128 a[96:99], v48 offset:0
    ds_read_b128 a[100:103], v48 offset:4096
    ds_read_b128 a[104:107], v49 offset:0
    ds_read_b128 a[108:111], v49 offset:4096
    s_waitcnt vmcnt(11)
    v_mfma_f32_32x32x16_bf16 v[64:79], v[148:151], a[40:43], v[64:79]
    ds_read_b128 a[112:115], v50 offset:0
    ds_read_b128 a[116:119], v50 offset:4096
    ds_read_b128 a[120:123], v51 offset:0
    ds_read_b128 a[124:127], v51 offset:4096
    v_mfma_f32_32x32x16_bf16 v[80:95], v[148:151], a[44:47], v[80:95]
    buffer_load_dwordx4 v[148:151], v24, s[48:51], s72 offen offset:1024 sc1
    s_waitcnt lgkmcnt(0)
    s_add_u32 m0, s36, 0
    s_nop 0
    buffer_load_dwordx4 v40, s[4:7], s28 offen offset:0 lds
    buffer_load_dwordx4 v41, s[4:7], s28 offen offset:1024 lds
    s_waitcnt vmcnt(13)
    v_mfma_f32_32x32x16_bf16 v[64:79], v[152:155], a[48:51], v[64:79]
    v_mfma_f32_32x32x16_bf16 v[80:95], v[152:155], a[52:55], v[80:95]
    buffer_load_dwordx4 v[152:155], v24, s[48:51], s72 offen offset:2048 sc1
    buffer_load_dwordx4 v42, s[4:7], s28 offen offset:2048 lds
    buffer_load_dwordx4 v43, s[4:7], s28 offen offset:3072 lds
    s_waitcnt vmcnt(15)
    v_mfma_f32_32x32x16_bf16 v[64:79], v[156:159], a[56:59], v[64:79]
    v_mfma_f32_32x32x16_bf16 v[80:95], v[156:159], a[60:63], v[80:95]
    buffer_load_dwordx4 v[156:159], v24, s[48:51], s72 offen offset:3072 sc1
    s_add_u32 s12, s28, 131072
    s_add_u32 m0, s36, 4096
    s_nop 0
    buffer_load_dwordx4 v40, s[4:7], s12 offen offset:0 lds
    buffer_load_dwordx4 v41, s[4:7], s12 offen offset:1024 lds
    s_waitcnt vmcnt(17)
    v_mfma_f32_32x32x16_bf16 v[64:79], v[160:163], a[64:67], v[64:79]
    s_add_u32 s72, s3, 5
    s_and_b32 s72, s72, 7
    s_lshl_b32 s72, s72, 12
    s_add_u32 s72, s72, s80
    s_lshl_b32 s13, s88, 17
    v_mfma_f32_32x32x16_bf16 v[80:95], v[160:163], a[68:71], v[80:95]
    s_add_u32 s72, s72, s13
    buffer_load_dwordx4 v[160:163], v24, s[48:51], s72 offen offset:0 sc1
    buffer_load_dwordx4 v42, s[4:7], s12 offen offset:2048 lds
    buffer_load_dwordx4 v43, s[4:7], s12 offen offset:3072 lds
    s_waitcnt vmcnt(19)
    v_mfma_f32_32x32x16_bf16 v[64:79], v[164:167], a[72:75], v[64:79]
    v_mfma_f32_32x32x16_bf16 v[80:95], v[164:167], a[76:79], v[80:95]
    buffer_load_dwordx4 v[164:167], v24, s[48:51], s72 offen offset:1024 sc1
    s_waitcnt vmcnt(19)
L_pad_p1_done_1:
    s_cbranch_execz L_pad_p1_done_2
    v_mfma_f32_32x32x16_bf16 v[64:79], v[168:171], a[80:83], v[64:79]
    v_mfma_f32_32x32x16_bf16 v[80:95], v[168:171], a[84:87], v[80:95]
    buffer_load_dwordx4 v[168:171], v24, s[48:51], s72 offen offset:2048 sc1
    ds_read_b128 a[128:131], v52 offset:0
    ds_read_b128 a[132:135], v52 offset:4096
    ds_read_b128 a[136:139], v53 offset:0
    ds_read_b128 a[140:143], v53 offset:4096
    s_waitcnt vmcnt(19)
    v_mfma_f32_32x32x16_bf16 v[64:79], v[172:175], a[88:91], v[64:79]
    ds_read_b128 a[144:147], v54 offset:0
    ds_read_b128 a[148:151], v54 offset:4096
    ds_read_b128 a[152:155], v55 offset:0
    ds_read_b128 a[156:159], v55 offset:4096
    v_mfma_f32_32x32x16_bf16 v[80:95], v[172:175], a[92:95], v[80:95]
    buffer_load_dwordx4 v[172:175], v24, s[48:51], s72 offen offset:3072 sc1
    s_waitcnt lgkmcnt(0)
    s_add_u32 m0, s37, 0
    s_nop 0
    buffer_load_dwordx4 v40, s[4:7], s29 offen offset:0 lds
    buffer_load_dwordx4 v41, s[4:7], s29 offen offset:1024 lds
    s_waitcnt vmcnt(21)
    v_mfma_f32_32x32x16_bf16 v[64:79], v[128:131], a[96:99], v[64:79]
    s_add_u32 s72, s3, 6
    s_and_b32 s72, s72, 7
    s_lshl_b32 s72, s72, 12
    s_add_u32 s72, s72, s80
    s_lshl_b32 s13, s88, 17
    v_mfma_f32_32x32x16_bf16 v[80:95], v[128:131], a[100:103], v[80:95]
    s_add_u32 s72, s72, s13
    buffer_load_dwordx4 v[128:131], v24, s[48:51], s72 offen offset:0 sc1
    buffer_load_dwordx4 v42, s[4:7], s29 offen offset:2048 lds
    buffer_load_dwordx4 v43, s[4:7], s29 offen offset:3072 lds
    s_waitcnt vmcnt(23)
    v_mfma_f32_32x32x16_bf16 v[64:79], v[132:135], a[104:107], v[64:79]
    v_mfma_f32_32x32x16_bf16 v[80:95], v[132:135], a[108:111], v[80:95]
    buffer_load_dwordx4 v[132:135], v24, s[48:51], s72 offen offset:1024 sc1
    s_add_u32 s12, s29, 131072
    s_add_u32 m0, s37, 4096
    s_nop 0
    buffer_load_dwordx4 v40, s[4:7], s12 offen offset:0 lds
    buffer_load_dwordx4 v41, s[4:7], s12 offen offset:1024 lds
    s_waitcnt vmcnt(25)
    v_mfma_f32_32x32x16_bf16 v[64:79], v[136:139], a[112:115], v[64:79]
    v_mfma_f32_32x32x16_bf16 v[80:95], v[136:139], a[116:119], v[80:95]
    buffer_load_dwordx4 v[136:139], v24, s[48:51], s72 offen offset:2048 sc1
    buffer_load_dwordx4 v42, s[4:7], s12 offen offset:2048 lds
    buffer_load_dwordx4 v43, s[4:7], s12 offen offset:3072 lds
    s_waitcnt vmcnt(27)
    v_mfma_f32_32x32x16_bf16 v[64:79], v[140:143], a[120:123], v[64:79]
    v_mfma_f32_32x32x16_bf16 v[80:95], v[140:143], a[124:127], v[80:95]
    buffer_load_dwordx4 v[140:143], v24, s[48:51], s72 offen offset:3072 sc1
    s_add_u32 s72, s3, 7
    s_and_b32 s72, s72, 7
    s_lshl_b32 s72, s72, 12
    s_add_u32 s72, s72, s80
    s_waitcnt vmcnt(27)
    v_mfma_f32_32x32x16_bf16 v[64:79], v[144:147], a[128:131], v[64:79]
    s_lshl_b32 s13, s88, 17
    s_add_u32 s72, s72, s13
    v_mfma_f32_32x32x16_bf16 v[80:95], v[144:147], a[132:135], v[80:95]
    buffer_load_dwordx4 v[144:147], v24, s[48:51], s72 offen offset:0 sc1
    ds_read_b128 a[160:163], v56 offset:0
    ds_read_b128 a[164:167], v56 offset:4096
    ds_read_b128 a[168:171], v57 offset:0
    ds_read_b128 a[172:175], v57 offset:4096
    s_waitcnt vmcnt(27)
    v_mfma_f32_32x32x16_bf16 v[64:79], v[148:151], a[136:139], v[64:79]
    ds_read_b128 a[176:179], v58 offset:0
    ds_read_b128 a[180:183], v58 offset:4096
    ds_read_b128 a[184:187], v59 offset:0
    ds_read_b128 a[188:191], v59 offset:4096
    v_mfma_f32_32x32x16_bf16 v[80:95], v[148:151], a[140:143], v[80:95]
    buffer_load_dwordx4 v[148:151], v24, s[48:51], s72 offen offset:1024 sc1
    s_waitcnt vmcnt(25)
    v_mfma_f32_32x32x16_bf16 v[64:79], v[152:155], a[144:147], v[64:79]
    v_mfma_f32_32x32x16_bf16 v[80:95], v[152:155], a[148:151], v[80:95]
    buffer_load_dwordx4 v[152:155], v24, s[48:51], s72 offen offset:2048 sc1
    s_waitcnt vmcnt(23)
    v_mfma_f32_32x32x16_bf16 v[64:79], v[156:159], a[152:155], v[64:79]
    v_mfma_f32_32x32x16_bf16 v[80:95], v[156:159], a[156:159], v[80:95]
    buffer_load_dwordx4 v[156:159], v24, s[48:51], s72 offen offset:3072 sc1
    s_add_u32 s72, s3, 0
    s_and_b32 s72, s72, 7
    s_lshl_b32 s72, s72, 12
    s_add_u32 s72, s72, s80
    s_waitcnt vmcnt(21) lgkmcnt(7)
    v_mfma_f32_32x32x16_bf16 v[64:79], v[160:163], a[160:163], v[64:79]
    s_lshl_b32 s13, s89, 17
    s_add_u32 s72, s72, s13
    s_waitcnt lgkmcnt(6)
    v_mfma_f32_32x32x16_bf16 v[80:95], v[160:163], a[164:167], v[80:95]
    buffer_load_dwordx4 v[160:163], v24, s[48:51], s72 offen offset:0 sc1
    s_waitcnt vmcnt(19) lgkmcnt(5)
    v_mfma_f32_32x32x16_bf16 v[64:79], v[164:167], a[168:171], v[64:79]
    s_waitcnt lgkmcnt(4)
    v_mfma_f32_32x32x16_bf16 v[80:95], v[164:167], a[172:175], v[80:95]
    buffer_load_dwordx4 v[164:167], v24, s[48:51], s72 offen offset:1024 sc1
    s_waitcnt vmcnt(19) lgkmcnt(3)
    v_mfma_f32_32x32x16_bf16 v[64:79], v[168:171], a[176:179], v[64:79]
    s_waitcnt lgkmcnt(2)
    v_mfma_f32_32x32x16_bf16 v[80:95], v[168:171], a[180:183], v[80:95]
    buffer_load_dwordx4 v[168:171], v24, s[48:51], s72 offen offset:2048 sc1
    ds_read_b128 a[192:195], v48 offset:0
    ds_read_b128 a[196:199], v48 offset:4096
    ds_read_b128 a[200:203], v49 offset:0
    ds_read_b128 a[204:207], v49 offset:4096
    s_waitcnt vmcnt(19) lgkmcnt(5)
    v_mfma_f32_32x32x16_bf16 v[64:79], v[172:175], a[184:187], v[64:79]
    ds_read_b128 a[208:211], v50 offset:0
    ds_read_b128 a[212:215], v50 offset:4096
    ds_read_b128 a[216:219], v51 offset:0
    ds_read_b128 a[220:223], v51 offset:4096
    s_waitcnt lgkmcnt(8)
    v_mfma_f32_32x32x16_bf16 v[80:95], v[172:175], a[188:191], v[80:95]
    buffer_load_dwordx4 v[172:175], v24, s[48:51], s72 offen offset:3072 sc1
    s_add_u32 s72, s3, 1
    s_and_b32 s72, s72, 7
    s_lshl_b32 s72, s72, 12
    s_add_u32 s72, s72, s80
    s_waitcnt vmcnt(17) lgkmcnt(7)
    v_mfma_f32_32x32x16_bf16 v[64:79], v[128:131], a[192:195], v[64:79]
    s_lshl_b32 s13, s89, 17
    s_add_u32 s72, s72, s13
    s_waitcnt lgkmcnt(6)
    v_mfma_f32_32x32x16_bf16 v[80:95], v[128:131], a[196:199], v[80:95]
    buffer_load_dwordx4 v[128:131], v24, s[48:51], s72 offen offset:0 sc1
    s_waitcnt vmcnt(15) lgkmcnt(5)
    v_mfma_f32_32x32x16_bf16 v[64:79], v[132:135], a[200:203], v[64:79]
    s_waitcnt lgkmcnt(4)
    v_mfma_f32_32x32x16_bf16 v[80:95], v[132:135], a[204:207], v[80:95]
    buffer_load_dwordx4 v[132:135], v24, s[48:51], s72 offen offset:1024 sc1
    s_waitcnt vmcnt(13) lgkmcnt(3)
    v_mfma_f32_32x32x16_bf16 v[64:79], v[136:139], a[208:211], v[64:79]
    s_waitcnt lgkmcnt(2)
    v_mfma_f32_32x32x16_bf16 v[80:95], v[136:139], a[212:215], v[80:95]
    buffer_load_dwordx4 v[136:139], v24, s[48:51], s72 offen offset:2048 sc1
    s_waitcnt vmcnt(12)
    ds_read_b128 a[224:227], v52 offset:0
    ds_read_b128 a[228:231], v52 offset:4096
    ds_read_b128 a[232:235], v53 offset:0
    ds_read_b128 a[236:239], v53 offset:4096
    s_waitcnt vmcnt(11) lgkmcnt(5)
    v_mfma_f32_32x32x16_bf16 v[64:79], v[140:143], a[216:219], v[64:79]
    ds_read_b128 a[240:243], v54 offset:0
    ds_read_b128 a[244:247], v54 offset:4096
    ds_read_b128 a[248:251], v55 offset:0
    ds_read_b128 a[252:255], v55 offset:4096
    s_waitcnt lgkmcnt(8)
    v_mfma_f32_32x32x16_bf16 v[80:95], v[140:143], a[220:223], v[80:95]
    buffer_load_dwordx4 v[140:143], v24, s[48:51], s72 offen offset:3072 sc1
    s_add_u32 s72, s3, 2
    s_and_b32 s72, s72, 7
    s_lshl_b32 s72, s72, 12
    s_add_u32 s72, s72, s80
    s_waitcnt vmcnt(11) lgkmcnt(7)
    v_mfma_f32_32x32x16_bf16 v[64:79], v[144:147], a[224:227], v[64:79]
    s_lshl_b32 s13, s89, 17
    s_add_u32 s72, s72, s13
    s_waitcnt lgkmcnt(6)
    v_mfma_f32_32x32x16_bf16 v[80:95], v[144:147], a[228:231], v[80:95]
    buffer_load_dwordx4 v[144:147], v24, s[48:51], s72 offen offset:0 sc1
    s_waitcnt vmcnt(11) lgkmcnt(5)
    v_mfma_f32_32x32x16_bf16 v[64:79], v[148:151], a[232:235], v[64:79]
    s_waitcnt lgkmcnt(4)
    v_mfma_f32_32x32x16_bf16 v[80:95], v[148:151], a[236:239], v[80:95]
    buffer_load_dwordx4 v[148:151], v24, s[48:51], s72 offen offset:1024 sc1
    s_waitcnt vmcnt(11) lgkmcnt(3)
    v_mfma_f32_32x32x16_bf16 v[64:79], v[152:155], a[240:243], v[64:79]
    s_waitcnt lgkmcnt(2)
    v_mfma_f32_32x32x16_bf16 v[80:95], v[152:155], a[244:247], v[80:95]
    buffer_load_dwordx4 v[152:155], v24, s[48:51], s72 offen offset:2048 sc1
    s_waitcnt vmcnt(11) lgkmcnt(1)
    v_mfma_f32_32x32x16_bf16 v[64:79], v[156:159], a[248:251], v[64:79]
    s_waitcnt lgkmcnt(0)
    v_mfma_f32_32x32x16_bf16 v[80:95], v[156:159], a[252:255], v[80:95]
    buffer_load_dwordx4 v[156:159], v24, s[48:51], s72 offen offset:3072 sc1
    s_waitcnt lgkmcnt(0)
    s_barrier
    s_add_u32 s72, s3, 3
    s_and_b32 s72, s72, 7
    s_waitcnt vmcnt(11)
    v_mfma_f32_32x32x16_bf16 v[96:111], v[160:163], a[0:3], 0
    s_lshl_b32 s72, s72, 12
    s_add_u32 s72, s72, s80
    s_lshl_b32 s13, s89, 17
    s_add_u32 s72, s72, s13
    v_mfma_f32_32x32x16_bf16 v[112:127], v[160:163], a[4:7], 0
    buffer_load_dwordx4 v[160:163], v24, s[48:51], s72 offen offset:0 sc1
    s_waitcnt vmcnt(11)
    v_mfma_f32_32x32x16_bf16 v[96:111], v[164:167], a[8:11], v[96:111]
    v_mfma_f32_32x32x16_bf16 v[112:127], v[164:167], a[12:15], v[112:127]
    buffer_load_dwordx4 v[164:167], v24, s[48:51], s72 offen offset:1024 sc1
    s_waitcnt vmcnt(11)
    v_mfma_f32_32x32x16_bf16 v[96:111], v[168:171], a[16:19], v[96:111]
    v_mfma_f32_32x32x16_bf16 v[112:127], v[168:171], a[20:23], v[112:127]
    buffer_load_dwordx4 v[168:171], v24, s[48:51], s72 offen offset:2048 sc1
    ds_write_b128 v16, v[64:67] offset:0
    s_waitcnt vmcnt(11)
    v_mfma_f32_32x32x16_bf16 v[96:111], v[172:175], a[24:27], v[96:111]
    v_mfma_f32_32x32x16_bf16 v[112:127], v[172:175], a[28:31], v[112:127]
    buffer_load_dwordx4 v[172:175], v24, s[48:51], s72 offen offset:3072 sc1
    ds_write_b128 v16, v[68:71] offset:1024
    s_add_u32 s72, s3, 4
    s_and_b32 s72, s72, 7
    s_lshl_b32 s72, s72, 12
    s_waitcnt vmcnt(11)
    v_mfma_f32_32x32x16_bf16 v[96:111], v[128:131], a[32:35], v[96:111]
    s_add_u32 s72, s72, s80
    s_lshl_b32 s13, s89, 17
    s_add_u32 s72, s72, s13
    v_mfma_f32_32x32x16_bf16 v[112:127], v[128:131], a[36:39], v[112:127]
    buffer_load_dwordx4 v[128:131], v24, s[48:51], s72 offen offset:0 sc1
    ds_write_b128 v17, v[80:83] offset:0
    s_waitcnt vmcnt(11)
    v_mfma_f32_32x32x16_bf16 v[96:111], v[132:135], a[40:43], v[96:111]
    v_mfma_f32_32x32x16_bf16 v[112:127], v[132:135], a[44:47], v[112:127]
    buffer_load_dwordx4 v[132:135], v24, s[48:51], s72 offen offset:1024 sc1
    ds_write_b128 v17, v[84:87] offset:1024
    s_waitcnt vmcnt(11)
    v_mfma_f32_32x32x16_bf16 v[96:111], v[136:139], a[48:51], v[96:111]
    v_mfma_f32_32x32x16_bf16 v[112:127], v[136:139], a[52:55], v[112:127]
    buffer_load_dwordx4 v[136:139], v24, s[48:51], s72 offen offset:2048 sc1
    ds_write_b128 v18, v[72:75] offset:0
    s_waitcnt vmcnt(11)
    v_mfma_f32_32x32x16_bf16 v[96:111], v[140:143], a[56:59], v[96:111]
    v_mfma_f32_32x32x16_bf16 v[112:127], v[140:143], a[60:63], v[112:127]
    buffer_load_dwordx4 v[140:143], v24, s[48:51], s72 offen offset:3072 sc1
    ds_write_b128 v18, v[76:79] offset:1024
    s_add_u32 s72, s3, 5
    s_and_b32 s72, s72, 7
    s_lshl_b32 s72, s72, 12
    s_waitcnt vmcnt(11)
    v_mfma_f32_32x32x16_bf16 v[96:111], v[144:147], a[64:67], v[96:111]
    s_add_u32 s72, s72, s80
    s_lshl_b32 s13, s89, 17
    s_add_u32 s72, s72, s13
    v_mfma_f32_32x32x16_bf16 v[112:127], v[144:147], a[68:71], v[112:127]
    buffer_load_dwordx4 v[144:147], v24, s[48:51], s72 offen offset:0 sc1
    ds_write_b128 v19, v[88:91] offset:0
    s_waitcnt vmcnt(11)
    v_mfma_f32_32x32x16_bf16 v[96:111], v[148:151], a[72:75], v[96:111]
    v_mfma_f32_32x32x16_bf16 v[112:127], v[148:151], a[76:79], v[112:127]
    buffer_load_dwordx4 v[148:151], v24, s[48:51], s72 offen offset:1024 sc1
    ds_write_b128 v19, v[92:95] offset:1024
    s_waitcnt vmcnt(11)
    v_mfma_f32_32x32x16_bf16 v[96:111], v[152:155], a[80:83], v[96:111]
    v_mfma_f32_32x32x16_bf16 v[112:127], v[152:155], a[84:87], v[112:127]
    buffer_load_dwordx4 v[152:155], v24, s[48:51], s72 offen offset:2048 sc1
    s_waitcnt vmcnt(11)
    v_mfma_f32_32x32x16_bf16 v[96:111], v[156:159], a[88:91], v[96:111]
    v_mfma_f32_32x32x16_bf16 v[112:127], v[156:159], a[92:95], v[112:127]
    buffer_load_dwordx4 v[156:159], v24, s[48:51], s72 offen offset:3072 sc1
    s_add_u32 s72, s3, 6
    s_and_b32 s72, s72, 7
    s_lshl_b32 s72, s72, 12
    s_add_u32 s72, s72, s80
    s_waitcnt vmcnt(11)
    v_mfma_f32_32x32x16_bf16 v[96:111], v[160:163], a[96:99], v[96:111]
    s_lshl_b32 s13, s89, 17
    s_add_u32 s72, s72, s13
    v_mfma_f32_32x32x16_bf16 v[112:127], v[160:163], a[100:103], v[112:127]
    buffer_load_dwordx4 v[160:163], v24, s[48:51], s72 offen offset:0 sc1
    s_waitcnt lgkmcnt(0)
    s_barrier
    ds_read_b128 v[192:195], v20 offset:0
    s_waitcnt vmcnt(11)
    v_mfma_f32_32x32x16_bf16 v[96:111], v[164:167], a[104:107], v[96:111]
    v_mfma_f32_32x32x16_bf16 v[112:127], v[164:167], a[108:111], v[112:127]
    buffer_load_dwordx4 v[164:167], v24, s[48:51], s72 offen offset:1024 sc1
    ds_read_b128 v[196:199], v20 offset:1024
    s_waitcnt vmcnt(11)
    v_mfma_f32_32x32x16_bf16 v[96:111], v[168:171], a[112:115], v[96:111]
    v_mfma_f32_32x32x16_bf16 v[112:127], v[168:171], a[116:119], v[112:127]
    buffer_load_dwordx4 v[168:171], v24, s[48:51], s72 offen offset:2048 sc1
    ds_read_b128 v[200:203], v20 offset:2048
    s_waitcnt vmcnt(11)
    v_mfma_f32_32x32x16_bf16 v[96:111], v[172:175], a[120:123], v[96:111]
    v_mfma_f32_32x32x16_bf16 v[112:127], v[172:175], a[124:127], v[112:127]
    buffer_load_dwordx4 v[172:175], v24, s[48:51], s72 offen offset:3072 sc1
    ds_read_b128 v[204:207], v20 offset:3072
    s_add_u32 s72, s3, 7
    s_and_b32 s72, s72, 7
    s_lshl_b32 s72, s72, 12
    s_waitcnt vmcnt(11)
    v_mfma_f32_32x32x16_bf16 v[96:111], v[128:131], a[128:131], v[96:111]
    s_add_u32 s72, s72, s80
    s_lshl_b32 s13, s89, 17
    s_add_u32 s72, s72, s13
    v_mfma_f32_32x32x16_bf16 v[112:127], v[128:131], a[132:135], v[112:127]
    buffer_load_dwordx4 v[128:131], v24, s[48:51], s72 offen offset:0 sc1
    ds_read_b128 v[208:211], v20 offset:4096
    s_waitcnt vmcnt(11)
    v_mfma_f32_32x32x16_bf16 v[96:111], v[132:135], a[136:139], v[96:111]
    v_mfma_f32_32x32x16_bf16 v[112:127], v[132:135], a[140:143], v[112:127]
    buffer_load_dwordx4 v[132:135], v24, s[48:51], s72 offen offset:1024 sc1
    ds_read_b128 v[212:215], v20 offset:5120
    s_waitcnt vmcnt(11)
    v_mfma_f32_32x32x16_bf16 v[96:111], v[136:139], a[144:147], v[96:111]
    v_mfma_f32_32x32x16_bf16 v[112:127], v[136:139], a[148:151], v[112:127]
    buffer_load_dwordx4 v[136:139], v24, s[48:51], s72 offen offset:2048 sc1
    ds_read_b128 v[216:219], v20 offset:6144
    s_waitcnt vmcnt(11)
    v_mfma_f32_32x32x16_bf16 v[96:111], v[140:143], a[152:155], v[96:111]
    v_mfma_f32_32x32x16_bf16 v[112:127], v[140:143], a[156:159], v[112:127]
    buffer_load_dwordx4 v[140:143], v24, s[48:51], s72 offen offset:3072 sc1
    ds_read_b128 v[220:223], v20 offset:7168
    s_add_u32 s72, s3, 0
    s_and_b32 s72, s72, 7
    s_lshl_b32 s72, s72, 12
    s_waitcnt vmcnt(11)
    v_mfma_f32_32x32x16_bf16 v[96:111], v[144:147], a[160:163], v[96:111]
    s_add_u32 s72, s72, s80
    s_lshl_b32 s13, s90, 17
    s_add_u32 s72, s72, s13
    v_mfma_f32_32x32x16_bf16 v[112:127], v[144:147], a[164:167], v[112:127]
    buffer_load_dwordx4 v[144:147], v24, s[48:51], s72 offen offset:0 sc1
    s_waitcnt vmcnt(11)
    v_mfma_f32_32x32x16_bf16 v[96:111], v[148:151], a[168:171], v[96:111]
    v_mfma_f32_32x32x16_bf16 v[112:127], v[148:151], a[172:175], v[112:127]
    buffer_load_dwordx4 v[148:151], v24, s[48:51], s72 offen offset:1024 sc1
    s_waitcnt lgkmcnt(5)
    v_add_f32 v192, v192, v200
    v_add_f32 v193, v193, v201
    v_add_f32 v194, v194, v202
    v_add_f32 v195, v195, v203
    s_waitcnt vmcnt(11)
    v_mfma_f32_32x32x16_bf16 v[96:111], v[152:155], a[176:179], v[96:111]
    s_waitcnt lgkmcnt(4)
    v_add_f32 v196, v196, v204
    v_add_f32 v197, v197, v205
    v_mfma_f32_32x32x16_bf16 v[112:127], v[152:155], a[180:183], v[112:127]
    buffer_load_dwordx4 v[152:155], v24, s[48:51], s72 offen offset:2048 sc1
    v_add_f32 v198, v198, v206
    v_add_f32 v199, v199, v207
    s_waitcnt lgkmcnt(1)
    v_add_f32 v208, v208, v216
    v_add_f32 v209, v209, v217
    s_waitcnt vmcnt(11)
    v_mfma_f32_32x32x16_bf16 v[96:111], v[156:159], a[184:187], v[96:111]
    v_add_f32 v210, v210, v218
    v_add_f32 v211, v211, v219
    v_mfma_f32_32x32x16_bf16 v[112:127], v[156:159], a[188:191], v[112:127]
    buffer_load_dwordx4 v[156:159], v24, s[48:51], s72 offen offset:3072 sc1
    s_waitcnt lgkmcnt(0)
    v_add_f32 v212, v212, v220
    v_add_f32 v213, v213, v221
    v_add_f32 v214, v214, v222
    v_add_f32 v215, v215, v223
    s_waitcnt vmcnt(11)
    v_mfma_f32_32x32x16_bf16 v[96:111], v[160:163], a[192:195], v[96:111]
    v_add_f32 v176, v192, v208
    v_add_f32 v177, v193, v209
    s_add_u32 s72, s3, 1
    s_and_b32 s72, s72, 7
    s_lshl_b32 s72, s72, 12
    v_mfma_f32_32x32x16_bf16 v[112:127], v[160:163], a[196:199], v[112:127]
    s_add_u32 s72, s72, s80
    s_lshl_b32 s13, s90, 17
    s_add_u32 s72, s72, s13
    buffer_load_dwordx4 v[160:163], v24, s[48:51], s72 offen offset:0 sc1
    v_add_f32 v178, v194, v210
    s_waitcnt vmcnt(11)
    v_mfma_f32_32x32x16_bf16 v[96:111], v[164:167], a[200:203], v[96:111]
    v_add_f32 v179, v195, v211
    v_add_f32 v180, v196, v212
    v_add_f32 v181, v197, v213
    v_add_f32 v182, v198, v214
    v_add_f32 v183, v199, v215
    v_mfma_f32_32x32x16_bf16 v[112:127], v[164:167], a[204:207], v[112:127]
    buffer_load_dwordx4 v[164:167], v24, s[48:51], s72 offen offset:1024 sc1
    s_waitcnt vmcnt(11)
    v_mfma_f32_32x32x16_bf16 v[96:111], v[168:171], a[208:211], v[96:111]
    v_mfma_f32_32x32x16_bf16 v[112:127], v[168:171], a[212:215], v[112:127]
    buffer_load_dwordx4 v[168:171], v24, s[48:51], s72 offen offset:2048 sc1
    s_waitcnt vmcnt(11)
    v_mfma_f32_32x32x16_bf16 v[96:111], v[172:175], a[216:219], v[96:111]
    v_mfma_f32_32x32x16_bf16 v[112:127], v[172:175], a[220:223], v[112:127]
    buffer_load_dwordx4 v[172:175], v24, s[48:51], s72 offen offset:3072 sc1
    s_add_u32 s72, s3, 2
    s_and_b32 s72, s72, 7
    s_lshl_b32 s72, s72, 12
    s_add_u32 s72, s72, s80
    s_waitcnt vmcnt(11)
    v_mfma_f32_32x32x16_bf16 v[96:111], v[128:131], a[224:227], v[96:111]
    s_lshl_b32 s13, s90, 17
    s_add_u32 s72, s72, s13
    v_mfma_f32_32x32x16_bf16 v[112:127], v[128:131], a[228:231], v[112:127]
    buffer_load_dwordx4 v[128:131], v24, s[48:51], s72 offen offset:0 sc1
    s_mov_b32 s97, 131072
    buffer_load_dword v14, v9, s[48:51], s97 offen sc1
    s_waitcnt vmcnt(12)
    v_mfma_f32_32x32x16_bf16 v[96:111], v[132:135], a[232:235], v[96:111]
    v_mfma_f32_32x32x16_bf16 v[112:127], v[132:135], a[236:239], v[112:127]
    buffer_load_dwordx4 v[132:135], v24, s[48:51], s72 offen offset:1024 sc1
    s_waitcnt vmcnt(12)
    v_mfma_f32_32x32x16_bf16 v[96:111], v[136:139], a[240:243], v[96:111]
    v_mfma_f32_32x32x16_bf16 v[112:127], v[136:139], a[244:247], v[112:127]
    buffer_load_dwordx4 v[136:139], v24, s[48:51], s72 offen offset:2048 sc1
    s_waitcnt vmcnt(12)
    v_mfma_f32_32x32x16_bf16 v[96:111], v[140:143], a[248:251], v[96:111]
    v_mfma_f32_32x32x16_bf16 v[112:127], v[140:143], a[252:255], v[112:127]
    buffer_load_dwordx4 v[140:143], v24, s[48:51], s72 offen offset:3072 sc1
    s_add_u32 s72, s3, 3
    s_and_b32 s72, s72, 7
    s_lshl_b32 s72, s72, 12
    s_add_u32 s72, s72, s80
    s_waitcnt vmcnt(12)
    v_mfma_f32_32x32x16_bf16 v[64:79], v[144:147], a[0:3], 0
    s_lshl_b32 s13, s90, 17
    s_add_u32 s72, s72, s13
    v_mfma_f32_32x32x16_bf16 v[80:95], v[144:147], a[4:7], 0
    buffer_load_dwordx4 v[144:147], v24, s[48:51], s72 offen offset:0 sc1
    s_waitcnt vmcnt(12)
    v_mfma_f32_32x32x16_bf16 v[64:79], v[148:151], a[8:11], v[64:79]
    v_mfma_f32_32x32x16_bf16 v[80:95], v[148:151], a[12:15], v[80:95]
    buffer_load_dwordx4 v[148:151], v24, s[48:51], s72 offen offset:1024 sc1
    s_waitcnt vmcnt(12)
    v_mfma_f32_32x32x16_bf16 v[64:79], v[152:155], a[16:19], v[64:79]
    v_mfma_f32_32x32x16_bf16 v[80:95], v[152:155], a[20:23], v[80:95]
    buffer_load_dwordx4 v[152:155], v24, s[48:51], s72 offen offset:2048 sc1
    ds_write_b128 v16, v[96:99] offset:8192
    s_waitcnt vmcnt(12)
    v_mfma_f32_32x32x16_bf16 v[64:79], v[156:159], a[24:27], v[64:79]
    v_mfma_f32_32x32x16_bf16 v[80:95], v[156:159], a[28:31], v[80:95]
    buffer_load_dwordx4 v[156:159], v24, s[48:51], s72 offen offset:3072 sc1
    ds_write_b128 v16, v[100:103] offset:9216
    s_add_u32 s72, s3, 4
    s_and_b32 s72, s72, 7
    s_lshl_b32 s72, s72, 12
    s_waitcnt vmcnt(12)
    v_mfma_f32_32x32x16_bf16 v[64:79], v[160:163], a[32:35], v[64:79]
    s_add_u32 s72, s72, s80
    s_lshl_b32 s13, s90, 17
    s_add_u32 s72, s72, s13
    v_mfma_f32_32x32x16_bf16 v[80:95], v[160:163], a[36:39], v[80:95]
    buffer_load_dwordx4 v[160:163], v24, s[48:51], s72 offen offset:0 sc1
    ds_write_b128 v17, v[112:115] offset:8192
    s_waitcnt vmcnt(12)
    v_mfma_f32_32x32x16_bf16 v[64:79], v[164:167], a[40:43], v[64:79]
    v_mfma_f32_32x32x16_bf16 v[80:95], v[164:167], a[44:47], v[80:95]
    buffer_load_dwordx4 v[164:167], v24, s[48:51], s72 offen offset:1024 sc1
    ds_write_b128 v17, v[116:119] offset:9216
    s_waitcnt vmcnt(12)
    v_mfma_f32_32x32x16_bf16 v[64:79], v[168:171], a[48:51], v[64:79]
    v_mfma_f32_32x32x16_bf16 v[80:95], v[168:171], a[52:55], v[80:95]
    buffer_load_dwordx4 v[168:171], v24, s[48:51], s72 offen offset:2048 sc1
    ds_write_b128 v18, v[104:107] offset:8192
    s_waitcnt vmcnt(12)
    v_mfma_f32_32x32x16_bf16 v[64:79], v[172:175], a[56:59], v[64:79]
    v_mfma_f32_32x32x16_bf16 v[80:95], v[172:175], a[60:63], v[80:95]
    buffer_load_dwordx4 v[172:175], v24, s[48:51], s72 offen offset:3072 sc1
    ds_write_b128 v18, v[108:111] offset:9216
    s_add_u32 s72, s3, 5
    s_and_b32 s72, s72, 7
    s_lshl_b32 s72, s72, 12
    s_waitcnt vmcnt(12)
    v_mfma_f32_32x32x16_bf16 v[64:79], v[128:131], a[64:67], v[64:79]
    s_add_u32 s72, s72, s80
    s_lshl_b32 s13, s90, 17
    s_add_u32 s72, s72, s13
    v_mfma_f32_32x32x16_bf16 v[80:95], v[128:131], a[68:71], v[80:95]
    buffer_load_dwordx4 v[128:131], v24, s[48:51], s72 offen offset:0 sc1
    ds_write_b128 v19, v[120:123] offset:8192
    s_waitcnt vmcnt(11)
    v_mfma_f32_32x32x16_bf16 v[64:79], v[132:135], a[72:75], v[64:79]
    v_mfma_f32_32x32x16_bf16 v[80:95], v[132:135], a[76:79], v[80:95]
    buffer_load_dwordx4 v[132:135], v24, s[48:51], s72 offen offset:1024 sc1
    ds_write_b128 v19, v[124:127] offset:9216
    s_waitcnt vmcnt(11)
    v_mfma_f32_32x32x16_bf16 v[64:79], v[136:139], a[80:83], v[64:79]
    v_mfma_f32_32x32x16_bf16 v[80:95], v[136:139], a[84:87], v[80:95]
    buffer_load_dwordx4 v[136:139], v24, s[48:51], s72 offen offset:2048 sc1
    s_waitcnt vmcnt(11)
    v_mfma_f32_32x32x16_bf16 v[64:79], v[140:143], a[88:91], v[64:79]
    v_mfma_f32_32x32x16_bf16 v[80:95], v[140:143], a[92:95], v[80:95]
    buffer_load_dwordx4 v[140:143], v24, s[48:51], s72 offen offset:3072 sc1
    s_add_u32 s72, s3, 6
    s_and_b32 s72, s72, 7
    s_lshl_b32 s72, s72, 12
    s_add_u32 s72, s72, s80
    s_waitcnt vmcnt(11)
    v_mfma_f32_32x32x16_bf16 v[64:79], v[144:147], a[96:99], v[64:79]
    s_lshl_b32 s13, s90, 17
    s_add_u32 s72, s72, s13
    v_mfma_f32_32x32x16_bf16 v[80:95], v[144:147], a[100:103], v[80:95]
    buffer_load_dwordx4 v[144:147], v24, s[48:51], s72 offen offset:0 sc1
    s_waitcnt lgkmcnt(0)
    s_barrier
    ds_read_b128 v[192:195], v20 offset:8192
    s_waitcnt vmcnt(11)
    v_mfma_f32_32x32x16_bf16 v[64:79], v[148:151], a[104:107], v[64:79]
    v_mfma_f32_32x32x16_bf16 v[80:95], v[148:151], a[108:111], v[80:95]
    buffer_load_dwordx4 v[148:151], v24, s[48:51], s72 offen offset:1024 sc1
    ds_read_b128 v[196:199], v20 offset:9216
    s_waitcnt vmcnt(11)
    v_mfma_f32_32x32x16_bf16 v[64:79], v[152:155], a[112:115], v[64:79]
    v_mfma_f32_32x32x16_bf16 v[80:95], v[152:155], a[116:119], v[80:95]
    buffer_load_dwordx4 v[152:155], v24, s[48:51], s72 offen offset:2048 sc1
    ds_read_b128 v[200:203], v20 offset:10240
    s_waitcnt vmcnt(11)
    v_mfma_f32_32x32x16_bf16 v[64:79], v[156:159], a[120:123], v[64:79]
    v_mfma_f32_32x32x16_bf16 v[80:95], v[156:159], a[124:127], v[80:95]
    buffer_load_dwordx4 v[156:159], v24, s[48:51], s72 offen offset:3072 sc1
    ds_read_b128 v[204:207], v20 offset:11264
    s_add_u32 s72, s3, 7
    s_and_b32 s72, s72, 7
    s_lshl_b32 s72, s72, 12
    s_waitcnt vmcnt(11)
    v_mfma_f32_32x32x16_bf16 v[64:79], v[160:163], a[128:131], v[64:79]
    s_add_u32 s72, s72, s80
    s_lshl_b32 s13, s90, 17
    s_add_u32 s72, s72, s13
    v_mfma_f32_32x32x16_bf16 v[80:95], v[160:163], a[132:135], v[80:95]
    buffer_load_dwordx4 v[160:163], v24, s[48:51], s72 offen offset:0 sc1
    ds_read_b128 v[208:211], v20 offset:12288
    s_waitcnt vmcnt(11)
    v_mfma_f32_32x32x16_bf16 v[64:79], v[164:167], a[136:139], v[64:79]
    v_mfma_f32_32x32x16_bf16 v[80:95], v[164:167], a[140:143], v[80:95]
    buffer_load_dwordx4 v[164:167], v24, s[48:51], s72 offen offset:1024 sc1
    ds_read_b128 v[212:215], v20 offset:13312
    s_waitcnt vmcnt(11)
    v_mfma_f32_32x32x16_bf16 v[64:79], v[168:171], a[144:147], v[64:79]
    v_mfma_f32_32x32x16_bf16 v[80:95], v[168:171], a[148:151], v[80:95]
    buffer_load_dwordx4 v[168:171], v24, s[48:51], s72 offen offset:2048 sc1
    ds_read_b128 v[216:219], v20 offset:14336
    s_waitcnt vmcnt(11)
    v_mfma_f32_32x32x16_bf16 v[64:79], v[172:175], a[152:155], v[64:79]
    v_mfma_f32_32x32x16_bf16 v[80:95], v[172:175], a[156:159], v[80:95]
    buffer_load_dwordx4 v[172:175], v24, s[48:51], s72 offen offset:3072 sc1
    ds_read_b128 v[220:223], v20 offset:15360
    s_mov_b32 s97, 131072
    v_cmp_ne_u32 vcc, s61, v14
    s_nop 0
    s_cbranch_vccnz PS_8
PC_7:
    s_waitcnt vmcnt(11)
    v_mfma_f32_32x32x16_bf16 v[64:79], v[128:131], a[160:163], v[64:79]
    s_lshl_b32 s64, s88, 11
    s_add_u32 s64, s64, s76
    buffer_load_dwordx4 v[224:227], v24, s[48:51], s64 offen sc1
    s_lshl_b32 s64, s89, 11
    s_add_u32 s64, s64, s76
    v_mfma_f32_32x32x16_bf16 v[80:95], v[128:131], a[164:167], v[80:95]
    buffer_load_dwordx4 v[228:231], v24, s[48:51], s64 offen sc1
    s_lshl_b32 s64, s90, 11
    s_add_u32 s64, s64, s76
    buffer_load_dwordx4 v[232:235], v24, s[48:51], s64 offen sc1
    s_lshl_b32 s64, s59, 8
    s_waitcnt vmcnt(13)
    v_mfma_f32_32x32x16_bf16 v[64:79], v[132:135], a[168:171], v[64:79]
    s_add_u32 s64, s64, 327680
    buffer_load_dword v22, v13, s[48:51], s64 offen sc1
    buffer_load_dword v23, v13, s[48:51], s64 offen offset:128 sc1
    s_waitcnt lgkmcnt(5)
    v_add_f32 v192, v192, v200
    v_add_f32 v193, v193, v201
    v_mfma_f32_32x32x16_bf16 v[80:95], v[132:135], a[172:175], v[80:95]
    v_add_f32 v194, v194, v202
    v_add_f32 v195, v195, v203
    s_waitcnt lgkmcnt(4)
    v_add_f32 v196, v196, v204
    v_add_f32 v197, v197, v205
    s_lshl1_add_u32 s12, s59, 0
    s_waitcnt vmcnt(14)
    v_mfma_f32_32x32x16_bf16 v[64:79], v[136:139], a[176:179], v[64:79]
    s_lshl_b32 s12, s12, 15
    s_lshl_b32 s65, s56, 13
    s_add_u32 s12, s12, s65
    s_add_u32 s12, s12, 8388608
    buffer_load_dwordx4 a[0:3], v24, s[48:51], s12 offen offset:0 sc1
    v_mfma_f32_32x32x16_bf16 v[80:95], v[136:139], a[180:183], v[80:95]
    s_lshl1_add_u32 s13, s59, 1
    s_lshl_b32 s13, s13, 15
    s_lshl_b32 s65, s56, 13
    s_add_u32 s13, s13, s65
    s_add_u32 s13, s13, 8388608
    s_waitcnt vmcnt(14)
    v_mfma_f32_32x32x16_bf16 v[64:79], v[140:143], a[184:187], v[64:79]
    buffer_load_dwordx4 a[4:7], v24, s[48:51], s13 offen offset:0 sc1
    v_add_f32 v198, v198, v206
    v_add_f32 v199, v199, v207
    s_waitcnt lgkmcnt(1)
    v_add_f32 v208, v208, v216
    v_add_f32 v209, v209, v217
    v_mfma_f32_32x32x16_bf16 v[80:95], v[140:143], a[188:191], v[80:95]
    v_add_f32 v210, v210, v218
    v_add_f32 v211, v211, v219
    buffer_load_dwordx4 a[8:11], v24, s[48:51], s12 offen offset:1024 sc1
    buffer_load_dwordx4 a[12:15], v24, s[48:51], s13 offen offset:1024 sc1
    s_waitcnt lgkmcnt(0)
    v_add_f32 v212, v212, v220
    s_waitcnt vmcnt(16)
    v_mfma_f32_32x32x16_bf16 v[64:79], v[144:147], a[192:195], v[64:79]
    v_add_f32 v213, v213, v221
    v_add_f32 v214, v214, v222
    v_add_f32 v215, v215, v223
    v_add_f32 v184, v192, v208
    v_add_f32 v185, v193, v209
    v_mfma_f32_32x32x16_bf16 v[80:95], v[144:147], a[196:199], v[80:95]
    buffer_load_dwordx4 a[16:19], v24, s[48:51], s12 offen offset:2048 sc1
    buffer_load_dwordx4 a[20:23], v24, s[48:51], s13 offen offset:2048 sc1
    v_add_f32 v186, v194, v210
    v_add_f32 v187, v195, v211
    v_add_f32 v188, v196, v212
    s_waitcnt vmcnt(17)
    v_mfma_f32_32x32x16_bf16 v[64:79], v[148:151], a[200:203], v[64:79]
    v_add_f32 v189, v197, v213
    v_add_f32 v190, v198, v214
    v_add_f32 v191, v199, v215
    buffer_load_dwordx4 a[24:27], v24, s[48:51], s12 offen offset:3072 sc1
    buffer_load_dwordx4 a[28:31], v24, s[48:51], s13 offen offset:3072 sc1
    v_mfma_f32_32x32x16_bf16 v[80:95], v[148:151], a[204:207], v[80:95]
    s_lshl1_add_u32 s12, s59, 0
    s_lshl_b32 s12, s12, 15
    s_lshl_b32 s65, s56, 13
    s_add_u32 s12, s12, s65
    s_add_u32 s12, s12, 8392704
    s_waitcnt vmcnt(18)
    v_mfma_f32_32x32x16_bf16 v[64:79], v[152:155], a[208:211], v[64:79]
    buffer_load_dwordx4 a[32:35], v24, s[48:51], s12 offen offset:0 sc1
    s_lshl1_add_u32 s13, s59, 1
    s_lshl_b32 s13, s13, 15
    s_lshl_b32 s65, s56, 13
    s_add_u32 s13, s13, s65
    v_mfma_f32_32x32x16_bf16 v[80:95], v[152:155], a[212:215], v[80:95]
    s_add_u32 s13, s13, 8392704
    buffer_load_dwordx4 a[36:39], v24, s[48:51], s13 offen offset:0 sc1
    buffer_load_dwordx4 a[40:43], v24, s[48:51], s12 offen offset:1024 sc1
    buffer_load_dwordx4 a[44:47], v24, s[48:51], s13 offen offset:1024 sc1
    s_waitcnt vmcnt(21)
    v_mfma_f32_32x32x16_bf16 v[64:79], v[156:159], a[216:219], v[64:79]
    v_mfma_f32_32x32x16_bf16 v[80:95], v[156:159], a[220:223], v[80:95]
    buffer_load_dwordx4 a[48:51], v24, s[48:51], s12 offen offset:2048 sc1
    buffer_load_dwordx4 a[52:55], v24, s[48:51], s13 offen offset:2048 sc1
    s_waitcnt vmcnt(22)
    v_mfma_f32_32x32x16_bf16 v[64:79], v[160:163], a[224:227], v[64:79]
    v_mfma_f32_32x32x16_bf16 v[80:95], v[160:163], a[228:231], v[80:95]
    buffer_load_dwordx4 a[56:59], v24, s[48:51], s12 offen offset:3072 sc1
    buffer_load_dwordx4 a[60:63], v24, s[48:51], s13 offen offset:3072 sc1
    s_waitcnt vmcnt(23)
    v_mfma_f32_32x32x16_bf16 v[64:79], v[164:167], a[232:235], v[64:79]
    v_mfma_f32_32x32x16_bf16 v[80:95], v[164:167], a[236:239], v[80:95]
    s_waitcnt vmcnt(22)
    v_mfma_f32_32x32x16_bf16 v[64:79], v[168:171], a[240:243], v[64:79]
    v_mfma_f32_32x32x16_bf16 v[80:95], v[168:171], a[244:247], v[80:95]
    s_waitcnt vmcnt(21)
    v_mfma_f32_32x32x16_bf16 v[64:79], v[172:175], a[248:251], v[64:79]
    v_mfma_f32_32x32x16_bf16 v[80:95], v[172:175], a[252:255], v[80:95]
    s_nop 10
    ds_write_b128 v16, v[64:67] offset:0
    ds_write_b128 v16, v[68:71] offset:1024
    ds_write_b128 v17, v[80:83] offset:0
    ds_write_b128 v17, v[84:87] offset:1024
    ds_write_b128 v18, v[72:75] offset:0
    ds_write_b128 v18, v[76:79] offset:1024
    ds_write_b128 v19, v[88:91] offset:0
    ds_write_b128 v19, v[92:95] offset:1024
    s_and_b32 s64, s56, 1
    s_cmp_eq_u32 s64, 0
    s_cselect_b64 vcc, -1, 0
    s_waitcnt vmcnt(16)
    v_cndmask_b32 v26, v23, v22, vcc
    v_sub_f32 v26, 1.0, v26
    v_mul_f32 v27, v21, v26
    v_mov_b32 v136, v26
    v_mov_b32 v137, v26
    v_mov_b32 v138, v27
L_pad_p1_done_2:
    s_cbranch_execz L_hopret
    v_mov_b32 v139, v27
    s_waitcnt lgkmcnt(0)
    s_barrier
    ds_read_b128 v[192:195], v20 offset:0
    ds_read_b128 v[196:199], v20 offset:1024
    ds_read_b128 v[200:203], v20 offset:2048
    ds_read_b128 v[204:207], v20 offset:3072
    ds_read_b128 v[208:211], v20 offset:4096
    ds_read_b128 v[212:215], v20 offset:5120
    ds_read_b128 v[216:219], v20 offset:6144
    ds_read_b128 v[220:223], v20 offset:7168
    v_pk_fma_f32 v[176:177], v[176:177], v[136:137], v[138:139]
    v_pk_fma_f32 v[178:179], v[178:179], v[136:137], v[138:139]
    v_pk_fma_f32 v[180:181], v[180:181], v[136:137], v[138:139]
    v_pk_fma_f32 v[182:183], v[182:183], v[136:137], v[138:139]
    v_lshlrev_b32 v128, 16, v224
    v_and_b32 v129, 0xffff0000, v224
    v_lshlrev_b32 v130, 16, v225
    v_and_b32 v131, 0xffff0000, v225
    v_lshlrev_b32 v132, 16, v226
    v_and_b32 v133, 0xffff0000, v226
    v_lshlrev_b32 v134, 16, v227
    v_and_b32 v135, 0xffff0000, v227
    v_pk_mul_f32 v[176:177], v[176:177], v[128:129]
    v_pk_mul_f32 v[178:179], v[178:179], v[130:131]
    v_pk_mul_f32 v[180:181], v[180:181], v[132:133]
    v_pk_mul_f32 v[182:183], v[182:183], v[134:135]
    v_cvt_pk_bf16_f32 v224, v176, v177
    v_cvt_pk_bf16_f32 v225, v178, v179
    v_cvt_pk_bf16_f32 v226, v180, v181
    v_cvt_pk_bf16_f32 v227, v182, v183
    s_lshl_b32 s64, s88, 11
    s_add_u32 s64, s64, s75
    buffer_store_dwordx4 v[224:227], v24, s[48:51], s64 offen sc1
    v_pk_fma_f32 v[184:185], v[184:185], v[136:137], v[138:139]
    v_pk_fma_f32 v[186:187], v[186:187], v[136:137], v[138:139]
    v_pk_fma_f32 v[188:189], v[188:189], v[136:137], v[138:139]
    v_pk_fma_f32 v[190:191], v[190:191], v[136:137], v[138:139]
    v_lshlrev_b32 v128, 16, v228
    v_and_b32 v129, 0xffff0000, v228
    v_lshlrev_b32 v130, 16, v229
    v_and_b32 v131, 0xffff0000, v229
    v_lshlrev_b32 v132, 16, v230
    v_and_b32 v133, 0xffff0000, v230
    v_lshlrev_b32 v134, 16, v231
    v_and_b32 v135, 0xffff0000, v231
    v_pk_mul_f32 v[184:185], v[184:185], v[128:129]
    v_pk_mul_f32 v[186:187], v[186:187], v[130:131]
    v_pk_mul_f32 v[188:189], v[188:189], v[132:133]
    v_pk_mul_f32 v[190:191], v[190:191], v[134:135]
    v_cvt_pk_bf16_f32 v228, v184, v185
    v_cvt_pk_bf16_f32 v229, v186, v187
    v_cvt_pk_bf16_f32 v230, v188, v189
    v_cvt_pk_bf16_f32 v231, v190, v191
    s_lshl_b32 s64, s89, 11
    s_add_u32 s64, s64, s75
    buffer_store_dwordx4 v[228:231], v24, s[48:51], s64 offen sc1
    s_waitcnt lgkmcnt(5)
    v_pk_add_f32 v[192:193], v[192:193], v[200:201]
    v_pk_add_f32 v[194:195], v[194:195], v[202:203]
    s_waitcnt lgkmcnt(4)
    v_pk_add_f32 v[196:197], v[196:197], v[204:205]
    v_pk_add_f32 v[198:199], v[198:199], v[206:207]
    s_waitcnt lgkmcnt(1)
    v_pk_add_f32 v[208:209], v[208:209], v[216:217]
    v_pk_add_f32 v[210:211], v[210:211], v[218:219]
    s_waitcnt lgkmcnt(0)
    v_pk_add_f32 v[212:213], v[212:213], v[220:221]
    v_pk_add_f32 v[214:215], v[214:215], v[222:223]
    v_pk_add_f32 v[176:177], v[192:193], v[208:209]
    v_pk_add_f32 v[178:179], v[194:195], v[210:211]
    v_pk_add_f32 v[180:181], v[196:197], v[212:213]
    v_pk_add_f32 v[182:183], v[198:199], v[214:215]
    v_pk_fma_f32 v[176:177], v[176:177], v[136:137], v[138:139]
    v_pk_fma_f32 v[178:179], v[178:179], v[136:137], v[138:139]
    v_pk_fma_f32 v[180:181], v[180:181], v[136:137], v[138:139]
    v_pk_fma_f32 v[182:183], v[182:183], v[136:137], v[138:139]
    v_lshlrev_b32 v128, 16, v232
    v_and_b32 v129, 0xffff0000, v232
    v_lshlrev_b32 v130, 16, v233
    v_and_b32 v131, 0xffff0000, v233
    v_lshlrev_b32 v132, 16, v234
    v_and_b32 v133, 0xffff0000, v234
    v_lshlrev_b32 v134, 16, v235
    v_and_b32 v135, 0xffff0000, v235
    v_pk_mul_f32 v[176:177], v[176:177], v[128:129]
    v_pk_mul_f32 v[178:179], v[178:179], v[130:131]
    v_pk_mul_f32 v[180:181], v[180:181], v[132:133]
    v_pk_mul_f32 v[182:183], v[182:183], v[134:135]
    v_cvt_pk_bf16_f32 v232, v176, v177
    v_cvt_pk_bf16_f32 v233, v178, v179
    v_cvt_pk_bf16_f32 v234, v180, v181
    v_cvt_pk_bf16_f32 v235, v182, v183
    s_lshl_b32 s64, s90, 11
    s_add_u32 s64, s64, s75
    buffer_store_dwordx4 v[232:235], v24, s[48:51], s64 offen sc1
    s_branch L_P3
L_P2L:
L_pad_P2L_0:
    s_cbranch_execz L_pad_P2L_1
    s_lshl_b32 s74, s59, 1
    s_and_b32 s64, s60, 1
    s_add_u32 s74, s74, s64
    s_lshr_b32 s64, s74, 3
    v_lshrrev_b32 v1, 2, v0
    v_lshlrev_b32 v1, 4, v1
    v_add_u32 v1, s64, v1
    v_and_b32 v2, 3, v0
    v_lshl_add_u32 v1, v1, 2, v2
    v_and_b32 v2, 3, v1
    v_lshrrev_b32 v1, 2, v1
    v_lshlrev_b32 v1, 4, v1
    v_add_lshl_u32 v10, v1, v2, 2
    s_mov_b32 s44, s48
    s_mov_b32 s45, s49
    s_cmp_lt_u32 s56, 2
    s_cselect_b32 s46, 0x10000000, 0
    s_mov_b32 s47, 0x20000
    s_lshl_b32 s78, s74, 14
    s_and_b32 s64, s56, 1
    s_lshl_b32 s64, s64, 13
    s_add_u32 s78, s78, s64
    s_add_u32 s78, s78, 1048576
    s_add_u32 s72, s3, 3
    s_and_b32 s72, s72, 7
    s_lshl_b32 s72, s72, 12
    s_add_u32 s72, s72, s80
    s_lshl_b32 s13, s88, 17
    s_waitcnt vmcnt(11)
    v_mfma_f32_32x32x16_bf16 v[64:79], v[128:131], a[0:3], 0
    s_add_u32 s72, s72, s13
    v_mfma_f32_32x32x16_bf16 v[80:95], v[128:131], a[4:7], 0
    buffer_load_dwordx4 v[128:131], v24, s[48:51], s72 offen offset:0 sc1
    s_waitcnt vmcnt(11)
    v_mfma_f32_32x32x16_bf16 v[64:79], v[132:135], a[8:11], v[64:79]
    v_mfma_f32_32x32x16_bf16 v[80:95], v[132:135], a[12:15], v[80:95]
    buffer_load_dwordx4 v[132:135], v24, s[48:51], s72 offen offset:1024 sc1
    s_waitcnt vmcnt(11)
    v_mfma_f32_32x32x16_bf16 v[64:79], v[136:139], a[16:19], v[64:79]
    v_mfma_f32_32x32x16_bf16 v[80:95], v[136:139], a[20:23], v[80:95]
    buffer_load_dwordx4 v[136:139], v24, s[48:51], s72 offen offset:2048 sc1
    s_waitcnt vmcnt(11)
    v_mfma_f32_32x32x16_bf16 v[64:79], v[140:143], a[24:27], v[64:79]
    v_mfma_f32_32x32x16_bf16 v[80:95], v[140:143], a[28:31], v[80:95]
    buffer_load_dwordx4 v[140:143], v24, s[48:51], s72 offen offset:3072 sc1
    s_add_u32 s72, s3, 4
    s_and_b32 s72, s72, 7
    s_lshl_b32 s72, s72, 12
    s_add_u32 s72, s72, s80
    s_waitcnt vmcnt(11)
    v_mfma_f32_32x32x16_bf16 v[64:79], v[144:147], a[32:35], v[64:79]
    s_lshl_b32 s13, s88, 17
    s_add_u32 s72, s72, s13
    v_mfma_f32_32x32x16_bf16 v[80:95], v[144:147], a[36:39], v[80:95]
    buffer_load_dwordx4 v[144:147], v24, s[48:51], s72 offen offset:0 sc1
    ds_read_b128 a[96:99], v48 offset:0
    ds_read_b128 a[100:103], v48 offset:4096
    ds_read_b128 a[104:107], v49 offset:0
    ds_read_b128 a[108:111], v49 offset:4096
    s_waitcnt vmcnt(11)
    v_mfma_f32_32x32x16_bf16 v[64:79], v[148:151], a[40:43], v[64:79]
    ds_read_b128 a[112:115], v50 offset:0
    ds_read_b128 a[116:119], v50 offset:4096
    ds_read_b128 a[120:123], v51 offset:0
    ds_read_b128 a[124:127], v51 offset:4096
    s_mov_b32 s97, 131072
    v_mfma_f32_32x32x16_bf16 v[80:95], v[148:151], a[44:47], v[80:95]
    buffer_load_dword v15, v10, s[48:51], s97 offen sc1
    buffer_load_dwordx4 v[148:151], v24, s[48:51], s72 offen offset:1024 sc1
    s_waitcnt lgkmcnt(0)
    s_add_u32 m0, s36, 0
    s_nop 0
    buffer_load_dwordx4 v40, s[4:7], s28 offen offset:0 lds
    s_waitcnt vmcnt(13)
    v_mfma_f32_32x32x16_bf16 v[64:79], v[152:155], a[48:51], v[64:79]
    buffer_load_dwordx4 v41, s[4:7], s28 offen offset:1024 lds
    v_mfma_f32_32x32x16_bf16 v[80:95], v[152:155], a[52:55], v[80:95]
    buffer_load_dwordx4 v[152:155], v24, s[48:51], s72 offen offset:2048 sc1
    buffer_load_dwordx4 v42, s[4:7], s28 offen offset:2048 lds
    buffer_load_dwordx4 v43, s[4:7], s28 offen offset:3072 lds
    s_waitcnt vmcnt(16)
    v_mfma_f32_32x32x16_bf16 v[64:79], v[156:159], a[56:59], v[64:79]
    v_mfma_f32_32x32x16_bf16 v[80:95], v[156:159], a[60:63], v[80:95]
    buffer_load_dwordx4 v[156:159], v24, s[48:51], s72 offen offset:3072 sc1
    s_add_u32 s12, s28, 131072
    s_add_u32 m0, s36, 4096
    s_nop 0
    buffer_load_dwordx4 v40, s[4:7], s12 offen offset:0 lds
    buffer_load_dwordx4 v41, s[4:7], s12 offen offset:1024 lds
    s_waitcnt vmcnt(18)
    v_mfma_f32_32x32x16_bf16 v[64:79], v[160:163], a[64:67], v[64:79]
    s_add_u32 s72, s3, 5
    s_and_b32 s72, s72, 7
    s_lshl_b32 s72, s72, 12
    s_add_u32 s72, s72, s80
    s_lshl_b32 s13, s88, 17
    v_mfma_f32_32x32x16_bf16 v[80:95], v[160:163], a[68:71], v[80:95]
    s_add_u32 s72, s72, s13
    buffer_load_dwordx4 v[160:163], v24, s[48:51], s72 offen offset:0 sc1
    buffer_load_dwordx4 v42, s[4:7], s12 offen offset:2048 lds
    buffer_load_dwordx4 v43, s[4:7], s12 offen offset:3072 lds
    s_waitcnt vmcnt(20)
    v_mfma_f32_32x32x16_bf16 v[64:79], v[164:167], a[72:75], v[64:79]
    v_mfma_f32_32x32x16_bf16 v[80:95], v[164:167], a[76:79], v[80:95]
    buffer_load_dwordx4 v[164:167], v24, s[48:51], s72 offen offset:1024 sc1
    s_waitcnt vmcnt(20)
    v_mfma_f32_32x32x16_bf16 v[64:79], v[168:171], a[80:83], v[64:79]
    v_mfma_f32_32x32x16_bf16 v[80:95], v[168:171], a[84:87], v[80:95]
    buffer_load_dwordx4 v[168:171], v24, s[48:51], s72 offen offset:2048 sc1
    ds_read_b128 a[128:131], v52 offset:0
    ds_read_b128 a[132:135], v52 offset:4096
    ds_read_b128 a[136:139], v53 offset:0
    ds_read_b128 a[140:143], v53 offset:4096
    s_waitcnt vmcnt(20)
    v_mfma_f32_32x32x16_bf16 v[64:79], v[172:175], a[88:91], v[64:79]
    ds_read_b128 a[144:147], v54 offset:0
    ds_read_b128 a[148:151], v54 offset:4096
    ds_read_b128 a[152:155], v55 offset:0
    ds_read_b128 a[156:159], v55 offset:4096
    v_mfma_f32_32x32x16_bf16 v[80:95], v[172:175], a[92:95], v[80:95]
    buffer_load_dwordx4 v[172:175], v24, s[48:51], s72 offen offset:3072 sc1
    s_waitcnt lgkmcnt(0)
    s_add_u32 m0, s37, 0
    s_nop 0
    buffer_load_dwordx4 v40, s[4:7], s29 offen offset:0 lds
    buffer_load_dwordx4 v41, s[4:7], s29 offen offset:1024 lds
    s_waitcnt vmcnt(22)
    v_mfma_f32_32x32x16_bf16 v[64:79], v[128:131], a[96:99], v[64:79]
    s_add_u32 s72, s3, 6
    s_and_b32 s72, s72, 7
    s_lshl_b32 s72, s72, 12
    s_add_u32 s72, s72, s80
    s_lshl_b32 s13, s88, 17
    v_mfma_f32_32x32x16_bf16 v[80:95], v[128:131], a[100:103], v[80:95]
    s_add_u32 s72, s72, s13
    buffer_load_dwordx4 v[128:131], v24, s[48:51], s72 offen offset:0 sc1
    buffer_load_dwordx4 v42, s[4:7], s29 offen offset:2048 lds
    buffer_load_dwordx4 v43, s[4:7], s29 offen offset:3072 lds
    s_waitcnt vmcnt(24)
    v_mfma_f32_32x32x16_bf16 v[64:79], v[132:135], a[104:107], v[64:79]
    v_mfma_f32_32x32x16_bf16 v[80:95], v[132:135], a[108:111], v[80:95]
    buffer_load_dwordx4 v[132:135], v24, s[48:51], s72 offen offset:1024 sc1
    s_add_u32 s12, s29, 131072
    s_add_u32 m0, s37, 4096
    s_nop 0
    buffer_load_dwordx4 v40, s[4:7], s12 offen offset:0 lds
    buffer_load_dwordx4 v41, s[4:7], s12 offen offset:1024 lds
    s_waitcnt vmcnt(26)
    v_mfma_f32_32x32x16_bf16 v[64:79], v[136:139], a[112:115], v[64:79]
    v_mfma_f32_32x32x16_bf16 v[80:95], v[136:139], a[116:119], v[80:95]
    buffer_load_dwordx4 v[136:139], v24, s[48:51], s72 offen offset:2048 sc1
    buffer_load_dwordx4 v42, s[4:7], s12 offen offset:2048 lds
    buffer_load_dwordx4 v43, s[4:7], s12 offen offset:3072 lds
    s_mov_b32 s97, 131072
    s_waitcnt vmcnt(26)
    v_cmp_ne_u32 vcc, s61, v15
    v_mfma_f32_32x32x16_bf16 v[64:79], v[140:143], a[120:123], v[64:79]
    s_cbranch_vccnz PS_10
PC_9:
    s_add_u32 s12, s78, 0
    buffer_load_dwordx4 v[176:179], v24, s[44:47], s12 offen offset:0 sc1
    v_mfma_f32_32x32x16_bf16 v[80:95], v[140:143], a[124:127], v[80:95]
    buffer_load_dwordx4 v[140:143], v24, s[48:51], s72 offen offset:3072 sc1
    buffer_load_dwordx4 v[180:183], v24, s[44:47], s12 offen offset:1024 sc1
    s_add_u32 s72, s3, 7
    s_and_b32 s72, s72, 7
    s_lshl_b32 s72, s72, 12
    v_mfma_f32_32x32x16_bf16 v[64:79], v[144:147], a[128:131], v[64:79]
    s_add_u32 s72, s72, s80
    s_lshl_b32 s13, s88, 17
    s_add_u32 s72, s72, s13
    v_mfma_f32_32x32x16_bf16 v[80:95], v[144:147], a[132:135], v[80:95]
    buffer_load_dwordx4 v[144:147], v24, s[48:51], s72 offen offset:0 sc1
    ds_read_b128 a[160:163], v56 offset:0
    ds_read_b128 a[164:167], v56 offset:4096
    ds_read_b128 a[168:171], v57 offset:0
    ds_read_b128 a[172:175], v57 offset:4096
    s_waitcnt vmcnt(29)
    v_mfma_f32_32x32x16_bf16 v[64:79], v[148:151], a[136:139], v[64:79]
    ds_read_b128 a[176:179], v58 offset:0
    ds_read_b128 a[180:183], v58 offset:4096
    ds_read_b128 a[184:187], v59 offset:0
    ds_read_b128 a[188:191], v59 offset:4096
    buffer_load_dwordx4 v[184:187], v24, s[44:47], s12 offen offset:2048 sc1
    v_mfma_f32_32x32x16_bf16 v[80:95], v[148:151], a[140:143], v[80:95]
    buffer_load_dwordx4 v[148:151], v24, s[48:51], s72 offen offset:1024 sc1
    buffer_load_dwordx4 v[188:191], v24, s[44:47], s12 offen offset:3072 sc1
    s_waitcnt vmcnt(29)
    v_mfma_f32_32x32x16_bf16 v[64:79], v[152:155], a[144:147], v[64:79]
    v_mfma_f32_32x32x16_bf16 v[80:95], v[152:155], a[148:151], v[80:95]
    buffer_load_dwordx4 v[152:155], v24, s[48:51], s72 offen offset:2048 sc1
    s_add_u32 s12, s78, 4096
    buffer_load_dwordx4 v[240:243], v24, s[44:47], s12 offen offset:0 sc1
    s_waitcnt vmcnt(28)
    v_mfma_f32_32x32x16_bf16 v[64:79], v[156:159], a[152:155], v[64:79]
    v_mfma_f32_32x32x16_bf16 v[80:95], v[156:159], a[156:159], v[80:95]
    buffer_load_dwordx4 v[156:159], v24, s[48:51], s72 offen offset:3072 sc1
    buffer_load_dwordx4 v[244:247], v24, s[44:47], s12 offen offset:1024 sc1
    s_add_u32 s72, s3, 0
    s_and_b32 s72, s72, 7
    s_lshl_b32 s72, s72, 12
    s_waitcnt vmcnt(27) lgkmcnt(7)
    v_mfma_f32_32x32x16_bf16 v[64:79], v[160:163], a[160:163], v[64:79]
    s_add_u32 s72, s72, s80
    s_lshl_b32 s13, s89, 17
    s_add_u32 s72, s72, s13
    s_waitcnt lgkmcnt(6)
    v_mfma_f32_32x32x16_bf16 v[80:95], v[160:163], a[164:167], v[80:95]
    buffer_load_dwordx4 v[160:163], v24, s[48:51], s72 offen offset:0 sc1
    buffer_load_dwordx4 v[248:251], v24, s[44:47], s12 offen offset:2048 sc1
    s_waitcnt vmcnt(26) lgkmcnt(5)
    v_mfma_f32_32x32x16_bf16 v[64:79], v[164:167], a[168:171], v[64:79]
    s_waitcnt lgkmcnt(4)
    v_mfma_f32_32x32x16_bf16 v[80:95], v[164:167], a[172:175], v[80:95]
    buffer_load_dwordx4 v[164:167], v24, s[48:51], s72 offen offset:1024 sc1
    buffer_load_dwordx4 v[252:255], v24, s[44:47], s12 offen offset:3072 sc1
    s_waitcnt vmcnt(27) lgkmcnt(3)
    v_mfma_f32_32x32x16_bf16 v[64:79], v[168:171], a[176:179], v[64:79]
    s_waitcnt lgkmcnt(2)
    v_mfma_f32_32x32x16_bf16 v[80:95], v[168:171], a[180:183], v[80:95]
    buffer_load_dwordx4 v[168:171], v24, s[48:51], s72 offen offset:2048 sc1
    ds_read_b128 a[192:195], v48 offset:0
    ds_read_b128 a[196:199], v48 offset:4096
    ds_read_b128 a[200:203], v49 offset:0
    ds_read_b128 a[204:207], v49 offset:4096
    s_waitcnt vmcnt(27) lgkmcnt(5)
    v_mfma_f32_32x32x16_bf16 v[64:79], v[172:175], a[184:187], v[64:79]
    ds_read_b128 a[208:211], v50 offset:0
    ds_read_b128 a[212:215], v50 offset:4096
    ds_read_b128 a[216:219], v51 offset:0
    ds_read_b128 a[220:223], v51 offset:4096
    s_waitcnt lgkmcnt(8)
    v_mfma_f32_32x32x16_bf16 v[80:95], v[172:175], a[188:191], v[80:95]
    buffer_load_dwordx4 v[172:175], v24, s[48:51], s72 offen offset:3072 sc1
    s_add_u32 s72, s3, 1
    s_and_b32 s72, s72, 7
    s_lshl_b32 s72, s72, 12
    s_add_u32 s72, s72, s80
    s_waitcnt vmcnt(25) lgkmcnt(7)
    v_mfma_f32_32x32x16_bf16 v[64:79], v[128:131], a[192:195], v[64:79]
    s_lshl_b32 s13, s89, 17
    s_add_u32 s72, s72, s13
    s_waitcnt lgkmcnt(6)
    v_mfma_f32_32x32x16_bf16 v[80:95], v[128:131], a[196:199], v[80:95]
    buffer_load_dwordx4 v[128:131], v24, s[48:51], s72 offen offset:0 sc1
    s_waitcnt vmcnt(23) lgkmcnt(5)
    v_mfma_f32_32x32x16_bf16 v[64:79], v[132:135], a[200:203], v[64:79]
    s_waitcnt lgkmcnt(4)
    v_mfma_f32_32x32x16_bf16 v[80:95], v[132:135], a[204:207], v[80:95]
    buffer_load_dwordx4 v[132:135], v24, s[48:51], s72 offen offset:1024 sc1
    s_waitcnt vmcnt(21) lgkmcnt(3)
    v_mfma_f32_32x32x16_bf16 v[64:79], v[136:139], a[208:211], v[64:79]
    s_waitcnt lgkmcnt(2)
    v_mfma_f32_32x32x16_bf16 v[80:95], v[136:139], a[212:215], v[80:95]
    buffer_load_dwordx4 v[136:139], v24, s[48:51], s72 offen offset:2048 sc1
    s_waitcnt vmcnt(20)
    ds_read_b128 a[224:227], v52 offset:0
    ds_read_b128 a[228:231], v52 offset:4096
    ds_read_b128 a[232:235], v53 offset:0
    ds_read_b128 a[236:239], v53 offset:4096
    s_waitcnt vmcnt(18) lgkmcnt(5)
    v_mfma_f32_32x32x16_bf16 v[64:79], v[140:143], a[216:219], v[64:79]
    ds_read_b128 a[240:243], v54 offset:0
    ds_read_b128 a[244:247], v54 offset:4096
    ds_read_b128 a[248:251], v55 offset:0
    ds_read_b128 a[252:255], v55 offset:4096
    s_waitcnt lgkmcnt(8)
    v_mfma_f32_32x32x16_bf16 v[80:95], v[140:143], a[220:223], v[80:95]
    buffer_load_dwordx4 v[140:143], v24, s[48:51], s72 offen offset:3072 sc1
    s_add_u32 s72, s3, 2
    s_and_b32 s72, s72, 7
    s_lshl_b32 s72, s72, 12
    s_add_u32 s72, s72, s80
    s_waitcnt vmcnt(17) lgkmcnt(7)
    v_mfma_f32_32x32x16_bf16 v[64:79], v[144:147], a[224:227], v[64:79]
    s_lshl_b32 s13, s89, 17
    s_add_u32 s72, s72, s13
    s_waitcnt lgkmcnt(6)
    v_mfma_f32_32x32x16_bf16 v[80:95], v[144:147], a[228:231], v[80:95]
    buffer_load_dwordx4 v[144:147], v24, s[48:51], s72 offen offset:0 sc1
    s_mov_b32 s97, 131072
    buffer_load_dword v14, v9, s[48:51], s97 offen sc1
    s_waitcnt vmcnt(17) lgkmcnt(5)
    v_mfma_f32_32x32x16_bf16 v[64:79], v[148:151], a[232:235], v[64:79]
    s_waitcnt lgkmcnt(4)
    v_mfma_f32_32x32x16_bf16 v[80:95], v[148:151], a[236:239], v[80:95]
    buffer_load_dwordx4 v[148:151], v24, s[48:51], s72 offen offset:1024 sc1
    s_waitcnt vmcnt(16) lgkmcnt(3)
    v_mfma_f32_32x32x16_bf16 v[64:79], v[152:155], a[240:243], v[64:79]
    s_waitcnt lgkmcnt(2)
    v_mfma_f32_32x32x16_bf16 v[80:95], v[152:155], a[244:247], v[80:95]
    buffer_load_dwordx4 v[152:155], v24, s[48:51], s72 offen offset:2048 sc1
    v_add_f32 v176, v176, v180
    v_add_f32 v177, v177, v181
    v_add_f32 v178, v178, v182
    v_add_f32 v179, v179, v183
    s_waitcnt vmcnt(15) lgkmcnt(1)
    v_mfma_f32_32x32x16_bf16 v[64:79], v[156:159], a[248:251], v[64:79]
    v_add_f32 v184, v184, v188
    v_add_f32 v185, v185, v189
    s_waitcnt lgkmcnt(0)
    v_mfma_f32_32x32x16_bf16 v[80:95], v[156:159], a[252:255], v[80:95]
    buffer_load_dwordx4 v[156:159], v24, s[48:51], s72 offen offset:3072 sc1
    s_waitcnt lgkmcnt(0)
    s_barrier
    v_add_f32 v186, v186, v190
    v_add_f32 v187, v187, v191
    s_waitcnt vmcnt(14)
    v_mfma_f32_32x32x16_bf16 v[96:111], v[160:163], a[0:3], 0
    v_add_f32 v240, v240, v244
    v_add_f32 v241, v241, v245
    v_add_f32 v242, v242, v246
    v_add_f32 v243, v243, v247
    s_add_u32 s72, s3, 3
    v_mfma_f32_32x32x16_bf16 v[112:127], v[160:163], a[4:7], 0
    s_and_b32 s72, s72, 7
    s_lshl_b32 s72, s72, 12
    s_add_u32 s72, s72, s80
    s_lshl_b32 s13, s89, 17
    s_add_u32 s72, s72, s13
    s_waitcnt vmcnt(12)
    v_mfma_f32_32x32x16_bf16 v[96:111], v[164:167], a[8:11], v[96:111]
    buffer_load_dwordx4 v[160:163], v24, s[48:51], s72 offen offset:0 sc1
    s_waitcnt vmcnt(12)
    v_add_f32 v248, v248, v252
    v_add_f32 v249, v249, v253
    v_add_f32 v250, v250, v254
    v_add_f32 v251, v251, v255
    v_mfma_f32_32x32x16_bf16 v[112:127], v[164:167], a[12:15], v[112:127]
    v_add_f32 v176, v176, v184
    v_add_f32 v240, v240, v248
    buffer_load_dwordx4 v[164:167], v24, s[48:51], s72 offen offset:1024 sc1
    v_add_f32 v177, v177, v185
    v_add_f32 v241, v241, v249
    s_waitcnt vmcnt(12)
    v_mfma_f32_32x32x16_bf16 v[96:111], v[168:171], a[16:19], v[96:111]
    v_add_f32 v178, v178, v186
    v_add_f32 v242, v242, v250
    v_add_f32 v179, v179, v187
    v_add_f32 v243, v243, v251
    v_mfma_f32_32x32x16_bf16 v[112:127], v[168:171], a[20:23], v[112:127]
    buffer_load_dwordx4 v[168:171], v24, s[48:51], s72 offen offset:2048 sc1
    ds_write_b128 v16, v[64:67] offset:0
    v_add_f32 v236, v176, v240
    v_add_f32 v237, v177, v241
    v_add_f32 v238, v178, v242
    s_waitcnt vmcnt(12)
    v_mfma_f32_32x32x16_bf16 v[96:111], v[172:175], a[24:27], v[96:111]
    v_add_f32 v239, v179, v243
    v_mfma_f32_32x32x16_bf16 v[112:127], v[172:175], a[28:31], v[112:127]
    buffer_load_dwordx4 v[172:175], v24, s[48:51], s72 offen offset:3072 sc1
    ds_write_b128 v16, v[68:71] offset:1024
    s_mul_i32 s64, s56, 40960
    s_add_u32 s64, s64, 38912
    v_add_u32 v1, s64, v24
    s_waitcnt vmcnt(12)
    v_mfma_f32_32x32x16_bf16 v[96:111], v[128:131], a[32:35], v[96:111]
    ds_write_b128 v1, v[236:239]
    s_waitcnt lgkmcnt(0)
    s_barrier
    v_add_u32 v1, 79872, v24
    ds_read_b128 v[240:243], v1
    v_mfma_f32_32x32x16_bf16 v[112:127], v[128:131], a[36:39], v[112:127]
    s_waitcnt lgkmcnt(0)
    v_add_f32 v236, v236, v240
    v_add_f32 v237, v237, v241
    v_add_f32 v238, v238, v242
    v_add_f32 v239, v239, v243
    v_cvt_pk_bf16_f32 v236, v236, v237
    s_waitcnt vmcnt(11)
    v_mfma_f32_32x32x16_bf16 v[96:111], v[132:135], a[40:43], v[96:111]
    v_cvt_pk_bf16_f32 v237, v238, v239
    s_cmp_eq_u32 s56, 0
    s_cselect_b32 s46, 0x10000000, 0
    s_lshr_b32 s64, s74, 1
    s_lshl_b32 s64, s64, 10
    v_mfma_f32_32x32x16_bf16 v[112:127], v[132:135], a[44:47], v[112:127]
    s_and_b32 s65, s74, 1
    s_lshl_b32 s65, s65, 3
    s_add_u32 s64, s64, s65
    s_add_u32 s64, s64, 393216
    buffer_store_dwordx2 v[236:237], v24, s[44:47], s64 offen sc1
    s_waitcnt vmcnt(11)
    v_mfma_f32_32x32x16_bf16 v[96:111], v[136:139], a[48:51], v[96:111]
    s_add_u32 s72, s3, 4
    s_and_b32 s72, s72, 7
    s_lshl_b32 s72, s72, 12
    s_add_u32 s72, s72, s80
    s_lshl_b32 s13, s89, 17
    v_mfma_f32_32x32x16_bf16 v[112:127], v[136:139], a[52:55], v[112:127]
    s_add_u32 s72, s72, s13
    buffer_load_dwordx4 v[128:131], v24, s[48:51], s72 offen offset:0 sc1
    ds_write_b128 v17, v[80:83] offset:0
    buffer_load_dwordx4 v[132:135], v24, s[48:51], s72 offen offset:1024 sc1
    ds_write_b128 v17, v[84:87] offset:1024
    s_waitcnt vmcnt(12)
    v_mfma_f32_32x32x16_bf16 v[96:111], v[140:143], a[56:59], v[96:111]
    buffer_load_dwordx4 v[136:139], v24, s[48:51], s72 offen offset:2048 sc1
    ds_write_b128 v18, v[72:75] offset:0
    v_mfma_f32_32x32x16_bf16 v[112:127], v[140:143], a[60:63], v[112:127]
    buffer_load_dwordx4 v[140:143], v24, s[48:51], s72 offen offset:3072 sc1
    ds_write_b128 v18, v[76:79] offset:1024
    s_add_u32 s72, s3, 5
    s_and_b32 s72, s72, 7
    s_lshl_b32 s72, s72, 12
    s_waitcnt vmcnt(13)
    v_mfma_f32_32x32x16_bf16 v[96:111], v[144:147], a[64:67], v[96:111]
    s_add_u32 s72, s72, s80
    s_lshl_b32 s13, s89, 17
    s_add_u32 s72, s72, s13
    v_mfma_f32_32x32x16_bf16 v[112:127], v[144:147], a[68:71], v[112:127]
    buffer_load_dwordx4 v[144:147], v24, s[48:51], s72 offen offset:0 sc1
    ds_write_b128 v19, v[88:91] offset:0
    s_waitcnt vmcnt(12)
    v_mfma_f32_32x32x16_bf16 v[96:111], v[148:151], a[72:75], v[96:111]
    v_mfma_f32_32x32x16_bf16 v[112:127], v[148:151], a[76:79], v[112:127]
    buffer_load_dwordx4 v[148:151], v24, s[48:51], s72 offen offset:1024 sc1
    ds_write_b128 v19, v[92:95] offset:1024
    s_waitcnt vmcnt(12)
    v_mfma_f32_32x32x16_bf16 v[96:111], v[152:155], a[80:83], v[96:111]
    v_mfma_f32_32x32x16_bf16 v[112:127], v[152:155], a[84:87], v[112:127]
    buffer_load_dwordx4 v[152:155], v24, s[48:51], s72 offen offset:2048 sc1
    s_waitcnt vmcnt(12)
    v_mfma_f32_32x32x16_bf16 v[96:111], v[156:159], a[88:91], v[96:111]
    v_mfma_f32_32x32x16_bf16 v[112:127], v[156:159], a[92:95], v[112:127]
    buffer_load_dwordx4 v[156:159], v24, s[48:51], s72 offen offset:3072 sc1
    s_add_u32 s72, s3, 6
    s_and_b32 s72, s72, 7
    s_lshl_b32 s72, s72, 12
    s_add_u32 s72, s72, s80
    s_waitcnt vmcnt(12)
    v_mfma_f32_32x32x16_bf16 v[96:111], v[160:163], a[96:99], v[96:111]
    s_lshl_b32 s13, s89, 17
    s_add_u32 s72, s72, s13
    v_mfma_f32_32x32x16_bf16 v[112:127], v[160:163], a[100:103], v[112:127]
    buffer_load_dwordx4 v[160:163], v24, s[48:51], s72 offen offset:0 sc1
    s_waitcnt lgkmcnt(0)
    s_barrier
    ds_read_b128 v[192:195], v20 offset:0
    s_waitcnt vmcnt(12)
    v_mfma_f32_32x32x16_bf16 v[96:111], v[164:167], a[104:107], v[96:111]
    v_mfma_f32_32x32x16_bf16 v[112:127], v[164:167], a[108:111], v[112:127]
    buffer_load_dwordx4 v[164:167], v24, s[48:51], s72 offen offset:1024 sc1
    ds_read_b128 v[196:199], v20 offset:1024
    s_waitcnt vmcnt(12)
    v_mfma_f32_32x32x16_bf16 v[96:111], v[168:171], a[112:115], v[96:111]
    v_mfma_f32_32x32x16_bf16 v[112:127], v[168:171], a[116:119], v[112:127]
    buffer_load_dwordx4 v[168:171], v24, s[48:51], s72 offen offset:2048 sc1
    ds_read_b128 v[200:203], v20 offset:2048
    s_waitcnt vmcnt(12)
    v_mfma_f32_32x32x16_bf16 v[96:111], v[172:175], a[120:123], v[96:111]
    v_mfma_f32_32x32x16_bf16 v[112:127], v[172:175], a[124:127], v[112:127]
    buffer_load_dwordx4 v[172:175], v24, s[48:51], s72 offen offset:3072 sc1
    ds_read_b128 v[204:207], v20 offset:3072
    s_add_u32 s72, s3, 7
    s_and_b32 s72, s72, 7
    s_lshl_b32 s72, s72, 12
    s_waitcnt vmcnt(11)
    v_mfma_f32_32x32x16_bf16 v[96:111], v[128:131], a[128:131], v[96:111]
    s_add_u32 s72, s72, s80
    s_lshl_b32 s13, s89, 17
    s_add_u32 s72, s72, s13
    v_mfma_f32_32x32x16_bf16 v[112:127], v[128:131], a[132:135], v[112:127]
    buffer_load_dwordx4 v[128:131], v24, s[48:51], s72 offen offset:0 sc1
    ds_read_b128 v[208:211], v20 offset:4096
    s_waitcnt vmcnt(11)
    v_mfma_f32_32x32x16_bf16 v[96:111], v[132:135], a[136:139], v[96:111]
    v_mfma_f32_32x32x16_bf16 v[112:127], v[132:135], a[140:143], v[112:127]
    buffer_load_dwordx4 v[132:135], v24, s[48:51], s72 offen offset:1024 sc1
    ds_read_b128 v[212:215], v20 offset:5120
    s_waitcnt vmcnt(11)
    v_mfma_f32_32x32x16_bf16 v[96:111], v[136:139], a[144:147], v[96:111]
    v_mfma_f32_32x32x16_bf16 v[112:127], v[136:139], a[148:151], v[112:127]
    buffer_load_dwordx4 v[136:139], v24, s[48:51], s72 offen offset:2048 sc1
    ds_read_b128 v[216:219], v20 offset:6144
    s_waitcnt vmcnt(11)
    v_mfma_f32_32x32x16_bf16 v[96:111], v[140:143], a[152:155], v[96:111]
    v_mfma_f32_32x32x16_bf16 v[112:127], v[140:143], a[156:159], v[112:127]
    buffer_load_dwordx4 v[140:143], v24, s[48:51], s72 offen offset:3072 sc1
    ds_read_b128 v[220:223], v20 offset:7168
    s_mov_b32 s97, 131072
    v_cmp_ne_u32 vcc, s61, v14
    s_nop 0
    s_cbranch_vccnz PS_12
PC_11:
    s_waitcnt vmcnt(11)
    v_mfma_f32_32x32x16_bf16 v[96:111], v[144:147], a[160:163], v[96:111]
    s_lshl_b32 s64, s74, 4
    s_add_u32 s64, s64, 262144
    v_mov_b32 v30, s61
    buffer_store_dword v30, off, s[44:47], s64 sc1
    s_lshl_b32 s64, s88, 11
    v_mfma_f32_32x32x16_bf16 v[112:127], v[144:147], a[164:167], v[112:127]
    s_add_u32 s64, s64, s76
    buffer_load_dwordx4 v[224:227], v24, s[48:51], s64 offen sc1
    s_lshl_b32 s64, s89, 11
    s_add_u32 s64, s64, s76
    buffer_load_dwordx4 v[228:231], v24, s[48:51], s64 offen sc1
    s_waitcnt vmcnt(13)
    v_mfma_f32_32x32x16_bf16 v[96:111], v[148:151], a[168:171], v[96:111]
    s_lshl_b32 s64, s59, 8
    s_add_u32 s64, s64, 327680
    buffer_load_dword v22, v13, s[48:51], s64 offen sc1
    buffer_load_dword v23, v13, s[48:51], s64 offen offset:128 sc1
    s_lshl1_add_u32 s12, s59, 0
    v_mfma_f32_32x32x16_bf16 v[112:127], v[148:151], a[172:175], v[112:127]
    s_lshl_b32 s12, s12, 15
    s_lshl_b32 s65, s56, 13
    s_add_u32 s12, s12, s65
    s_add_u32 s12, s12, 8388608
    buffer_load_dwordx4 a[0:3], v24, s[48:51], s12 offen offset:0 sc1
    s_waitcnt vmcnt(15)
    v_mfma_f32_32x32x16_bf16 v[96:111], v[152:155], a[176:179], v[96:111]
    s_waitcnt lgkmcnt(5)
    v_add_f32 v192, v192, v200
    v_add_f32 v193, v193, v201
    v_add_f32 v194, v194, v202
    v_add_f32 v195, v195, v203
    s_waitcnt lgkmcnt(4)
    v_add_f32 v196, v196, v204
    v_mfma_f32_32x32x16_bf16 v[112:127], v[152:155], a[180:183], v[112:127]
    v_add_f32 v197, v197, v205
    s_lshl1_add_u32 s13, s59, 1
    s_lshl_b32 s13, s13, 15
    s_lshl_b32 s65, s56, 13
    s_add_u32 s13, s13, s65
    s_waitcnt vmcnt(14)
    v_mfma_f32_32x32x16_bf16 v[96:111], v[156:159], a[184:187], v[96:111]
    s_add_u32 s13, s13, 8388608
    buffer_load_dwordx4 a[4:7], v24, s[48:51], s13 offen offset:0 sc1
    buffer_load_dwordx4 a[8:11], v24, s[48:51], s12 offen offset:1024 sc1
    v_add_f32 v198, v198, v206
    v_add_f32 v199, v199, v207
    v_mfma_f32_32x32x16_bf16 v[112:127], v[156:159], a[188:191], v[112:127]
    s_waitcnt lgkmcnt(1)
    v_add_f32 v208, v208, v216
    v_add_f32 v209, v209, v217
    v_add_f32 v210, v210, v218
    v_add_f32 v211, v211, v219
    buffer_load_dwordx4 a[12:15], v24, s[48:51], s13 offen offset:1024 sc1
    s_waitcnt vmcnt(16)
    v_mfma_f32_32x32x16_bf16 v[96:111], v[160:163], a[192:195], v[96:111]
    buffer_load_dwordx4 a[16:19], v24, s[48:51], s12 offen offset:2048 sc1
    s_waitcnt lgkmcnt(0)
    v_add_f32 v212, v212, v220
    v_add_f32 v213, v213, v221
    v_add_f32 v214, v214, v222
    v_add_f32 v215, v215, v223
    v_mfma_f32_32x32x16_bf16 v[112:127], v[160:163], a[196:199], v[112:127]
    v_add_f32 v176, v192, v208
    v_add_f32 v177, v193, v209
    buffer_load_dwordx4 a[20:23], v24, s[48:51], s13 offen offset:2048 sc1
    buffer_load_dwordx4 a[24:27], v24, s[48:51], s12 offen offset:3072 sc1
    v_add_f32 v178, v194, v210
    s_waitcnt vmcnt(18)
    v_mfma_f32_32x32x16_bf16 v[96:111], v[164:167], a[200:203], v[96:111]
    v_add_f32 v179, v195, v211
    v_add_f32 v180, v196, v212
    v_add_f32 v181, v197, v213
    v_add_f32 v182, v198, v214
    v_add_f32 v183, v199, v215
    v_mfma_f32_32x32x16_bf16 v[112:127], v[164:167], a[204:207], v[112:127]
    buffer_load_dwordx4 a[28:31], v24, s[48:51], s13 offen offset:3072 sc1
    s_lshl1_add_u32 s12, s59, 0
    s_lshl_b32 s12, s12, 15
L_pad_P2L_1:
    s_cbranch_execz L_pad_P3_0
    s_lshl_b32 s65, s56, 13
    s_add_u32 s12, s12, s65
    s_waitcnt vmcnt(18)
    v_mfma_f32_32x32x16_bf16 v[96:111], v[168:171], a[208:211], v[96:111]
    s_add_u32 s12, s12, 8392704
    buffer_load_dwordx4 a[32:35], v24, s[48:51], s12 offen offset:0 sc1
    s_lshl1_add_u32 s13, s59, 1
    s_lshl_b32 s13, s13, 15
    s_lshl_b32 s65, s56, 13
    v_mfma_f32_32x32x16_bf16 v[112:127], v[168:171], a[212:215], v[112:127]
    s_add_u32 s13, s13, s65
    s_add_u32 s13, s13, 8392704
    buffer_load_dwordx4 a[36:39], v24, s[48:51], s13 offen offset:0 sc1
    buffer_load_dwordx4 a[40:43], v24, s[48:51], s12 offen offset:1024 sc1
    buffer_load_dwordx4 a[44:47], v24, s[48:51], s13 offen offset:1024 sc1
    s_waitcnt vmcnt(21)
    v_mfma_f32_32x32x16_bf16 v[96:111], v[172:175], a[216:219], v[96:111]
    buffer_load_dwordx4 a[48:51], v24, s[48:51], s12 offen offset:2048 sc1
    v_mfma_f32_32x32x16_bf16 v[112:127], v[172:175], a[220:223], v[112:127]
    buffer_load_dwordx4 a[52:55], v24, s[48:51], s13 offen offset:2048 sc1
    buffer_load_dwordx4 a[56:59], v24, s[48:51], s12 offen offset:3072 sc1
    s_waitcnt vmcnt(23)
    v_mfma_f32_32x32x16_bf16 v[96:111], v[128:131], a[224:227], v[96:111]
    v_mfma_f32_32x32x16_bf16 v[112:127], v[128:131], a[228:231], v[112:127]
    buffer_load_dwordx4 a[60:63], v24, s[48:51], s13 offen offset:3072 sc1
    s_waitcnt vmcnt(23)
    v_mfma_f32_32x32x16_bf16 v[96:111], v[132:135], a[232:235], v[96:111]
    v_mfma_f32_32x32x16_bf16 v[112:127], v[132:135], a[236:239], v[112:127]
    s_waitcnt vmcnt(22)
    v_mfma_f32_32x32x16_bf16 v[96:111], v[136:139], a[240:243], v[96:111]
    v_mfma_f32_32x32x16_bf16 v[112:127], v[136:139], a[244:247], v[112:127]
    s_waitcnt vmcnt(21)
    v_mfma_f32_32x32x16_bf16 v[96:111], v[140:143], a[248:251], v[96:111]
    v_mfma_f32_32x32x16_bf16 v[112:127], v[140:143], a[252:255], v[112:127]
    s_nop 10
    ds_write_b128 v16, v[96:99] offset:8192
    ds_write_b128 v16, v[100:103] offset:9216
    ds_write_b128 v17, v[112:115] offset:8192
    ds_write_b128 v17, v[116:119] offset:9216
    ds_write_b128 v18, v[104:107] offset:8192
    ds_write_b128 v18, v[108:111] offset:9216
    ds_write_b128 v19, v[120:123] offset:8192
    ds_write_b128 v19, v[124:127] offset:9216
    s_and_b32 s64, s56, 1
    s_cmp_eq_u32 s64, 0
    s_cselect_b64 vcc, -1, 0
    s_waitcnt vmcnt(16)
    v_cndmask_b32 v26, v23, v22, vcc
    v_sub_f32 v26, 1.0, v26
    v_mul_f32 v27, v21, v26
    v_mov_b32 v136, v26
    v_mov_b32 v137, v26
    v_mov_b32 v138, v27
    v_mov_b32 v139, v27
    s_waitcnt lgkmcnt(0)
    s_barrier
    ds_read_b128 v[192:195], v20 offset:8192
    ds_read_b128 v[196:199], v20 offset:9216
    ds_read_b128 v[200:203], v20 offset:10240
    ds_read_b128 v[204:207], v20 offset:11264
    ds_read_b128 v[208:211], v20 offset:12288
    ds_read_b128 v[212:215], v20 offset:13312
    ds_read_b128 v[216:219], v20 offset:14336
    ds_read_b128 v[220:223], v20 offset:15360
    v_pk_fma_f32 v[176:177], v[176:177], v[136:137], v[138:139]
    v_pk_fma_f32 v[178:179], v[178:179], v[136:137], v[138:139]
    v_pk_fma_f32 v[180:181], v[180:181], v[136:137], v[138:139]
    v_pk_fma_f32 v[182:183], v[182:183], v[136:137], v[138:139]
    v_lshlrev_b32 v128, 16, v224
    v_and_b32 v129, 0xffff0000, v224
    v_lshlrev_b32 v130, 16, v225
    v_and_b32 v131, 0xffff0000, v225
    v_lshlrev_b32 v132, 16, v226
    v_and_b32 v133, 0xffff0000, v226
    v_lshlrev_b32 v134, 16, v227
    v_and_b32 v135, 0xffff0000, v227
    v_pk_mul_f32 v[176:177], v[176:177], v[128:129]
    v_pk_mul_f32 v[178:179], v[178:179], v[130:131]
    v_pk_mul_f32 v[180:181], v[180:181], v[132:133]
    v_pk_mul_f32 v[182:183], v[182:183], v[134:135]
    v_cvt_pk_bf16_f32 v224, v176, v177
    v_cvt_pk_bf16_f32 v225, v178, v179
    v_cvt_pk_bf16_f32 v226, v180, v181
    v_cvt_pk_bf16_f32 v227, v182, v183
    s_lshl_b32 s64, s88, 11
    s_add_u32 s64, s64, s75
    buffer_store_dwordx4 v[224:227], v24, s[48:51], s64 offen sc1
    s_waitcnt lgkmcnt(5)
    v_pk_add_f32 v[192:193], v[192:193], v[200:201]
    v_pk_add_f32 v[194:195], v[194:195], v[202:203]
    s_waitcnt lgkmcnt(4)
    v_pk_add_f32 v[196:197], v[196:197], v[204:205]
    v_pk_add_f32 v[198:199], v[198:199], v[206:207]
    s_waitcnt lgkmcnt(1)
    v_pk_add_f32 v[208:209], v[208:209], v[216:217]
    v_pk_add_f32 v[210:211], v[210:211], v[218:219]
    s_waitcnt lgkmcnt(0)
    v_pk_add_f32 v[212:213], v[212:213], v[220:221]
    v_pk_add_f32 v[214:215], v[214:215], v[222:223]
    v_pk_add_f32 v[176:177], v[192:193], v[208:209]
    v_pk_add_f32 v[178:179], v[194:195], v[210:211]
    v_pk_add_f32 v[180:181], v[196:197], v[212:213]
    v_pk_add_f32 v[182:183], v[198:199], v[214:215]
    v_pk_fma_f32 v[176:177], v[176:177], v[136:137], v[138:139]
    v_pk_fma_f32 v[178:179], v[178:179], v[136:137], v[138:139]
    v_pk_fma_f32 v[180:181], v[180:181], v[136:137], v[138:139]
    v_pk_fma_f32 v[182:183], v[182:183], v[136:137], v[138:139]
    v_lshlrev_b32 v128, 16, v228
    v_and_b32 v129, 0xffff0000, v228
    v_lshlrev_b32 v130, 16, v229
    v_and_b32 v131, 0xffff0000, v229
    v_lshlrev_b32 v132, 16, v230
    v_and_b32 v133, 0xffff0000, v230
    v_lshlrev_b32 v134, 16, v231
    v_and_b32 v135, 0xffff0000, v231
    v_pk_mul_f32 v[176:177], v[176:177], v[128:129]
    v_pk_mul_f32 v[178:179], v[178:179], v[130:131]
    v_pk_mul_f32 v[180:181], v[180:181], v[132:133]
    v_pk_mul_f32 v[182:183], v[182:183], v[134:135]
    v_cvt_pk_bf16_f32 v228, v176, v177
    v_cvt_pk_bf16_f32 v229, v178, v179
    v_cvt_pk_bf16_f32 v230, v180, v181
    v_cvt_pk_bf16_f32 v231, v182, v183
    s_lshl_b32 s64, s89, 11
    s_add_u32 s64, s64, s75
    buffer_store_dwordx4 v[228:231], v24, s[48:51], s64 offen sc1
    s_lshl_b32 s64, s59, 5
    s_lshl2_add_u32 s64, s60, s64
    s_add_u32 s64, s64, s56
    s_cmp_lg_u32 s64, 27
    s_cbranch_scc1 EP_13_end
    s_mov_b32 s86, 20000
EP_13:
    v_and_b32 v2, 3, v0
    v_lshrrev_b32 v1, 2, v0
    v_lshlrev_b32 v1, 4, v1
    v_add_lshl_u32 v1, v1, v2, 2
    s_mov_b32 s67, 131072
    buffer_load_dword v32, v1, s[48:51], s67 offen sc1
    s_mov_b32 s67, 132096
    buffer_load_dword v33, v1, s[48:51], s67 offen sc1
    s_mov_b32 s67, 133120
    buffer_load_dword v34, v1, s[48:51], s67 offen sc1
    s_mov_b32 s67, 134144
    buffer_load_dword v35, v1, s[48:51], s67 offen sc1
    s_mov_b32 s67, 135168
    buffer_load_dword v36, v1, s[48:51], s67 offen sc1
    s_mov_b32 s67, 136192
    buffer_load_dword v37, v1, s[48:51], s67 offen sc1
    s_mov_b32 s67, 137216
    buffer_load_dword v38, v1, s[48:51], s67 offen sc1
    s_mov_b32 s67, 138240
    buffer_load_dword v39, v1, s[48:51], s67 offen sc1
    s_mov_b32 s67, 139264
    buffer_load_dword v40, v1, s[48:51], s67 offen sc1
    s_mov_b32 s67, 140288
    buffer_load_dword v41, v1, s[48:51], s67 offen sc1
    s_mov_b32 s67, 141312
    buffer_load_dword v42, v1, s[48:51], s67 offen sc1
    s_mov_b32 s67, 142336
    buffer_load_dword v43, v1, s[48:51], s67 offen sc1
    s_mov_b32 s67, 143360
    buffer_load_dword v44, v1, s[48:51], s67 offen sc1
    s_mov_b32 s67, 144384
    buffer_load_dword v45, v1, s[48:51], s67 offen sc1
    s_mov_b32 s67, 145408
    buffer_load_dword v46, v1, s[48:51], s67 offen sc1
    s_mov_b32 s67, 146432
    buffer_load_dword v47, v1, s[48:51], s67 offen sc1
    s_waitcnt vmcnt(0)
    v_xor_b32 v32, s61, v32
    v_xor_b32 v33, s61, v33
    v_xor_b32 v34, s61, v34
    v_xor_b32 v35, s61, v35
    v_xor_b32 v36, s61, v36
    v_xor_b32 v37, s61, v37
    v_xor_b32 v38, s61, v38
    v_xor_b32 v39, s61, v39
    v_xor_b32 v40, s61, v40
    v_xor_b32 v41, s61, v41
    v_xor_b32 v42, s61, v42
    v_xor_b32 v43, s61, v43
    v_xor_b32 v44, s61, v44
    v_xor_b32 v45, s61, v45
    v_xor_b32 v46, s61, v46
    v_xor_b32 v47, s61, v47
    v_or3_b32 v32, v32, v33, v34
    v_or3_b32 v32, v32, v35, v36
    v_or3_b32 v32, v32, v37, v38
    v_or3_b32 v32, v32, v39, v40
    v_or3_b32 v32, v32, v41, v42
    v_or3_b32 v32, v32, v43, v44
    v_or3_b32 v32, v32, v45, v46
    v_or3_b32 v32, v32, v47, v47
    v_cmp_ne_u32 vcc, 0, v32
    s_cbranch_vccz EP_13_ok
    s_sub_u32 s86, s86, 1
    s_cmp_lg_u32 s86, 0
    s_cbranch_scc1 EP_13
EP_13_ok:
    v_mov_b32 v30, s61
    buffer_store_dword v30, off, s[48:51], 0 sc1
EP_13_end:
L_P3:
L_pad_P3_0:
    s_cbranch_execz L_pad_P3_1
    v_bfe_u32 v1, v0, 2, 1
    v_bfe_u32 v2, v0, 4, 1
    v_xor_b32 v1, v1, v2
    v_and_b32 v2, 3, v0
    v_lshlrev_b32 v2, 4, v2
    v_lshl_add_u32 v1, v1, 6, v2
    v_lshrrev_b32 v2, 3, v0
    v_lshl_add_u32 v1, v2, 10, v1
    s_lshl_b32 s64, s60, 7
    v_add_u32 v28, s64, v1
    v_add_u32 v29, 7168, v28
    s_cmp_eq_u32 s56, 0
    s_cselect_b32 s64, 0x40000000, 0
    v_add_u32 v32, s64, v28
    s_mul_i32 s77, s56, 180224
    s_sub_u32 s77, s77, 16384
    s_mul_i32 s73, s56, 40960
    s_mov_b32 s40, s20
    s_mov_b32 s41, s21
    s_mov_b32 s42, 0x80000
    s_mov_b32 s43, 0x20000
    s_mov_b32 s8, s30
    s_mov_b32 s9, s31
    s_mov_b32 s10, 0xac000
    s_mov_b32 s11, 0x20000
    v_and_b32 v1, 15, v0
    s_lshl_b32 s64, s56, 4
    v_add_u32 v1, s64, v1
    v_lshlrev_b32 v11, 4, v1
    s_mov_b32 s97, 262144
    buffer_load_dword v14, v11, s[48:51], s97 offen sc1
    s_add_u32 m0, s73, 22528
    s_lshl_b32 s12, s56, 17
    s_add_u32 s12, s12, 0
    buffer_load_dwordx4 v28, s[40:43], s12 offen lds
    buffer_load_dwordx4 v29, s[40:43], s12 offen offset:1024 lds
    s_add_u32 m0, s73, 24576
    s_lshl_b32 s12, s56, 17
    s_add_u32 s12, s12, 16384
    buffer_load_dwordx4 v28, s[40:43], s12 offen lds
    buffer_load_dwordx4 v29, s[40:43], s12 offen offset:1024 lds
    s_add_u32 m0, s73, 26624
    s_lshl_b32 s12, s56, 17
    s_add_u32 s12, s12, 32768
    buffer_load_dwordx4 v28, s[40:43], s12 offen lds
    buffer_load_dwordx4 v29, s[40:43], s12 offen offset:1024 lds
    s_add_u32 m0, s73, 28672
    s_lshl_b32 s12, s56, 17
    s_add_u32 s12, s12, 49152
    buffer_load_dwordx4 v28, s[40:43], s12 offen lds
    buffer_load_dwordx4 v29, s[40:43], s12 offen offset:1024 lds
    v_bfe_u32 v1, v0, 2, 2
    v_lshrrev_b32 v2, 5, v0
    v_lshl_add_u32 v2, v2, 2, v1
    v_lshlrev_b32 v2, 7, v2
    v_lshrrev_b32 v1, 1, v1
    v_lshl_add_u32 v2, v1, 6, v2
    v_bfe_u32 v1, v0, 4, 1
    v_lshl_add_u32 v2, v1, 5, v2
    v_and_b32 v1, 3, v0
    v_lshl_add_u32 v26, v1, 3, v2
    v_add_u32 v26, s73, v26
    v_xor_b32 v27, 64, v26
    s_waitcnt vmcnt(9)
    s_lshl3_add_u32 s64, s59, s60
    s_lshl4_add_u32 s64, s64, s56
    s_lshl_b32 s64, s64, 2
    s_add_u32 s64, s64, 196608
    v_mov_b32 v30, s61
    buffer_store_dword v30, off, s[48:51], s64 sc1
    s_waitcnt vmcnt(9)
    v_cmp_ne_u32 vcc, s61, v14
    s_nop 0
    s_cbranch_vccnz PS_15
PC_14:
    s_lshl_b32 s64, s56, 13
    s_add_u32 s64, s64, 393216
    buffer_load_dwordx4 a[64:67], v24, s[48:51], s64 offen offset:0 sc1
    buffer_load_dwordx4 a[68:71], v24, s[48:51], s64 offen offset:1024 sc1
    buffer_load_dwordx4 a[72:75], v24, s[48:51], s64 offen offset:2048 sc1
    buffer_load_dwordx4 a[76:79], v24, s[48:51], s64 offen offset:3072 sc1
    s_add_u32 s64, s64, 4096
    buffer_load_dwordx4 a[80:83], v24, s[48:51], s64 offen offset:0 sc1
    buffer_load_dwordx4 a[84:87], v24, s[48:51], s64 offen offset:1024 sc1
    buffer_load_dwordx4 a[88:91], v24, s[48:51], s64 offen offset:2048 sc1
    buffer_load_dwordx4 a[92:95], v24, s[48:51], s64 offen offset:3072 sc1
    s_waitcnt vmcnt(15)
    ds_read_b64_tr_b16 v[48:49], v26 offset:22528
    ds_read_b64_tr_b16 v[50:51], v26 offset:23552
    ds_read_b64_tr_b16 v[52:53], v27 offset:22528
    ds_read_b64_tr_b16 v[54:55], v27 offset:23552
    s_waitcnt vmcnt(7)
    v_mfma_f32_32x32x16_bf16 v[224:239], a[64:67], a[0:3], 0
    s_nop 11
    v_add_f32 v232, 0x358637bd, v232
    v_rcp_f32 v232, v232
    s_add_u32 m0, s73, 30720
    s_lshl_b32 s12, s56, 17
    s_add_u32 s12, s12, 65536
    buffer_load_dwordx4 v28, s[40:43], s12 offen lds
    v_mfma_f32_32x32x16_bf16 v[240:255], a[64:67], a[4:7], 0
    v_mul_f32 v232, v232, v22
    v_mul_f32 v224, v224, v232
    v_mul_f32 v225, v225, v232
    v_mul_f32 v226, v226, v232
    v_mul_f32 v227, v227, v232
    v_mul_f32 v228, v228, v232
    v_mul_f32 v229, v229, v232
    v_mul_f32 v230, v230, v232
    buffer_load_dwordx4 v29, s[40:43], s12 offen offset:1024 lds
    v_mul_f32 v231, v231, v232
    v_cvt_pk_bf16_f32 v8, v224, v225
    v_cvt_pk_bf16_f32 v9, v226, v227
    v_cvt_pk_bf16_f32 v10, v228, v229
    v_cvt_pk_bf16_f32 v11, v230, v231
    s_waitcnt vmcnt(8)
    v_mfma_f32_32x32x16_bf16 v[224:239], a[68:71], a[8:11], 0
    v_add_f32 v248, 0x358637bd, v248
    v_rcp_f32 v248, v248
    s_nop 0
    v_mul_f32 v248, v248, v23
    s_add_u32 m0, s73, 32768
    s_lshl_b32 s12, s56, 17
    s_add_u32 s12, s12, 81920
    buffer_load_dwordx4 v28, s[40:43], s12 offen lds
    v_mul_f32 v240, v240, v248
    v_mul_f32 v241, v241, v248
    v_mul_f32 v242, v242, v248
    v_mul_f32 v243, v243, v248
    v_mul_f32 v244, v244, v248
    v_mul_f32 v245, v245, v248
    v_mul_f32 v246, v246, v248
    v_mul_f32 v247, v247, v248
    buffer_load_dwordx4 v29, s[40:43], s12 offen offset:1024 lds
    v_cvt_pk_bf16_f32 v12, v240, v241
    v_cvt_pk_bf16_f32 v13, v242, v243
    v_cvt_pk_bf16_f32 v14, v244, v245
    v_cvt_pk_bf16_f32 v15, v246, v247
    v_mfma_f32_32x32x16_bf16 v[240:255], a[68:71], a[12:15], 0
    ds_read_b64_tr_b16 v[56:57], v26 offset:24576
    ds_read_b64_tr_b16 v[58:59], v26 offset:25600
    s_add_u32 m0, s73, 34816
    s_lshl_b32 s12, s56, 17
    s_add_u32 s12, s12, 98304
    buffer_load_dwordx4 v28, s[40:43], s12 offen lds
    s_waitcnt lgkmcnt(4)
    v_mfma_f32_32x32x16_bf16 v[64:79], v[48:51], v[8:11], 0
    ds_read_b64_tr_b16 v[60:61], v27 offset:24576
    ds_read_b64_tr_b16 v[62:63], v27 offset:25600
    s_waitcnt lgkmcnt(4)
    v_mfma_f32_32x32x16_bf16 v[80:95], v[52:55], v[8:11], 0
    v_add_f32 v224, 0x358637bd, v224
    v_rcp_f32 v224, v224
    buffer_load_dwordx4 v29, s[40:43], s12 offen offset:1024 lds
    v_mul_f32 v224, v224, v22
    v_mul_f32 v232, v232, v224
    v_mul_f32 v233, v233, v224
    v_mfma_f32_32x32x16_bf16 v[96:111], v[48:51], v[12:15], 0
    v_mul_f32 v234, v234, v224
    v_mul_f32 v235, v235, v224
    v_mul_f32 v236, v236, v224
    v_mul_f32 v237, v237, v224
    v_mul_f32 v238, v238, v224
    s_add_u32 m0, s73, 36864
    v_mfma_f32_32x32x16_bf16 v[112:127], v[52:55], v[12:15], 0
    s_lshl_b32 s12, s56, 17
    s_add_u32 s12, s12, 114688
    buffer_load_dwordx4 v28, s[40:43], s12 offen lds
    v_mul_f32 v239, v239, v224
    v_cvt_pk_bf16_f32 v16, v232, v233
    v_cvt_pk_bf16_f32 v17, v234, v235
    v_cvt_pk_bf16_f32 v18, v236, v237
    v_cvt_pk_bf16_f32 v19, v238, v239
    s_waitcnt vmcnt(12)
    v_mfma_f32_32x32x16_bf16 v[224:239], a[72:75], a[16:19], 0
    v_add_f32 v240, 0x358637bd, v240
    v_rcp_f32 v240, v240
    s_nop 0
    v_mul_f32 v240, v240, v23
    buffer_load_dwordx4 v29, s[40:43], s12 offen offset:1024 lds
    v_mul_f32 v248, v248, v240
    v_mul_f32 v249, v249, v240
    v_mul_f32 v250, v250, v240
    v_mul_f32 v251, v251, v240
    v_mul_f32 v252, v252, v240
    v_mul_f32 v253, v253, v240
    v_mul_f32 v254, v254, v240
    v_mul_f32 v255, v255, v240
    s_add_u32 m0, s73, 0
    s_add_u32 s12, s77, 0
    s_max_i32 s12, s12, 0
    buffer_load_dwordx4 v32, s[8:11], s12 offen lds
    v_cvt_pk_bf16_f32 v4, v248, v249
    v_cvt_pk_bf16_f32 v5, v250, v251
    v_cvt_pk_bf16_f32 v6, v252, v253
    v_cvt_pk_bf16_f32 v7, v254, v255
    v_mfma_f32_32x32x16_bf16 v[240:255], a[72:75], a[20:23], 0
    ds_read_b64_tr_b16 v[48:49], v26 offset:26624
    ds_read_b64_tr_b16 v[50:51], v26 offset:27648
    s_add_u32 m0, s73, 1024
    s_add_u32 s12, s77, 8192
    s_max_i32 s12, s12, 0
    buffer_load_dwordx4 v32, s[8:11], s12 offen lds
    s_waitcnt lgkmcnt(4)
    v_mfma_f32_32x32x16_bf16 v[64:79], v[56:59], v[16:19], v[64:79]
    ds_read_b64_tr_b16 v[52:53], v27 offset:26624
    ds_read_b64_tr_b16 v[54:55], v27 offset:27648
    s_waitcnt lgkmcnt(4)
    v_mfma_f32_32x32x16_bf16 v[80:95], v[60:63], v[16:19], v[80:95]
    v_add_f32 v232, 0x358637bd, v232
    v_rcp_f32 v232, v232
    s_add_u32 m0, s73, 2048
    s_add_u32 s12, s77, 16384
    buffer_load_dwordx4 v28, s[8:11], s12 offen lds
    v_mul_f32 v232, v232, v22
    v_mfma_f32_32x32x16_bf16 v[96:111], v[56:59], v[4:7], v[96:111]
    v_mul_f32 v224, v224, v232
    v_mul_f32 v225, v225, v232
    v_mul_f32 v226, v226, v232
    v_mul_f32 v227, v227, v232
    v_mul_f32 v228, v228, v232
    v_mul_f32 v229, v229, v232
    v_mfma_f32_32x32x16_bf16 v[112:127], v[60:63], v[4:7], v[112:127]
    v_mul_f32 v230, v230, v232
    s_add_u32 m0, s73, 3072
    s_add_u32 s12, s77, 24576
    buffer_load_dwordx4 v28, s[8:11], s12 offen lds
    v_mul_f32 v231, v231, v232
    v_cvt_pk_bf16_f32 v8, v224, v225
    v_cvt_pk_bf16_f32 v9, v226, v227
    v_cvt_pk_bf16_f32 v10, v228, v229
    v_cvt_pk_bf16_f32 v11, v230, v231
    s_waitcnt vmcnt(16)
    v_mfma_f32_32x32x16_bf16 v[224:239], a[76:79], a[24:27], 0
    v_add_f32 v248, 0x358637bd, v248
    v_rcp_f32 v248, v248
    s_nop 0
    v_mul_f32 v248, v248, v23
    s_add_u32 m0, s73, 4096
    s_add_u32 s12, s77, 32768
    buffer_load_dwordx4 v28, s[8:11], s12 offen lds
    v_mul_f32 v240, v240, v248
    v_mul_f32 v241, v241, v248
    v_mul_f32 v242, v242, v248
    v_mul_f32 v243, v243, v248
    v_mul_f32 v244, v244, v248
    v_mul_f32 v245, v245, v248
    v_mul_f32 v246, v246, v248
    v_mul_f32 v247, v247, v248
    s_add_u32 m0, s73, 5120
    s_add_u32 s12, s77, 40960
    buffer_load_dwordx4 v28, s[8:11], s12 offen lds
    v_cvt_pk_bf16_f32 v12, v240, v241
    v_cvt_pk_bf16_f32 v13, v242, v243
    v_cvt_pk_bf16_f32 v14, v244, v245
    v_cvt_pk_bf16_f32 v15, v246, v247
    v_mfma_f32_32x32x16_bf16 v[240:255], a[76:79], a[28:31], 0
    v_and_b32 v2, 31, v0
    s_lshl_b32 s64, s59, 5
    v_add_u32 v2, s64, v2
    v_and_b32 v1, 3, v2
    v_lshrrev_b32 v2, 2, v2
    v_lshlrev_b32 v2, 4, v2
    s_waitcnt lgkmcnt(2)
    v_mfma_f32_32x32x16_bf16 v[64:79], v[48:51], v[8:11], v[64:79]
    v_add_lshl_u32 v20, v2, v1, 2
    s_mov_b32 s97, 196608
    buffer_load_dword v21, v20, s[48:51], s97 offen sc1
    ds_read_b64_tr_b16 v[56:57], v26 offset:28672
    ds_read_b64_tr_b16 v[58:59], v26 offset:29696
    s_add_u32 m0, s73, 6144
    s_waitcnt lgkmcnt(2)
    v_mfma_f32_32x32x16_bf16 v[80:95], v[52:55], v[8:11], v[80:95]
    s_add_u32 s12, s77, 49152
    buffer_load_dwordx4 v28, s[8:11], s12 offen lds
    ds_read_b64_tr_b16 v[60:61], v27 offset:28672
    ds_read_b64_tr_b16 v[62:63], v27 offset:29696
    v_add_f32 v224, 0x358637bd, v224
    v_rcp_f32 v224, v224
    v_mfma_f32_32x32x16_bf16 v[96:111], v[48:51], v[12:15], v[96:111]
    s_add_u32 m0, s73, 7168
    s_add_u32 s12, s77, 57344
    buffer_load_dwordx4 v28, s[8:11], s12 offen lds
    v_mul_f32 v224, v224, v22
    v_mul_f32 v232, v232, v224
    v_mul_f32 v233, v233, v224
    v_mfma_f32_32x32x16_bf16 v[112:127], v[52:55], v[12:15], v[112:127]
    v_mul_f32 v234, v234, v224
    v_mul_f32 v235, v235, v224
    v_mul_f32 v236, v236, v224
    v_mul_f32 v237, v237, v224
    v_mul_f32 v238, v238, v224
    s_add_u32 m0, s73, 8192
    s_add_u32 s12, s77, 65536
    buffer_load_dwordx4 v28, s[8:11], s12 offen lds
    v_mul_f32 v239, v239, v224
    v_cvt_pk_bf16_f32 v16, v232, v233
    v_cvt_pk_bf16_f32 v17, v234, v235
    v_cvt_pk_bf16_f32 v18, v236, v237
    v_cvt_pk_bf16_f32 v19, v238, v239
    s_waitcnt vmcnt(21)
    v_mfma_f32_32x32x16_bf16 v[224:239], a[80:83], a[32:35], 0
    v_add_f32 v240, 0x358637bd, v240
    v_rcp_f32 v240, v240
    s_nop 0
    v_mul_f32 v240, v240, v23
    s_add_u32 m0, s73, 9216
    s_add_u32 s12, s77, 73728
    buffer_load_dwordx4 v28, s[8:11], s12 offen lds
    v_mul_f32 v248, v248, v240
    v_mul_f32 v249, v249, v240
    v_mul_f32 v250, v250, v240
    v_mul_f32 v251, v251, v240
    v_mul_f32 v252, v252, v240
    v_mul_f32 v253, v253, v240
    v_mul_f32 v254, v254, v240
    v_mul_f32 v255, v255, v240
    s_add_u32 m0, s73, 10240
    s_add_u32 s12, s77, 81920
    buffer_load_dwordx4 v28, s[8:11], s12 offen lds
    v_cvt_pk_bf16_f32 v4, v248, v249
    v_cvt_pk_bf16_f32 v5, v250, v251
    v_cvt_pk_bf16_f32 v6, v252, v253
    v_cvt_pk_bf16_f32 v7, v254, v255
    v_mfma_f32_32x32x16_bf16 v[240:255], a[80:83], a[36:39], 0
    s_waitcnt vmcnt(18)
    ds_read_b64_tr_b16 v[48:49], v26 offset:30720
    ds_read_b64_tr_b16 v[50:51], v26 offset:31744
    s_add_u32 m0, s73, 11264
    s_add_u32 s12, s77, 90112
    buffer_load_dwordx4 v28, s[8:11], s12 offen lds
    ds_read_b64_tr_b16 v[52:53], v27 offset:30720
    s_waitcnt lgkmcnt(5)
    v_mfma_f32_32x32x16_bf16 v[64:79], v[56:59], v[16:19], v[64:79]
    ds_read_b64_tr_b16 v[54:55], v27 offset:31744
    s_waitcnt lgkmcnt(4)
    v_mfma_f32_32x32x16_bf16 v[80:95], v[60:63], v[16:19], v[80:95]
    v_add_f32 v232, 0x358637bd, v232
    v_rcp_f32 v232, v232
    s_add_u32 m0, s73, 12288
    s_add_u32 s12, s77, 98304
    buffer_load_dwordx4 v28, s[8:11], s12 offen lds
    v_mul_f32 v232, v232, v22
    v_mfma_f32_32x32x16_bf16 v[96:111], v[56:59], v[4:7], v[96:111]
    v_mul_f32 v224, v224, v232
    v_mul_f32 v225, v225, v232
    v_mul_f32 v226, v226, v232
    v_mul_f32 v227, v227, v232
    v_mul_f32 v228, v228, v232
    v_mul_f32 v229, v229, v232
    v_mfma_f32_32x32x16_bf16 v[112:127], v[60:63], v[4:7], v[112:127]
    v_mul_f32 v230, v230, v232
    s_add_u32 m0, s73, 13312
    s_add_u32 s12, s77, 106496
    buffer_load_dwordx4 v28, s[8:11], s12 offen lds
    v_mul_f32 v231, v231, v232
    v_cvt_pk_bf16_f32 v8, v224, v225
    v_cvt_pk_bf16_f32 v9, v226, v227
    v_cvt_pk_bf16_f32 v10, v228, v229
    v_cvt_pk_bf16_f32 v11, v230, v231
    v_mfma_f32_32x32x16_bf16 v[224:239], a[84:87], a[40:43], 0
    v_add_f32 v248, 0x358637bd, v248
    v_rcp_f32 v248, v248
    s_nop 0
    v_mul_f32 v248, v248, v23
    s_add_u32 m0, s73, 14336
    s_add_u32 s12, s77, 114688
    buffer_load_dwordx4 v28, s[8:11], s12 offen lds
    v_mul_f32 v240, v240, v248
    v_mul_f32 v241, v241, v248
    v_mul_f32 v242, v242, v248
    v_mul_f32 v243, v243, v248
    v_mul_f32 v244, v244, v248
    v_mul_f32 v245, v245, v248
    v_mul_f32 v246, v246, v248
    v_mul_f32 v247, v247, v248
    s_add_u32 m0, s73, 15360
    s_add_u32 s12, s77, 122880
    buffer_load_dwordx4 v28, s[8:11], s12 offen lds
    v_cvt_pk_bf16_f32 v12, v240, v241
    v_cvt_pk_bf16_f32 v13, v242, v243
    v_cvt_pk_bf16_f32 v14, v244, v245
    v_cvt_pk_bf16_f32 v15, v246, v247
    v_mfma_f32_32x32x16_bf16 v[240:255], a[84:87], a[44:47], 0
    s_waitcnt vmcnt(21)
    ds_read_b64_tr_b16 v[56:57], v26 offset:32768
    ds_read_b64_tr_b16 v[58:59], v26 offset:33792
    s_add_u32 m0, s73, 16384
    s_add_u32 s12, s77, 131072
    buffer_load_dwordx4 v28, s[8:11], s12 offen lds
    ds_read_b64_tr_b16 v[60:61], v27 offset:32768
    s_waitcnt lgkmcnt(5)
    v_mfma_f32_32x32x16_bf16 v[64:79], v[48:51], v[8:11], v[64:79]
    ds_read_b64_tr_b16 v[62:63], v27 offset:33792
    s_waitcnt lgkmcnt(4)
    v_mfma_f32_32x32x16_bf16 v[80:95], v[52:55], v[8:11], v[80:95]
    v_add_f32 v224, 0x358637bd, v224
    v_rcp_f32 v224, v224
    s_add_u32 m0, s73, 17408
    s_add_u32 s12, s77, 139264
    buffer_load_dwordx4 v28, s[8:11], s12 offen lds
    v_mul_f32 v224, v224, v22
    v_mfma_f32_32x32x16_bf16 v[96:111], v[48:51], v[12:15], v[96:111]
    v_mul_f32 v232, v232, v224
    v_mul_f32 v233, v233, v224
    v_mul_f32 v234, v234, v224
    v_mul_f32 v235, v235, v224
    v_mul_f32 v236, v236, v224
    v_mul_f32 v237, v237, v224
    v_mfma_f32_32x32x16_bf16 v[112:127], v[52:55], v[12:15], v[112:127]
    v_mul_f32 v238, v238, v224
    s_add_u32 m0, s73, 18432
    s_add_u32 s12, s77, 147456
    buffer_load_dwordx4 v28, s[8:11], s12 offen lds
    v_mul_f32 v239, v239, v224
    v_cvt_pk_bf16_f32 v16, v232, v233
    v_cvt_pk_bf16_f32 v17, v234, v235
    v_cvt_pk_bf16_f32 v18, v236, v237
    v_cvt_pk_bf16_f32 v19, v238, v239
    v_mfma_f32_32x32x16_bf16 v[224:239], a[88:91], a[48:51], 0
    v_add_f32 v240, 0x358637bd, v240
    v_rcp_f32 v240, v240
    s_nop 0
    v_mul_f32 v240, v240, v23
    s_add_u32 m0, s73, 19456
    s_add_u32 s12, s77, 155648
    buffer_load_dwordx4 v28, s[8:11], s12 offen lds
    v_mul_f32 v248, v248, v240
    v_mul_f32 v249, v249, v240
    v_mul_f32 v250, v250, v240
    v_mul_f32 v251, v251, v240
    v_mul_f32 v252, v252, v240
    v_mul_f32 v253, v253, v240
    v_mul_f32 v254, v254, v240
    v_mul_f32 v255, v255, v240
    s_add_u32 m0, s73, 20480
    s_add_u32 s12, s77, 163840
    buffer_load_dwordx4 v28, s[8:11], s12 offen lds
    v_cvt_pk_bf16_f32 v4, v248, v249
    v_cvt_pk_bf16_f32 v5, v250, v251
    v_cvt_pk_bf16_f32 v6, v252, v253
    v_cvt_pk_bf16_f32 v7, v254, v255
    v_mfma_f32_32x32x16_bf16 v[240:255], a[88:91], a[52:55], 0
    s_waitcnt vmcnt(15)
    v_cmp_ne_u32 vcc, s61, v21
    s_nop 0
    s_cbranch_vccnz PS_17
PC_16:
    ds_read_b64_tr_b16 v[48:49], v26 offset:34816
    ds_read_b64_tr_b16 v[50:51], v26 offset:35840
L_pad_P3_1:
    s_cbranch_execz L_hopret
    s_add_u32 m0, s73, 21504
    s_add_u32 s12, s77, 172032
    s_waitcnt lgkmcnt(4)
    v_mfma_f32_32x32x16_bf16 v[64:79], v[56:59], v[16:19], v[64:79]
    buffer_load_dwordx4 v28, s[8:11], s12 offen lds
    ds_read_b64_tr_b16 v[52:53], v27 offset:34816
    ds_read_b64_tr_b16 v[54:55], v27 offset:35840
    s_waitcnt lgkmcnt(4)
    v_mfma_f32_32x32x16_bf16 v[80:95], v[60:63], v[16:19], v[80:95]
    v_add_f32 v232, 0x358637bd, v232
    v_rcp_f32 v232, v232
    s_lshl1_add_u32 s78, s59, 0
    s_mul_i32 s78, s78, 45056
    s_mul_i32 s13, s56, 11264
    s_add_u32 s78, s78, s13
    v_mfma_f32_32x32x16_bf16 v[96:111], v[56:59], v[4:7], v[96:111]
    s_add_u32 s78, s78, 11534336
    buffer_load_dwordx4 a[96:99], v24, s[48:51], s78 offen offset:0 sc1
    v_mul_f32 v232, v232, v22
    v_mul_f32 v224, v224, v232
    v_mul_f32 v225, v225, v232
    v_mul_f32 v226, v226, v232
    v_mfma_f32_32x32x16_bf16 v[112:127], v[60:63], v[4:7], v[112:127]
    v_mul_f32 v227, v227, v232
    v_mul_f32 v228, v228, v232
    v_mul_f32 v229, v229, v232
    v_mul_f32 v230, v230, v232
    buffer_load_dwordx4 a[104:107], v24, s[48:51], s78 offen offset:1024 sc1
    v_mul_f32 v231, v231, v232
    v_cvt_pk_bf16_f32 v8, v224, v225
    v_cvt_pk_bf16_f32 v9, v226, v227
    v_cvt_pk_bf16_f32 v10, v228, v229
    v_cvt_pk_bf16_f32 v11, v230, v231
    v_mfma_f32_32x32x16_bf16 v[224:239], a[92:95], a[56:59], 0
    v_add_f32 v248, 0x358637bd, v248
    v_rcp_f32 v248, v248
    s_nop 0
    v_mul_f32 v248, v248, v23
    buffer_load_dwordx4 a[112:115], v24, s[48:51], s78 offen offset:2048 sc1
    v_mul_f32 v240, v240, v248
    v_mul_f32 v241, v241, v248
    v_mul_f32 v242, v242, v248
    v_mul_f32 v243, v243, v248
    v_mul_f32 v244, v244, v248
    v_mul_f32 v245, v245, v248
    v_mul_f32 v246, v246, v248
    v_mul_f32 v247, v247, v248
    buffer_load_dwordx4 a[120:123], v24, s[48:51], s78 offen offset:3072 sc1
    v_cvt_pk_bf16_f32 v12, v240, v241
    v_cvt_pk_bf16_f32 v13, v242, v243
    v_cvt_pk_bf16_f32 v14, v244, v245
    v_cvt_pk_bf16_f32 v15, v246, v247
    v_mfma_f32_32x32x16_bf16 v[240:255], a[92:95], a[60:63], 0
    ds_read_b64_tr_b16 v[56:57], v26 offset:36864
    ds_read_b64_tr_b16 v[58:59], v26 offset:37888
    s_lshl1_add_u32 s78, s59, 0
    s_mul_i32 s78, s78, 45056
    s_mul_i32 s13, s56, 11264
    s_add_u32 s78, s78, s13
    s_waitcnt lgkmcnt(4)
    v_mfma_f32_32x32x16_bf16 v[64:79], v[48:51], v[8:11], v[64:79]
    s_add_u32 s78, s78, 11538432
    buffer_load_dwordx4 a[128:131], v24, s[48:51], s78 offen offset:0 sc1
    ds_read_b64_tr_b16 v[60:61], v27 offset:36864
    ds_read_b64_tr_b16 v[62:63], v27 offset:37888
    s_waitcnt lgkmcnt(4)
    v_mfma_f32_32x32x16_bf16 v[80:95], v[52:55], v[8:11], v[80:95]
    v_add_f32 v224, 0x358637bd, v224
    v_rcp_f32 v224, v224
    buffer_load_dwordx4 a[136:139], v24, s[48:51], s78 offen offset:1024 sc1
    v_mul_f32 v224, v224, v22
    v_mul_f32 v232, v232, v224
    v_mul_f32 v233, v233, v224
    v_mfma_f32_32x32x16_bf16 v[96:111], v[48:51], v[12:15], v[96:111]
    v_mul_f32 v234, v234, v224
    v_mul_f32 v235, v235, v224
    v_mul_f32 v236, v236, v224
    v_mul_f32 v237, v237, v224
    v_mul_f32 v238, v238, v224
    buffer_load_dwordx4 a[144:147], v24, s[48:51], s78 offen offset:2048 sc1
    v_mfma_f32_32x32x16_bf16 v[112:127], v[52:55], v[12:15], v[112:127]
    v_mul_f32 v239, v239, v224
    v_cvt_pk_bf16_f32 v16, v232, v233
    v_cvt_pk_bf16_f32 v17, v234, v235
    v_cvt_pk_bf16_f32 v18, v236, v237
    v_cvt_pk_bf16_f32 v19, v238, v239
    v_add_f32 v240, 0x358637bd, v240
    s_waitcnt lgkmcnt(2)
    v_mfma_f32_32x32x16_bf16 v[64:79], v[56:59], v[16:19], v[64:79]
    v_rcp_f32 v240, v240
    s_nop 0
    v_mul_f32 v240, v240, v23
    buffer_load_dwordx4 a[152:155], v24, s[48:51], s78 offen offset:3072 sc1
    v_mul_f32 v248, v248, v240
    v_mul_f32 v249, v249, v240
    v_mul_f32 v250, v250, v240
    s_waitcnt lgkmcnt(0)
    v_mfma_f32_32x32x16_bf16 v[80:95], v[60:63], v[16:19], v[80:95]
    v_mul_f32 v251, v251, v240
    v_mul_f32 v252, v252, v240
    v_mul_f32 v253, v253, v240
    v_mul_f32 v254, v254, v240
    v_mul_f32 v255, v255, v240
    s_lshl1_add_u32 s78, s59, 0
    s_mul_i32 s78, s78, 45056
    s_mul_i32 s13, s56, 11264
    s_add_u32 s78, s78, s13
    s_add_u32 s78, s78, 11542528
    buffer_load_dwordx4 a[160:163], v24, s[48:51], s78 offen offset:0 sc1
    v_cvt_pk_bf16_f32 v4, v248, v249
    v_cvt_pk_bf16_f32 v5, v250, v251
    v_cvt_pk_bf16_f32 v6, v252, v253
    v_cvt_pk_bf16_f32 v7, v254, v255
    s_nop 1
    v_mfma_f32_32x32x16_bf16 v[96:111], v[56:59], v[4:7], v[96:111]
    buffer_load_dwordx4 a[168:171], v24, s[48:51], s78 offen offset:1024 sc1
    buffer_load_dwordx4 a[176:179], v24, s[48:51], s78 offen offset:2048 sc1
    s_lshl1_add_u32 s81, s59, 1
    s_mul_i32 s81, s81, 45056
    s_mul_i32 s13, s56, 11264
    s_add_u32 s81, s81, s13
    v_mfma_f32_32x32x16_bf16 v[112:127], v[60:63], v[4:7], v[112:127]
    s_add_u32 s81, s81, 11534336
    buffer_load_dwordx4 a[100:103], v24, s[48:51], s81 offen offset:0 sc1
    buffer_load_dwordx4 a[108:111], v24, s[48:51], s81 offen offset:1024 sc1
    buffer_load_dwordx4 a[116:119], v24, s[48:51], s81 offen offset:2048 sc1
    buffer_load_dwordx4 a[124:127], v24, s[48:51], s81 offen offset:3072 sc1
    s_lshl1_add_u32 s81, s59, 1
    s_mul_i32 s81, s81, 45056
    s_mul_i32 s13, s56, 11264
    s_add_u32 s81, s81, s13
    s_add_u32 s81, s81, 11538432
    buffer_load_dwordx4 a[132:135], v24, s[48:51], s81 offen offset:0 sc1
    buffer_load_dwordx4 a[140:143], v24, s[48:51], s81 offen offset:1024 sc1
    buffer_load_dwordx4 a[148:151], v24, s[48:51], s81 offen offset:2048 sc1
    buffer_load_dwordx4 a[156:159], v24, s[48:51], s81 offen offset:3072 sc1
    s_lshl1_add_u32 s81, s59, 1
    s_mul_i32 s81, s81, 45056
    s_mul_i32 s13, s56, 11264
    s_add_u32 s81, s81, s13
    s_add_u32 s81, s81, 11542528
    buffer_load_dwordx4 a[164:167], v24, s[48:51], s81 offen offset:0 sc1
    buffer_load_dwordx4 a[172:175], v24, s[48:51], s81 offen offset:1024 sc1
    buffer_load_dwordx4 a[180:183], v24, s[48:51], s81 offen offset:2048 sc1
    s_waitcnt vmcnt(22)
    v_add_u32 v1, s73, v24
    ds_read_b64_tr_b16 v[128:129], v26 offset:0
    ds_read_b64_tr_b16 v[130:131], v26 offset:1024
    ds_read_b64_tr_b16 v[132:133], v26 offset:2048
    ds_read_b64_tr_b16 v[134:135], v26 offset:3072
    s_waitcnt vmcnt(21) lgkmcnt(2)
    v_mfma_f32_32x32x16_bf16 v[64:79], v[128:131], a[96:99], v[64:79]
    ds_read_b64_tr_b16 v[136:137], v26 offset:4096
    ds_read_b64_tr_b16 v[138:139], v26 offset:5120
    ds_read_b64_tr_b16 v[140:141], v26 offset:6144
    ds_read_b64_tr_b16 v[142:143], v26 offset:7168
    ds_read_b64_tr_b16 v[144:145], v26 offset:8192
    s_waitcnt vmcnt(20) lgkmcnt(5)
    v_mfma_f32_32x32x16_bf16 v[64:79], v[132:135], a[104:107], v[64:79]
    ds_read_b64_tr_b16 v[146:147], v26 offset:9216
    ds_read_b64_tr_b16 v[148:149], v26 offset:10240
    ds_read_b64_tr_b16 v[150:151], v26 offset:11264
    ds_read_b64_tr_b16 v[152:153], v26 offset:12288
    ds_read_b64_tr_b16 v[154:155], v26 offset:13312
    s_waitcnt vmcnt(19) lgkmcnt(8)
    v_mfma_f32_32x32x16_bf16 v[64:79], v[136:139], a[112:115], v[64:79]
    ds_read_b64_tr_b16 v[156:157], v26 offset:14336
    ds_read_b64_tr_b16 v[158:159], v26 offset:15360
    ds_read_b64_tr_b16 v[160:161], v26 offset:16384
    ds_read_b64_tr_b16 v[162:163], v26 offset:17408
    ds_read_b64_tr_b16 v[164:165], v26 offset:18432
    s_waitcnt vmcnt(18) lgkmcnt(11)
    v_mfma_f32_32x32x16_bf16 v[64:79], v[140:143], a[120:123], v[64:79]
    ds_read_b64_tr_b16 v[166:167], v26 offset:19456
    ds_read_b64_tr_b16 v[168:169], v26 offset:20480
    ds_read_b64_tr_b16 v[170:171], v26 offset:21504
    s_waitcnt vmcnt(17) lgkmcnt(12)
    v_mfma_f32_32x32x16_bf16 v[64:79], v[144:147], a[128:131], v[64:79]
    s_waitcnt vmcnt(16) lgkmcnt(10)
    v_mfma_f32_32x32x16_bf16 v[64:79], v[148:151], a[136:139], v[64:79]
    s_waitcnt vmcnt(15) lgkmcnt(8)
    v_mfma_f32_32x32x16_bf16 v[64:79], v[152:155], a[144:147], v[64:79]
    s_waitcnt vmcnt(14) lgkmcnt(6)
    v_mfma_f32_32x32x16_bf16 v[64:79], v[156:159], a[152:155], v[64:79]
    s_waitcnt vmcnt(13) lgkmcnt(4)
    v_mfma_f32_32x32x16_bf16 v[64:79], v[160:163], a[160:163], v[64:79]
    s_waitcnt vmcnt(12) lgkmcnt(2)
    v_mfma_f32_32x32x16_bf16 v[64:79], v[164:167], a[168:171], v[64:79]
    s_waitcnt vmcnt(11) lgkmcnt(0)
    v_mfma_f32_32x32x16_bf16 v[64:79], v[168:171], a[176:179], v[64:79]
    s_waitcnt vmcnt(10)
    v_mfma_f32_32x32x16_bf16 v[96:111], v[128:131], a[100:103], v[96:111]
    s_waitcnt vmcnt(9)
    v_mfma_f32_32x32x16_bf16 v[96:111], v[132:135], a[108:111], v[96:111]
    s_waitcnt vmcnt(8)
    v_mfma_f32_32x32x16_bf16 v[96:111], v[136:139], a[116:119], v[96:111]
    s_nop 5
    ds_write_b128 v1, v[64:67] offset:22528
    s_waitcnt vmcnt(7)
    v_mfma_f32_32x32x16_bf16 v[96:111], v[140:143], a[124:127], v[96:111]
    s_waitcnt vmcnt(6)
    v_mfma_f32_32x32x16_bf16 v[96:111], v[144:147], a[132:135], v[96:111]
    ds_write_b128 v1, v[68:71] offset:23552
    s_waitcnt vmcnt(5)
    v_mfma_f32_32x32x16_bf16 v[96:111], v[148:151], a[140:143], v[96:111]
    s_waitcnt vmcnt(4)
    v_mfma_f32_32x32x16_bf16 v[96:111], v[152:155], a[148:151], v[96:111]
    ds_write_b128 v1, v[72:75] offset:24576
    s_waitcnt vmcnt(3)
    v_mfma_f32_32x32x16_bf16 v[96:111], v[156:159], a[156:159], v[96:111]
    s_waitcnt vmcnt(2)
    v_mfma_f32_32x32x16_bf16 v[96:111], v[160:163], a[164:167], v[96:111]
    ds_write_b128 v1, v[76:79] offset:25600
    s_waitcnt vmcnt(1)
    v_mfma_f32_32x32x16_bf16 v[96:111], v[164:167], a[172:175], v[96:111]
    s_waitcnt vmcnt(0)
    v_mfma_f32_32x32x16_bf16 v[96:111], v[168:171], a[180:183], v[96:111]
    ds_read_b64_tr_b16 v[172:173], v27 offset:0
    ds_read_b64_tr_b16 v[174:175], v27 offset:1024
    ds_read_b64_tr_b16 v[176:177], v27 offset:2048
    ds_read_b64_tr_b16 v[178:179], v27 offset:3072
    ds_read_b64_tr_b16 v[180:181], v27 offset:4096
    s_waitcnt lgkmcnt(3)
    v_mfma_f32_32x32x16_bf16 v[80:95], v[172:175], a[96:99], v[80:95]
    ds_read_b64_tr_b16 v[182:183], v27 offset:5120
    ds_read_b64_tr_b16 v[184:185], v27 offset:6144
    ds_read_b64_tr_b16 v[186:187], v27 offset:7168
    ds_read_b64_tr_b16 v[188:189], v27 offset:8192
    ds_read_b64_tr_b16 v[190:191], v27 offset:9216
    s_waitcnt lgkmcnt(6)
    v_mfma_f32_32x32x16_bf16 v[80:95], v[176:179], a[104:107], v[80:95]
    ds_read_b64_tr_b16 v[192:193], v27 offset:10240
    ds_read_b64_tr_b16 v[194:195], v27 offset:11264
    ds_read_b64_tr_b16 v[196:197], v27 offset:12288
    ds_read_b64_tr_b16 v[198:199], v27 offset:13312
    ds_read_b64_tr_b16 v[200:201], v27 offset:14336
    s_waitcnt lgkmcnt(9)
    v_mfma_f32_32x32x16_bf16 v[80:95], v[180:183], a[112:115], v[80:95]
    ds_read_b64_tr_b16 v[202:203], v27 offset:15360
    ds_read_b64_tr_b16 v[204:205], v27 offset:16384
    ds_read_b64_tr_b16 v[206:207], v27 offset:17408
    ds_read_b64_tr_b16 v[208:209], v27 offset:18432
    ds_read_b64_tr_b16 v[210:211], v27 offset:19456
    s_waitcnt lgkmcnt(12)
    v_mfma_f32_32x32x16_bf16 v[80:95], v[184:187], a[120:123], v[80:95]
    ds_read_b64_tr_b16 v[212:213], v27 offset:20480
    ds_read_b64_tr_b16 v[214:215], v27 offset:21504
    ds_write_b128 v1, v[96:99] offset:30720
    s_waitcnt lgkmcnt(13)
    v_mfma_f32_32x32x16_bf16 v[80:95], v[188:191], a[128:131], v[80:95]
    ds_write_b128 v1, v[100:103] offset:31744
    s_waitcnt lgkmcnt(12)
    v_mfma_f32_32x32x16_bf16 v[80:95], v[192:195], a[136:139], v[80:95]
    s_waitcnt lgkmcnt(10)
    v_mfma_f32_32x32x16_bf16 v[80:95], v[196:199], a[144:147], v[80:95]
    ds_write_b128 v1, v[104:107] offset:32768
    s_waitcnt lgkmcnt(9)
    v_mfma_f32_32x32x16_bf16 v[80:95], v[200:203], a[152:155], v[80:95]
    s_waitcnt lgkmcnt(7)
    v_mfma_f32_32x32x16_bf16 v[80:95], v[204:207], a[160:163], v[80:95]
    ds_write_b128 v1, v[108:111] offset:33792
    s_waitcnt lgkmcnt(6)
    v_mfma_f32_32x32x16_bf16 v[80:95], v[208:211], a[168:171], v[80:95]
    s_waitcnt lgkmcnt(4)
    v_mfma_f32_32x32x16_bf16 v[80:95], v[212:215], a[176:179], v[80:95]
    v_mfma_f32_32x32x16_bf16 v[112:127], v[172:175], a[100:103], v[112:127]
    v_mfma_f32_32x32x16_bf16 v[112:127], v[176:179], a[108:111], v[112:127]
    v_mfma_f32_32x32x16_bf16 v[112:127], v[180:183], a[116:119], v[112:127]
    s_nop 8
    ds_write_b128 v1, v[80:83] offset:26624
    v_mfma_f32_32x32x16_bf16 v[112:127], v[184:187], a[124:127], v[112:127]
    v_mfma_f32_32x32x16_bf16 v[112:127], v[188:191], a[132:135], v[112:127]
    ds_write_b128 v1, v[84:87] offset:27648
    v_mfma_f32_32x32x16_bf16 v[112:127], v[192:195], a[140:143], v[112:127]
    v_mfma_f32_32x32x16_bf16 v[112:127], v[196:199], a[148:151], v[112:127]
    ds_write_b128 v1, v[88:91] offset:28672
    v_mfma_f32_32x32x16_bf16 v[112:127], v[200:203], a[156:159], v[112:127]
    v_mfma_f32_32x32x16_bf16 v[112:127], v[204:207], a[164:167], v[112:127]
    ds_write_b128 v1, v[92:95] offset:29696
    v_mfma_f32_32x32x16_bf16 v[112:127], v[208:211], a[172:175], v[112:127]
    v_mfma_f32_32x32x16_bf16 v[112:127], v[212:215], a[180:183], v[112:127]
    s_nop 11
    ds_write_b128 v1, v[112:115] offset:34816
    ds_write_b128 v1, v[116:119] offset:35840
    ds_write_b128 v1, v[120:123] offset:36864
    ds_write_b128 v1, v[124:127] offset:37888
    s_mov_b32 s52, s34
    s_mov_b32 s53, s35
    s_mov_b32 s54, 0x200000
    s_mov_b32 s55, 0x20000
    v_and_b32 v4, 31, v0
    v_lshlrev_b32 v4, 10, v4
    v_lshrrev_b32 v2, 5, v0
    v_lshl_add_u32 v4, v2, 4, v4
    s_lshl_b32 s64, s59, 16
    s_lshr_b32 s65, s56, 1
    s_lshl_b32 s65, s65, 15
    s_add_u32 s64, s64, s65
    s_lshl_b32 s65, s60, 7
    s_add_u32 s64, s64, s65
    s_and_b32 s65, s56, 1
    s_lshl_b32 s65, s65, 6
    s_add_u32 s68, s64, s65
    s_waitcnt lgkmcnt(0)
    s_barrier
    s_lshl_b32 s64, s56, 12
    s_add_u32 s64, s64, 22528
    v_add_u32 v1, s64, v24
    v_add_u32 v2, 81920, v1
    ds_read_b128 v[128:131], v1 offset:0
    ds_read_b128 v[132:135], v1 offset:1024
    ds_read_b128 v[136:139], v1 offset:2048
    ds_read_b128 v[140:143], v1 offset:3072
    ds_read_b128 v[144:147], v1 offset:40960
    ds_read_b128 v[148:151], v1 offset:41984
    ds_read_b128 v[152:155], v1 offset:43008
    ds_read_b128 v[156:159], v1 offset:44032
    ds_read_b128 v[160:163], v2 offset:0
    ds_read_b128 v[164:167], v2 offset:1024
    ds_read_b128 v[168:171], v2 offset:2048
    ds_read_b128 v[172:175], v2 offset:3072
    ds_read_b128 v[176:179], v2 offset:40960
    ds_read_b128 v[180:183], v2 offset:41984
    ds_read_b128 v[184:187], v2 offset:43008
    ds_read_b128 v[188:191], v2 offset:44032
    s_waitcnt lgkmcnt(11)
    v_pk_add_f32 v[128:129], v[128:129], v[144:145]
    s_waitcnt lgkmcnt(3)
    v_pk_add_f32 v[160:161], v[160:161], v[176:177]
    v_pk_add_f32 v[130:131], v[130:131], v[146:147]
    v_pk_add_f32 v[162:163], v[162:163], v[178:179]
    v_pk_add_f32 v[132:133], v[132:133], v[148:149]
    s_waitcnt lgkmcnt(2)
    v_pk_add_f32 v[164:165], v[164:165], v[180:181]
    v_pk_add_f32 v[134:135], v[134:135], v[150:151]
    v_pk_add_f32 v[166:167], v[166:167], v[182:183]
    v_pk_add_f32 v[136:137], v[136:137], v[152:153]
    s_waitcnt lgkmcnt(1)
    v_pk_add_f32 v[168:169], v[168:169], v[184:185]
    v_pk_add_f32 v[138:139], v[138:139], v[154:155]
    v_pk_add_f32 v[170:171], v[170:171], v[186:187]
    v_pk_add_f32 v[140:141], v[140:141], v[156:157]
    s_waitcnt lgkmcnt(0)
    v_pk_add_f32 v[172:173], v[172:173], v[188:189]
    v_pk_add_f32 v[142:143], v[142:143], v[158:159]
    v_pk_add_f32 v[174:175], v[174:175], v[190:191]
    v_pk_add_f32 v[128:129], v[128:129], v[160:161]
    v_pk_add_f32 v[130:131], v[130:131], v[162:163]
    v_pk_add_f32 v[132:133], v[132:133], v[164:165]
    v_pk_add_f32 v[134:135], v[134:135], v[166:167]
    v_pk_add_f32 v[136:137], v[136:137], v[168:169]
    v_pk_add_f32 v[138:139], v[138:139], v[170:171]
    v_pk_add_f32 v[140:141], v[140:141], v[172:173]
    v_pk_add_f32 v[142:143], v[142:143], v[174:175]
    v_cvt_pk_bf16_f32 v192, v128, v129
    v_cvt_pk_bf16_f32 v193, v130, v131
    v_cvt_pk_bf16_f32 v194, v132, v133
    v_cvt_pk_bf16_f32 v195, v134, v135
    v_cvt_pk_bf16_f32 v196, v136, v137
    v_cvt_pk_bf16_f32 v197, v138, v139
    v_cvt_pk_bf16_f32 v198, v140, v141
    v_cvt_pk_bf16_f32 v199, v142, v143
    v_permlane32_swap_b32 v192, v194
    v_permlane32_swap_b32 v193, v195
    v_permlane32_swap_b32 v196, v198
    v_permlane32_swap_b32 v197, v199
    buffer_store_dwordx4 v[192:195], v4, s[52:55], s68 offen offset:0
    buffer_store_dwordx4 v[196:199], v4, s[52:55], s68 offen offset:32
L_END:
    s_endpgm
ZS_2:
    s_mov_b32 s86, 20000
ZS_2_l:
    s_mul_i32 s69, s79, 5632
    s_add_u32 s69, s69, 524288
    s_add_u32 s68, s69, 4096
    buffer_load_dwordx2 v[224:225], v25, s[48:51], s69 offen offset:0 sc1
    buffer_load_dwordx2 v[226:227], v25, s[48:51], s69 offen offset:512 sc1
    buffer_load_dwordx2 v[228:229], v25, s[48:51], s69 offen offset:1024 sc1
    buffer_load_dwordx2 v[230:231], v25, s[48:51], s69 offen offset:1536 sc1
    buffer_load_dwordx2 v[232:233], v25, s[48:51], s69 offen offset:2048 sc1
    buffer_load_dwordx2 v[234:235], v25, s[48:51], s69 offen offset:2560 sc1
    buffer_load_dwordx2 v[236:237], v25, s[48:51], s69 offen offset:3072 sc1
    buffer_load_dwordx2 v[238:239], v25, s[48:51], s69 offen offset:3584 sc1
    buffer_load_dwordx2 v[240:241], v25, s[48:51], s68 offen offset:0 sc1
    buffer_load_dwordx2 v[242:243], v25, s[48:51], s68 offen offset:512 sc1
    buffer_load_dwordx2 v[244:245], v25, s[48:51], s68 offen offset:1024 sc1
    s_waitcnt vmcnt(0)
    v_min3_u32 v160, v225, v227, v229
    v_max3_u32 v161, v225, v227, v229
    v_min3_u32 v160, v160, v231, v233
    v_max3_u32 v161, v161, v231, v233
    v_min3_u32 v160, v160, v235, v237
    v_max3_u32 v161, v161, v235, v237
    v_min3_u32 v160, v160, v239, v241
    v_max3_u32 v161, v161, v239, v241
    v_min3_u32 v160, v160, v243, v245
    v_max3_u32 v161, v161, v243, v245
    v_xor_b32 v160, s61, v160
    v_xor_b32 v161, s61, v161
    v_or_b32 v160, v160, v161
    v_cmp_ne_u32 vcc, 0, v160
    s_cbranch_vccz ZC_1
    s_sub_u32 s86, s86, 1
    s_cmp_lg_u32 s86, 0
    s_cbranch_scc1 ZS_2_l
    s_branch ZC_1
ZS_4:
    s_mov_b32 s86, 20000
ZS_4_l:
    s_mul_i32 s69, s79, 5632
    s_add_u32 s69, s69, 524288
    s_add_u32 s68, s69, 4096
    buffer_load_dwordx2 v[224:225], v25, s[48:51], s69 offen offset:0 sc1
    buffer_load_dwordx2 v[226:227], v25, s[48:51], s69 offen offset:512 sc1
    buffer_load_dwordx2 v[228:229], v25, s[48:51], s69 offen offset:1024 sc1
    buffer_load_dwordx2 v[230:231], v25, s[48:51], s69 offen offset:1536 sc1
    buffer_load_dwordx2 v[232:233], v25, s[48:51], s69 offen offset:2048 sc1
    buffer_load_dwordx2 v[234:235], v25, s[48:51], s69 offen offset:2560 sc1
    buffer_load_dwordx2 v[236:237], v25, s[48:51], s69 offen offset:3072 sc1
    buffer_load_dwordx2 v[238:239], v25, s[48:51], s69 offen offset:3584 sc1
    buffer_load_dwordx2 v[240:241], v25, s[48:51], s68 offen offset:0 sc1
    buffer_load_dwordx2 v[242:243], v25, s[48:51], s68 offen offset:512 sc1
    buffer_load_dwordx2 v[244:245], v25, s[48:51], s68 offen offset:1024 sc1
    s_waitcnt vmcnt(0)
    v_min3_u32 v160, v225, v227, v229
    v_max3_u32 v161, v225, v227, v229
    v_min3_u32 v160, v160, v231, v233
    v_max3_u32 v161, v161, v231, v233
    v_min3_u32 v160, v160, v235, v237
    v_max3_u32 v161, v161, v235, v237
    v_min3_u32 v160, v160, v239, v241
    v_max3_u32 v161, v161, v239, v241
    v_min3_u32 v160, v160, v243, v245
    v_max3_u32 v161, v161, v243, v245
    v_xor_b32 v160, s61, v160
    v_xor_b32 v161, s61, v161
    v_or_b32 v160, v160, v161
    v_cmp_ne_u32 vcc, 0, v160
    s_cbranch_vccz ZC_3
    s_sub_u32 s86, s86, 1
    s_cmp_lg_u32 s86, 0
    s_cbranch_scc1 ZS_4_l
    s_branch ZC_3
PS_6:
    s_mov_b32 s86, 20000
PS_6_l:
    buffer_load_dword v14, v8, s[48:51], s97 offen sc1
    s_waitcnt vmcnt(0)
    v_cmp_ne_u32 vcc, s61, v14
    s_cbranch_vccz PC_5
    s_sub_u32 s86, s86, 1
    s_cmp_lg_u32 s86, 0
    s_cbranch_scc1 PS_6_l
    s_branch PC_5
PS_8:
    s_mov_b32 s86, 20000
PS_8_l:
    buffer_load_dword v14, v9, s[48:51], s97 offen sc1
    s_waitcnt vmcnt(0)
    v_cmp_ne_u32 vcc, s61, v14
    s_cbranch_vccz PC_7
    s_sub_u32 s86, s86, 1
    s_cmp_lg_u32 s86, 0
    s_cbranch_scc1 PS_8_l
    s_branch PC_7
PS_10:
    s_mov_b32 s86, 20000
PS_10_l:
    buffer_load_dword v15, v10, s[48:51], s97 offen sc1
    s_waitcnt vmcnt(0)
    v_cmp_ne_u32 vcc, s61, v15
    s_cbranch_vccz PC_9
    s_sub_u32 s86, s86, 1
    s_cmp_lg_u32 s86, 0
    s_cbranch_scc1 PS_10_l
    s_branch PC_9
PS_12:
    s_mov_b32 s86, 20000
PS_12_l:
    buffer_load_dword v14, v9, s[48:51], s97 offen sc1
    s_waitcnt vmcnt(0)
    v_cmp_ne_u32 vcc, s61, v14
    s_cbranch_vccz PC_11
    s_sub_u32 s86, s86, 1
    s_cmp_lg_u32 s86, 0
    s_cbranch_scc1 PS_12_l
    s_branch PC_11
PS_15:
    s_mov_b32 s86, 20000
PS_15_l:
    buffer_load_dword v14, v11, s[48:51], s97 offen sc1
    s_waitcnt vmcnt(0)
    v_cmp_ne_u32 vcc, s61, v14
    s_cbranch_vccz PC_14
    s_sub_u32 s86, s86, 1
    s_cmp_lg_u32 s86, 0
    s_cbranch_scc1 PS_15_l
    s_branch PC_14
PS_17:
    s_mov_b32 s86, 20000
PS_17_l:
    buffer_load_dword v21, v20, s[48:51], s97 offen sc1
    s_waitcnt vmcnt(0)
    v_cmp_ne_u32 vcc, s61, v21
    s_cbranch_vccz PC_16
    s_sub_u32 s86, s86, 1
    s_cmp_lg_u32 s86, 0
    s_cbranch_scc1 PS_17_l
    s_branch PC_16

L_code_end:
    s_endpgm
.section .rodata,"a"
.p2align 6
.amdhsa_kernel gated_mix__linear_attn_block__mixer_gmlp__prompt_kernel
  .amdhsa_next_free_vgpr 512
  .amdhsa_next_free_sgpr 102
  .amdhsa_accum_offset 256
  .amdhsa_group_segment_fixed_size 0
  .amdhsa_kernarg_size 96
  .amdhsa_user_sgpr_count 2
  .amdhsa_user_sgpr_kernarg_segment_ptr 1
  .amdhsa_system_sgpr_workgroup_id_x 1
  .amdhsa_float_denorm_mode_32 3
.end_amdhsa_kernel
```
